```python
import torch

def _softmax(x, axis=-1):
    return torch.softmax(x, dim=axis)
def _gelu(x):
    return torch.nn.functional.gelu(x, approximate="tanh")
def _silu(x):
    return torch.nn.functional.silu(x)
def _sigmoid(x):
    return torch.sigmoid(x)
def _layernorm(x, axis=-1, eps=1e-5):
    m = x.mean(dim=axis, keepdim=True)
    v = x.var(dim=axis, keepdim=True, unbiased=False)
    return (x - m) / torch.sqrt(v + eps)
def _scatter_add(tgt, idx, src, axis=0):
    return tgt.clone().index_add_(axis, idx, src)
def _segment_sum(src, seg, n):
    out = torch.zeros((n,) + src.shape[1:], dtype=src.dtype)
    return out.index_add_(0, seg, src)
def _pad(x, pw):
    flat = tuple(v for pair in reversed(pw) for v in pair)
    return torch.nn.functional.pad(x, flat)

kernel_name = 'standalone__mha_softmax__prompt'

def setup_inputs():

    _w = (lambda a: (lambda t: t.to(torch.bfloat16) if t.is_floating_point() else t)(torch.as_tensor(a)))
    B, H, Sq, Sk, D = 1, 32, 2048, 2048, 192
    return {
        "q": _w((lambda *s: torch.randn(*s, dtype=torch.bfloat16) * 0.8)(B, H, Sq, D)),
        "k": _w((lambda *s: torch.randn(*s, dtype=torch.bfloat16) * 0.8)(B, H, Sk, D)),
        "v": _w((lambda *s: torch.randn(*s, dtype=torch.bfloat16) * 0.05)(B, H, Sk, D)),
    }

def reference(q, k, v):
    scale = q.shape[-1] ** -0.5
    scores = torch.einsum("bhqd,bhkd->bhqk", q, k) * scale
    p = _softmax(scores, axis=-1)
    return torch.einsum("bhqk,bhkd->bhqd", p, v)
```

```asm
; @launch grid=(256,1,1) block=(256,1,1) lds=98368
.amdgcn_target "amdgcn-amd-amdhsa--gfx950"
.text
.globl standalone__mha_softmax__prompt_kernel
.p2align 8
.type standalone__mha_softmax__prompt_kernel,@function
standalone__mha_softmax__prompt_kernel:
    s_cmp_ge_u32 s2, 256
    s_cbranch_scc1 L_end
    s_load_dwordx8 s[4:11], s[0:1], 0
    s_getpc_b64 s[80:81]
    s_lshr_b32 s3, s2, 3
    s_lshl_b32 s3, s3, 10
    v_lshrrev_b32 v1, 4, v0
    v_lshl_add_u32 v1, v1, 6, s3
    v_mov_b32 v3, s81
    v_add_co_u32 v2, vcc, s80, v1
    s_nop 1
    v_addc_co_u32 v3, vcc, 0, v3, vcc
    global_load_dword v226, v[2:3], off
    v_mov_b32 v224, v0
    v_lshrrev_b32 v1, 6, v0
    v_and_b32 v8, 63, v0
    s_and_b32 s3, s2, 7
    v_readfirstlane_b32 s14, v1
    s_lshr_b32 s15, s2, 6
    s_lshl_b32 s3, s3, 2
    s_add_u32 s3, s3, s15
    s_lshr_b32 s15, s2, 3
    s_and_b32 s15, s15, 7
    s_mul_i32 s3, s3, 786432
    s_mul_i32 s15, s15, 98304
    s_add_u32 s15, s15, s3
    s_mul_i32 s32, s14, 3072
    v_and_b32 v5, 15, v8
    v_lshrrev_b32 v6, 4, v8
    v_lshl_add_u32 v9, v1, 6, v5
    v_mul_u32_u24 v9, 384, v9
    v_lshl_add_u32 v225, v6, 4, v9
    v_and_b32 v10, 1, v1
    s_mov_b32 s33, 0
    s_mov_b32 s34, 0
    s_mov_b32 s83, 761856
    s_mov_b32 s85, 65536
    s_mov_b32 s86, 0x3f803f80
    s_mov_b32 s84, 761856
    v_add_u32 v9, 0, v8
    v_mul_u32_u24 v9, 2731, v9
    v_lshrrev_b32 v9, 17, v9
    v_lshl_add_u32 v4, v10, 2, v9
    v_xor_b32 v4, v4, v8
    v_lshl_add_u32 v214, v4, 4, s32
    v_lshlrev_b32 v4, 1, v9
    v_xor_b32 v4, v4, v8
    v_lshl_add_u32 v217, v4, 4, s32
    v_add_u32 v9, 64, v8
    v_mul_u32_u24 v9, 2731, v9
    v_lshrrev_b32 v9, 17, v9
    v_lshl_add_u32 v4, v10, 2, v9
    v_xor_b32 v4, v4, v8
    v_lshl_add_u32 v215, v4, 4, s32
    v_lshlrev_b32 v4, 1, v9
    v_xor_b32 v4, v4, v8
    v_lshl_add_u32 v218, v4, 4, s32
    v_add_u32 v9, 128, v8
    v_mul_u32_u24 v9, 2731, v9
    v_lshrrev_b32 v9, 17, v9
    v_lshl_add_u32 v4, v10, 2, v9
    v_xor_b32 v4, v4, v8
    v_lshl_add_u32 v216, v4, 4, s32
    v_lshlrev_b32 v4, 1, v9
    v_xor_b32 v4, v4, v8
    v_lshl_add_u32 v219, v4, 4, s32
    s_mov_b32 s18, 98304
    s_mov_b32 s19, 0x20000
    s_mov_b32 s22, 786432
    s_mov_b32 s23, 0x20000
    s_mov_b32 s26, 786432
    s_mov_b32 s27, 0x20000
    s_mov_b32 s30, 98304
    s_mov_b32 s31, 0x20000
    s_mov_b32 s73, 6144
    s_mov_b32 s74, 12288
    s_mov_b32 s75, 18432
    v_mov_b32 v228, 0
    v_mov_b32 v229, 0
    v_mov_b32 v230, 0
    v_mov_b32 v231, 0
    s_waitcnt lgkmcnt(0)
    s_add_u32 s20, s6, s3
    s_addc_u32 s21, s7, 0
    s_add_u32 s16, s4, s15
    s_addc_u32 s17, s5, 0
    v_mfma_f32_32x32x16_bf16 a[240:255], v[228:231], v[228:231], 0
    s_add_u32 m0, s32, 0
    s_nop 0
    buffer_load_dwordx4 v214, s[20:23], s33 offen offset:0  lds
    buffer_load_dwordx4 v215, s[20:23], s33 offen offset:1024  lds
    buffer_load_dwordx4 v216, s[20:23], s33 offen offset:2048  lds
    s_add_u32 s33, s33, 12288
    s_add_u32 m0, s32, 12288
    s_nop 0
    buffer_load_dwordx4 v214, s[20:23], s33 offen offset:0  lds
    buffer_load_dwordx4 v215, s[20:23], s33 offen offset:1024  lds
    buffer_load_dwordx4 v216, s[20:23], s33 offen offset:2048  lds
    s_add_u32 s33, s33, 12288
    buffer_load_dwordx4 v[112:115], v225, s[16:19], 0 offen offset:0
    buffer_load_dwordx4 v[116:119], v225, s[16:19], 0 offen offset:64
    buffer_load_dwordx4 v[120:123], v225, s[16:19], 0 offen offset:128
    buffer_load_dwordx4 v[124:127], v225, s[16:19], 0 offen offset:192
    buffer_load_dwordx4 v[128:131], v225, s[16:19], 0 offen offset:256
    buffer_load_dwordx4 v[132:135], v225, s[16:19], 0 offen offset:320
    s_add_u32 s24, s8, s3
    s_addc_u32 s25, s9, 0
    s_add_u32 s28, s10, s15
    s_addc_u32 s29, s11, 0
    s_cmp_ge_u32 s14, 2
    s_cselect_b32 s76, s24, s20
    s_cselect_b32 s77, s25, s21
    s_cselect_b32 s82, 2, 5
    s_mul_i32 s82, s82, 24576
    s_mov_b32 s78, 786432
    s_mov_b32 s79, 0x20000
    s_bfe_u32 s14, s2, 0x30003
    s_lshl_b32 s14, s14, 13
    s_add_u32 m0, s32, 24576
    v_and_b32 v3, 127, v224
    v_lshl_add_u32 v227, v3, 6, s14
    s_mov_b32 s36, 0x4f800000
    s_mov_b32 s38, 0x3dd53b95
    s_mov_b32 s37, 0xffff0000
    s_mov_b32 s35, 0
    v_mul_u32_u24 v3, 384, v5
    v_bfe_u32 v4, v5, 1, 3
    v_xor_b32 v7, v6, v4
    v_lshl_add_u32 v208, v7, 4, v3
    v_xor_b32 v7, 4, v7
    v_lshl_add_u32 v209, v7, 4, v3
    v_lshrrev_b32 v3, 2, v8
    v_mul_u32_u24 v4, 384, v3
    v_and_b32 v7, 3, v8
    v_lshl_add_u32 v4, v7, 3, v4
    v_add_u32 v4, 49152, v4
    v_bfe_u32 v3, v3, 1, 2
    v_xor_b32 v7, 0, v3
    v_lshl_add_u32 v210, v7, 5, v4
    v_xor_b32 v7, 1, v3
    v_lshl_add_u32 v211, v7, 5, v4
    v_xor_b32 v7, 2, v3
    v_lshl_add_u32 v212, v7, 5, v4
    v_xor_b32 v7, 3, v3
    v_lshl_add_u32 v213, v7, 5, v4
    v_mov_b32 v220, 0
    v_mov_b32 v221, 0
    v_mov_b32 v222, 0
    v_mov_b32 v223, 0
    buffer_load_dwordx4 v[136:139], v225, s[16:19], s73 offen offset:0
    buffer_load_dwordx4 v[140:143], v225, s[16:19], s73 offen offset:64
    buffer_load_dwordx4 v[144:147], v225, s[16:19], s73 offen offset:128
    buffer_load_dwordx4 v[148:151], v225, s[16:19], s73 offen offset:192
    s_waitcnt vmcnt(10)
    s_barrier
    ds_read_b128 a[0:3], v208 offset:0
    ds_read_b128 a[4:7], v208 offset:6144
    ds_read_b128 a[8:11], v208 offset:12288
    ds_read_b128 a[12:15], v208 offset:18432
    ds_read_b128 a[16:19], v209 offset:0
    ds_read_b128 a[20:23], v209 offset:6144
    ds_read_b128 a[24:27], v209 offset:12288
    ds_read_b128 a[28:31], v209 offset:18432
    ds_read_b128 a[32:35], v208 offset:128
    ds_read_b128 a[36:39], v208 offset:6272
    ds_read_b128 a[40:43], v208 offset:12416
    ds_read_b128 a[44:47], v208 offset:18560
    ds_read_b128 a[48:51], v209 offset:128
    ds_read_b128 a[52:55], v209 offset:6272
    ds_read_b128 a[56:59], v209 offset:12416
    ds_read_b128 a[60:63], v209 offset:18560
    ds_read_b128 a[64:67], v208 offset:256
    ds_read_b128 a[68:71], v208 offset:6400
    ds_read_b128 a[72:75], v208 offset:12544
    ds_read_b128 a[76:79], v208 offset:18688
    ds_read_b128 a[80:83], v209 offset:256
    ds_read_b128 a[84:87], v209 offset:6400
    ds_read_b128 a[88:91], v209 offset:12544
    ds_read_b128 a[92:95], v209 offset:18688
    s_waitcnt vmcnt(9)
    v_lshlrev_b32 v232, 16, v112
    v_and_b32 v233, s37, v112
    v_lshlrev_b32 v234, 16, v113
    v_and_b32 v235, s37, v113
    v_lshlrev_b32 v236, 16, v114
    v_and_b32 v237, s37, v114
    v_lshlrev_b32 v238, 16, v115
    v_and_b32 v239, s37, v115
    v_mul_f32 v232, s38, v232
    v_mul_f32 v233, s38, v233
    v_mul_f32 v234, s38, v234
    v_mul_f32 v235, s38, v235
    v_mul_f32 v236, s38, v236
    v_mul_f32 v237, s38, v237
    v_mul_f32 v238, s38, v238
    v_mul_f32 v239, s38, v239
    v_cvt_pk_bf16_f32 v112, v232, v233
    v_cvt_pk_bf16_f32 v113, v234, v235
    v_cvt_pk_bf16_f32 v114, v236, v237
    v_cvt_pk_bf16_f32 v115, v238, v239
    v_accvgpr_write_b32 a96, v112
    v_accvgpr_write_b32 a97, v113
    s_waitcnt lgkmcnt(14)
    v_mfma_f32_16x16x32_bf16 v[0:3], a[0:3], v[112:115], 0
    v_accvgpr_write_b32 a98, v114
    v_accvgpr_write_b32 a99, v115
    v_mfma_f32_16x16x32_bf16 v[64:67], a[4:7], v[112:115], 0
    v_mfma_f32_16x16x32_bf16 v[16:19], a[8:11], v[112:115], 0
    v_mfma_f32_16x16x32_bf16 v[80:83], a[12:15], v[112:115], 0
    s_waitcnt vmcnt(8)
    v_lshlrev_b32 v240, 16, v116
    v_and_b32 v241, s37, v116
    v_lshlrev_b32 v242, 16, v117
    v_and_b32 v243, s37, v117
    v_lshlrev_b32 v244, 16, v118
    v_and_b32 v245, s37, v118
    v_lshlrev_b32 v246, 16, v119
    v_and_b32 v247, s37, v119
    v_mul_f32 v240, s38, v240
    v_mul_f32 v241, s38, v241
    v_mul_f32 v242, s38, v242
    v_mul_f32 v243, s38, v243
    v_mul_f32 v244, s38, v244
    v_mul_f32 v245, s38, v245
    v_mul_f32 v246, s38, v246
    v_mul_f32 v247, s38, v247
    v_cvt_pk_bf16_f32 v116, v240, v241
    v_cvt_pk_bf16_f32 v117, v242, v243
    v_cvt_pk_bf16_f32 v118, v244, v245
    v_cvt_pk_bf16_f32 v119, v246, v247
    v_accvgpr_write_b32 a100, v116
    v_accvgpr_write_b32 a101, v117
    v_mfma_f32_16x16x32_bf16 v[0:3], a[16:19], v[116:119], v[0:3]
    v_accvgpr_write_b32 a102, v118
    v_accvgpr_write_b32 a103, v119
    v_mfma_f32_16x16x32_bf16 v[64:67], a[20:23], v[116:119], v[64:67]
    v_mfma_f32_16x16x32_bf16 v[16:19], a[24:27], v[116:119], v[16:19]
    v_mfma_f32_16x16x32_bf16 v[80:83], a[28:31], v[116:119], v[80:83]
    buffer_load_dwordx4 v[152:155], v225, s[16:19], s73 offen offset:256
    s_waitcnt vmcnt(8)
    v_lshlrev_b32 v232, 16, v120
    v_and_b32 v233, s37, v120
    v_lshlrev_b32 v234, 16, v121
    v_and_b32 v235, s37, v121
    v_lshlrev_b32 v236, 16, v122
    v_and_b32 v237, s37, v122
    v_lshlrev_b32 v238, 16, v123
    v_and_b32 v239, s37, v123
    v_mul_f32 v232, s38, v232
    v_mul_f32 v233, s38, v233
    v_mul_f32 v234, s38, v234
    v_mul_f32 v235, s38, v235
    v_mul_f32 v236, s38, v236
    v_mul_f32 v237, s38, v237
    v_mul_f32 v238, s38, v238
    v_mul_f32 v239, s38, v239
    v_cvt_pk_bf16_f32 v120, v232, v233
    v_cvt_pk_bf16_f32 v121, v234, v235
    v_cvt_pk_bf16_f32 v122, v236, v237
    v_cvt_pk_bf16_f32 v123, v238, v239
    v_accvgpr_write_b32 a104, v120
    v_accvgpr_write_b32 a105, v121
    v_mfma_f32_16x16x32_bf16 v[0:3], a[32:35], v[120:123], v[0:3]
    v_accvgpr_write_b32 a106, v122
    v_accvgpr_write_b32 a107, v123
    v_mfma_f32_16x16x32_bf16 v[64:67], a[36:39], v[120:123], v[64:67]
    s_waitcnt lgkmcnt(13)
    v_mfma_f32_16x16x32_bf16 v[16:19], a[40:43], v[120:123], v[16:19]
    s_waitcnt lgkmcnt(12)
    v_mfma_f32_16x16x32_bf16 v[80:83], a[44:47], v[120:123], v[80:83]
    buffer_load_dwordx4 v[156:159], v225, s[16:19], s73 offen offset:320
    s_waitcnt vmcnt(8)
    v_lshlrev_b32 v240, 16, v124
    v_and_b32 v241, s37, v124
    v_lshlrev_b32 v242, 16, v125
    v_and_b32 v243, s37, v125
    v_lshlrev_b32 v244, 16, v126
    v_and_b32 v245, s37, v126
    v_lshlrev_b32 v246, 16, v127
    v_and_b32 v247, s37, v127
    v_mul_f32 v240, s38, v240
    v_mul_f32 v241, s38, v241
    v_mul_f32 v242, s38, v242
    v_mul_f32 v243, s38, v243
    v_mul_f32 v244, s38, v244
    v_mul_f32 v245, s38, v245
    v_mul_f32 v246, s38, v246
    v_mul_f32 v247, s38, v247
    v_cvt_pk_bf16_f32 v124, v240, v241
    v_cvt_pk_bf16_f32 v125, v242, v243
    v_cvt_pk_bf16_f32 v126, v244, v245
    v_cvt_pk_bf16_f32 v127, v246, v247
    v_accvgpr_write_b32 a108, v124
    v_accvgpr_write_b32 a109, v125
    s_waitcnt lgkmcnt(11)
    v_mfma_f32_16x16x32_bf16 v[0:3], a[48:51], v[124:127], v[0:3]
    v_accvgpr_write_b32 a110, v126
    v_accvgpr_write_b32 a111, v127
    s_waitcnt lgkmcnt(10)
    v_mfma_f32_16x16x32_bf16 v[64:67], a[52:55], v[124:127], v[64:67]
    s_waitcnt lgkmcnt(9)
    v_mfma_f32_16x16x32_bf16 v[16:19], a[56:59], v[124:127], v[16:19]
    s_waitcnt lgkmcnt(8)
    v_mfma_f32_16x16x32_bf16 v[80:83], a[60:63], v[124:127], v[80:83]
    v_mfma_f32_32x32x16_bf16 v[112:127], v[228:231], v[228:231], 0
    buffer_load_dwordx4 v[160:163], v225, s[16:19], s74 offen offset:0
    s_waitcnt vmcnt(8)
    v_lshlrev_b32 v232, 16, v128
    v_and_b32 v233, s37, v128
    v_lshlrev_b32 v234, 16, v129
    v_and_b32 v235, s37, v129
    v_lshlrev_b32 v236, 16, v130
    v_and_b32 v237, s37, v130
    v_lshlrev_b32 v238, 16, v131
    v_and_b32 v239, s37, v131
    v_mul_f32 v232, s38, v232
    v_mul_f32 v233, s38, v233
    v_mul_f32 v234, s38, v234
    v_mul_f32 v235, s38, v235
    v_mul_f32 v236, s38, v236
    v_mul_f32 v237, s38, v237
    v_mul_f32 v238, s38, v238
    v_mul_f32 v239, s38, v239
    v_cvt_pk_bf16_f32 v128, v232, v233
    v_cvt_pk_bf16_f32 v129, v234, v235
    v_cvt_pk_bf16_f32 v130, v236, v237
    v_cvt_pk_bf16_f32 v131, v238, v239
    v_accvgpr_write_b32 a112, v128
    v_accvgpr_write_b32 a113, v129
    s_waitcnt lgkmcnt(7)
    v_mfma_f32_16x16x32_bf16 v[0:3], a[64:67], v[128:131], v[0:3]
    v_accvgpr_write_b32 a114, v130
    v_accvgpr_write_b32 a115, v131
    s_waitcnt lgkmcnt(6)
    v_mfma_f32_16x16x32_bf16 v[64:67], a[68:71], v[128:131], v[64:67]
    s_waitcnt lgkmcnt(5)
    v_mfma_f32_16x16x32_bf16 v[16:19], a[72:75], v[128:131], v[16:19]
    s_waitcnt lgkmcnt(4)
    v_mfma_f32_16x16x32_bf16 v[80:83], a[76:79], v[128:131], v[80:83]
    buffer_load_dwordx4 v[164:167], v225, s[16:19], s74 offen offset:64
    s_waitcnt vmcnt(8)
    v_lshlrev_b32 v240, 16, v132
    v_and_b32 v241, s37, v132
    v_lshlrev_b32 v242, 16, v133
    v_and_b32 v243, s37, v133
    v_lshlrev_b32 v244, 16, v134
    v_and_b32 v245, s37, v134
    v_lshlrev_b32 v246, 16, v135
    v_and_b32 v247, s37, v135
    v_mul_f32 v240, s38, v240
    v_mul_f32 v241, s38, v241
    v_mul_f32 v242, s38, v242
    v_mul_f32 v243, s38, v243
    v_mul_f32 v244, s38, v244
    v_mul_f32 v245, s38, v245
    v_mul_f32 v246, s38, v246
    v_mul_f32 v247, s38, v247
    v_cvt_pk_bf16_f32 v132, v240, v241
    v_cvt_pk_bf16_f32 v133, v242, v243
    v_cvt_pk_bf16_f32 v134, v244, v245
    v_cvt_pk_bf16_f32 v135, v246, v247
    v_accvgpr_write_b32 a116, v132
    v_accvgpr_write_b32 a117, v133
    s_waitcnt lgkmcnt(3)
    v_mfma_f32_16x16x32_bf16 v[0:3], a[80:83], v[132:135], v[0:3]
    v_accvgpr_write_b32 a118, v134
    v_accvgpr_write_b32 a119, v135
    s_waitcnt lgkmcnt(2)
    v_mfma_f32_16x16x32_bf16 v[64:67], a[84:87], v[132:135], v[64:67]
    s_waitcnt lgkmcnt(1)
    v_mfma_f32_16x16x32_bf16 v[16:19], a[88:91], v[132:135], v[16:19]
    s_waitcnt lgkmcnt(0)
    v_mfma_f32_16x16x32_bf16 v[80:83], a[92:95], v[132:135], v[80:83]
    v_max3_f32 v248, v0, v1, v2
    s_nop 2
    v_max3_f32 v249, v3, v64, v65
    v_max3_f32 v249, v249, v66, v67
    v_max3_f32 v248, v248, v16, v17
    v_max3_f32 v249, v249, v18, v19
    v_max3_f32 v248, v248, v80, v81
    v_max3_f32 v249, v249, v82, v83
    v_max_f32 v248, v248, v249
    v_mov_b32 v249, v248
    s_nop 1
    v_permlane32_swap_b32 v248, v249
    s_nop 0
    v_max_f32 v248, v248, v249
    v_mov_b32 v249, v248
    s_nop 1
    v_permlane16_swap_b32 v248, v249
    s_nop 0
    v_max_f32 v248, v248, v249
    v_sub_f32 v0, v0, v248
    v_sub_f32 v1, v1, v248
    v_sub_f32 v2, v2, v248
    v_sub_f32 v3, v3, v248
    v_sub_f32 v64, v64, v248
    v_sub_f32 v65, v65, v248
    v_sub_f32 v66, v66, v248
    v_sub_f32 v67, v67, v248
    v_sub_f32 v16, v16, v248
    buffer_load_dwordx4 v[168:171], v225, s[16:19], s74 offen offset:128
    v_sub_f32 v17, v17, v248
    v_sub_f32 v18, v18, v248
    v_sub_f32 v19, v19, v248
    v_sub_f32 v80, v80, v248
    v_sub_f32 v81, v81, v248
    v_sub_f32 v82, v82, v248
    v_sub_f32 v83, v83, v248
    v_sub_f32 v96, 0, v248
    v_sub_f32 v97, 0, v248
    v_sub_f32 v98, 0, v248
    v_sub_f32 v99, 0, v248
    v_exp_f32 v0, v0
    v_exp_f32 v1, v1
    v_exp_f32 v2, v2
    v_exp_f32 v3, v3
    v_add_f32 v220, v220, v0
    v_add_f32 v220, v220, v1
    v_cvt_pk_bf16_f32 v0, v0, v1
    v_add_f32 v220, v220, v2
    v_add_f32 v220, v220, v3
    v_cvt_pk_bf16_f32 v1, v2, v3
    v_exp_f32 v64, v64
    v_exp_f32 v65, v65
    v_exp_f32 v66, v66
    v_exp_f32 v67, v67
    v_add_f32 v220, v220, v64
    v_add_f32 v220, v220, v65
    v_cvt_pk_bf16_f32 v2, v64, v65
    v_add_f32 v220, v220, v66
    v_add_f32 v220, v220, v67
    v_cvt_pk_bf16_f32 v3, v66, v67
    v_exp_f32 v16, v16
    v_exp_f32 v17, v17
    v_exp_f32 v18, v18
    v_exp_f32 v19, v19
    v_add_f32 v220, v220, v16
    v_add_f32 v220, v220, v17
    v_cvt_pk_bf16_f32 v16, v16, v17
    v_add_f32 v220, v220, v18
    v_add_f32 v220, v220, v19
    v_cvt_pk_bf16_f32 v17, v18, v19
    v_exp_f32 v80, v80
    v_exp_f32 v81, v81
    v_add_f32 v220, v220, v80
    v_add_f32 v220, v220, v81
    v_cvt_pk_bf16_f32 v18, v80, v81
    s_waitcnt vmcnt(8)
    v_lshlrev_b32 v232, 16, v136
    v_and_b32 v233, s37, v136
    v_lshlrev_b32 v234, 16, v137
    v_and_b32 v235, s37, v137
    v_lshlrev_b32 v236, 16, v138
    v_and_b32 v237, s37, v138
    buffer_load_dwordx4 v[172:175], v225, s[16:19], s74 offen offset:192
    v_lshlrev_b32 v238, 16, v139
    v_and_b32 v239, s37, v139
    v_mul_f32 v232, s38, v232
    v_mul_f32 v233, s38, v233
    v_mul_f32 v234, s38, v234
    v_mul_f32 v235, s38, v235
    v_mul_f32 v236, s38, v236
    v_mul_f32 v237, s38, v237
    v_mul_f32 v238, s38, v238
    v_mul_f32 v239, s38, v239
    v_cvt_pk_bf16_f32 v136, v232, v233
    v_cvt_pk_bf16_f32 v137, v234, v235
    v_cvt_pk_bf16_f32 v138, v236, v237
    v_cvt_pk_bf16_f32 v139, v238, v239
    v_accvgpr_write_b32 a120, v136
    v_accvgpr_write_b32 a121, v137
    v_mfma_f32_16x16x32_bf16 v[4:7], a[0:3], v[136:139], 0
    v_accvgpr_write_b32 a122, v138
    v_accvgpr_write_b32 a123, v139
    v_mfma_f32_16x16x32_bf16 v[68:71], a[4:7], v[136:139], 0
    s_waitcnt vmcnt(8)
    v_lshlrev_b32 v240, 16, v140
    v_and_b32 v241, s37, v140
    v_mfma_f32_16x16x32_bf16 v[20:23], a[8:11], v[136:139], 0
    v_lshlrev_b32 v242, 16, v141
    v_and_b32 v243, s37, v141
    v_mfma_f32_16x16x32_bf16 v[84:87], a[12:15], v[136:139], 0
    v_lshlrev_b32 v244, 16, v142
    v_and_b32 v245, s37, v142
    v_lshlrev_b32 v246, 16, v143
    v_and_b32 v247, s37, v143
    v_mul_f32 v240, s38, v240
    v_mul_f32 v241, s38, v241
    v_mul_f32 v242, s38, v242
    v_mul_f32 v243, s38, v243
    v_mul_f32 v244, s38, v244
    v_mul_f32 v245, s38, v245
    v_mul_f32 v246, s38, v246
    v_mul_f32 v247, s38, v247
    v_cvt_pk_bf16_f32 v140, v240, v241
    v_cvt_pk_bf16_f32 v141, v242, v243
    v_cvt_pk_bf16_f32 v142, v244, v245
    v_cvt_pk_bf16_f32 v143, v246, v247
    v_accvgpr_write_b32 a124, v140
    v_accvgpr_write_b32 a125, v141
    v_mfma_f32_16x16x32_bf16 v[4:7], a[16:19], v[140:143], v[4:7]
    v_accvgpr_write_b32 a126, v142
    v_accvgpr_write_b32 a127, v143
    v_mfma_f32_16x16x32_bf16 v[68:71], a[20:23], v[140:143], v[68:71]
    v_mfma_f32_16x16x32_bf16 v[20:23], a[24:27], v[140:143], v[20:23]
    v_mfma_f32_16x16x32_bf16 v[84:87], a[28:31], v[140:143], v[84:87]
    v_mfma_f32_32x32x16_bf16 v[128:143], v[228:231], v[228:231], 0
    buffer_load_dwordx4 v[176:179], v225, s[16:19], s74 offen offset:256
    s_waitcnt vmcnt(8)
    v_lshlrev_b32 v232, 16, v144
    v_and_b32 v233, s37, v144
    v_lshlrev_b32 v234, 16, v145
    v_and_b32 v235, s37, v145
    v_lshlrev_b32 v236, 16, v146
    v_and_b32 v237, s37, v146
    v_lshlrev_b32 v238, 16, v147
    v_and_b32 v239, s37, v147
    v_mul_f32 v232, s38, v232
    v_mul_f32 v233, s38, v233
    v_mul_f32 v234, s38, v234
    v_mul_f32 v235, s38, v235
    v_mul_f32 v236, s38, v236
    v_mul_f32 v237, s38, v237
    v_mul_f32 v238, s38, v238
    v_mul_f32 v239, s38, v239
    v_cvt_pk_bf16_f32 v144, v232, v233
    v_cvt_pk_bf16_f32 v145, v234, v235
    v_cvt_pk_bf16_f32 v146, v236, v237
    v_cvt_pk_bf16_f32 v147, v238, v239
    v_accvgpr_write_b32 a128, v144
    v_accvgpr_write_b32 a129, v145
    v_mfma_f32_16x16x32_bf16 v[4:7], a[32:35], v[144:147], v[4:7]
    v_accvgpr_write_b32 a130, v146
    v_accvgpr_write_b32 a131, v147
    v_mfma_f32_16x16x32_bf16 v[68:71], a[36:39], v[144:147], v[68:71]
    v_mfma_f32_16x16x32_bf16 v[20:23], a[40:43], v[144:147], v[20:23]
    v_mfma_f32_16x16x32_bf16 v[84:87], a[44:47], v[144:147], v[84:87]
    buffer_load_dwordx4 v[180:183], v225, s[16:19], s74 offen offset:320
    s_waitcnt vmcnt(8)
    v_lshlrev_b32 v240, 16, v148
    v_and_b32 v241, s37, v148
    v_lshlrev_b32 v242, 16, v149
    v_and_b32 v243, s37, v149
    v_lshlrev_b32 v244, 16, v150
    v_and_b32 v245, s37, v150
    v_lshlrev_b32 v246, 16, v151
    v_and_b32 v247, s37, v151
    v_mul_f32 v240, s38, v240
    v_mul_f32 v241, s38, v241
    v_mul_f32 v242, s38, v242
    v_mul_f32 v243, s38, v243
    v_mul_f32 v244, s38, v244
    v_mul_f32 v245, s38, v245
    v_mul_f32 v246, s38, v246
    v_mul_f32 v247, s38, v247
    v_cvt_pk_bf16_f32 v148, v240, v241
    v_cvt_pk_bf16_f32 v149, v242, v243
    v_cvt_pk_bf16_f32 v150, v244, v245
    v_cvt_pk_bf16_f32 v151, v246, v247
    v_accvgpr_write_b32 a132, v148
    v_accvgpr_write_b32 a133, v149
    v_mfma_f32_16x16x32_bf16 v[4:7], a[48:51], v[148:151], v[4:7]
    v_accvgpr_write_b32 a134, v150
    v_accvgpr_write_b32 a135, v151
    v_mfma_f32_16x16x32_bf16 v[68:71], a[52:55], v[148:151], v[68:71]
    v_mfma_f32_16x16x32_bf16 v[20:23], a[56:59], v[148:151], v[20:23]
    v_mfma_f32_16x16x32_bf16 v[84:87], a[60:63], v[148:151], v[84:87]
    buffer_load_dwordx4 v[184:187], v225, s[16:19], s75 offen offset:0
    s_waitcnt vmcnt(8)
    v_lshlrev_b32 v232, 16, v152
    v_and_b32 v233, s37, v152
    v_lshlrev_b32 v234, 16, v153
    v_and_b32 v235, s37, v153
    v_lshlrev_b32 v236, 16, v154
    v_and_b32 v237, s37, v154
    v_lshlrev_b32 v238, 16, v155
    v_and_b32 v239, s37, v155
    v_mul_f32 v232, s38, v232
    v_mul_f32 v233, s38, v233
    v_mul_f32 v234, s38, v234
    v_mul_f32 v235, s38, v235
    v_mul_f32 v236, s38, v236
    v_mul_f32 v237, s38, v237
    v_mul_f32 v238, s38, v238
    v_mul_f32 v239, s38, v239
    v_cvt_pk_bf16_f32 v152, v232, v233
    v_cvt_pk_bf16_f32 v153, v234, v235
    v_cvt_pk_bf16_f32 v154, v236, v237
    v_cvt_pk_bf16_f32 v155, v238, v239
    v_accvgpr_write_b32 a136, v152
    v_accvgpr_write_b32 a137, v153
    v_mfma_f32_16x16x32_bf16 v[4:7], a[64:67], v[152:155], v[4:7]
    v_accvgpr_write_b32 a138, v154
    v_accvgpr_write_b32 a139, v155
    v_mfma_f32_16x16x32_bf16 v[68:71], a[68:71], v[152:155], v[68:71]
    v_mfma_f32_16x16x32_bf16 v[20:23], a[72:75], v[152:155], v[20:23]
    v_mfma_f32_16x16x32_bf16 v[84:87], a[76:79], v[152:155], v[84:87]
    buffer_load_dwordx4 v[188:191], v225, s[16:19], s75 offen offset:64
    s_waitcnt vmcnt(8)
    v_lshlrev_b32 v240, 16, v156
    v_and_b32 v241, s37, v156
    v_lshlrev_b32 v242, 16, v157
    v_and_b32 v243, s37, v157
    v_lshlrev_b32 v244, 16, v158
    v_and_b32 v245, s37, v158
    v_lshlrev_b32 v246, 16, v159
    v_and_b32 v247, s37, v159
    v_mul_f32 v240, s38, v240
    v_mul_f32 v241, s38, v241
    v_mul_f32 v242, s38, v242
    v_mul_f32 v243, s38, v243
    v_mul_f32 v244, s38, v244
    v_mul_f32 v245, s38, v245
    v_mul_f32 v246, s38, v246
    v_mul_f32 v247, s38, v247
    v_cvt_pk_bf16_f32 v156, v240, v241
    v_cvt_pk_bf16_f32 v157, v242, v243
    v_cvt_pk_bf16_f32 v158, v244, v245
    v_cvt_pk_bf16_f32 v159, v246, v247
    v_accvgpr_write_b32 a140, v156
    v_accvgpr_write_b32 a141, v157
    v_mfma_f32_16x16x32_bf16 v[4:7], a[80:83], v[156:159], v[4:7]
    v_accvgpr_write_b32 a142, v158
    v_accvgpr_write_b32 a143, v159
    v_mfma_f32_16x16x32_bf16 v[68:71], a[84:87], v[156:159], v[68:71]
    v_mfma_f32_16x16x32_bf16 v[20:23], a[88:91], v[156:159], v[20:23]
    v_mfma_f32_16x16x32_bf16 v[84:87], a[92:95], v[156:159], v[84:87]
    v_mfma_f32_32x32x16_bf16 v[144:159], v[228:231], v[228:231], 0
    s_nop 1
    v_max3_f32 v248, v4, v5, v6
    s_nop 1
    v_max3_f32 v249, v7, v68, v69
    v_max3_f32 v249, v249, v70, v71
    v_max3_f32 v248, v248, v20, v21
    v_max3_f32 v249, v249, v22, v23
    v_max3_f32 v248, v248, v84, v85
    v_max3_f32 v249, v249, v86, v87
    v_max_f32 v248, v248, v249
    v_mov_b32 v249, v248
    s_nop 1
    v_permlane32_swap_b32 v248, v249
    s_nop 0
    v_max_f32 v248, v248, v249
    v_mov_b32 v249, v248
    s_nop 1
    v_permlane16_swap_b32 v248, v249
    s_nop 0
    v_max_f32 v248, v248, v249
    v_sub_f32 v4, v4, v248
    v_sub_f32 v5, v5, v248
    v_sub_f32 v6, v6, v248
    v_sub_f32 v7, v7, v248
    v_sub_f32 v68, v68, v248
    v_sub_f32 v69, v69, v248
    v_sub_f32 v70, v70, v248
    buffer_load_dwordx4 v[192:195], v225, s[16:19], s75 offen offset:128
    v_sub_f32 v71, v71, v248
    v_sub_f32 v20, v20, v248
    v_sub_f32 v21, v21, v248
    v_sub_f32 v22, v22, v248
    v_sub_f32 v23, v23, v248
    v_sub_f32 v84, v84, v248
    v_sub_f32 v85, v85, v248
    v_sub_f32 v86, v86, v248
    v_sub_f32 v87, v87, v248
    v_sub_f32 v100, 0, v248
    v_sub_f32 v101, 0, v248
    v_sub_f32 v102, 0, v248
    v_sub_f32 v103, 0, v248
    v_exp_f32 v4, v4
    v_exp_f32 v5, v5
    v_exp_f32 v6, v6
    v_exp_f32 v7, v7
    v_add_f32 v221, v221, v4
    v_add_f32 v221, v221, v5
    v_cvt_pk_bf16_f32 v4, v4, v5
    v_add_f32 v221, v221, v6
    v_add_f32 v221, v221, v7
    v_cvt_pk_bf16_f32 v5, v6, v7
    v_exp_f32 v68, v68
    v_exp_f32 v69, v69
    v_exp_f32 v70, v70
    v_exp_f32 v71, v71
    v_add_f32 v221, v221, v68
    v_add_f32 v221, v221, v69
    v_cvt_pk_bf16_f32 v6, v68, v69
    v_add_f32 v221, v221, v70
    v_add_f32 v221, v221, v71
    v_cvt_pk_bf16_f32 v7, v70, v71
    v_exp_f32 v20, v20
    v_exp_f32 v21, v21
    v_exp_f32 v22, v22
    v_exp_f32 v23, v23
    v_add_f32 v221, v221, v20
    v_add_f32 v221, v221, v21
    v_cvt_pk_bf16_f32 v20, v20, v21
    v_add_f32 v221, v221, v22
    v_add_f32 v221, v221, v23
    v_cvt_pk_bf16_f32 v21, v22, v23
    v_exp_f32 v84, v84
    v_exp_f32 v85, v85
    v_exp_f32 v86, v86
    v_exp_f32 v87, v87
    v_add_f32 v221, v221, v84
    v_add_f32 v221, v221, v85
    v_cvt_pk_bf16_f32 v22, v84, v85
    buffer_load_dwordx4 v[196:199], v225, s[16:19], s75 offen offset:192
    v_add_f32 v221, v221, v86
    v_add_f32 v221, v221, v87
    v_cvt_pk_bf16_f32 v23, v86, v87
    s_waitcnt vmcnt(9)
    v_lshlrev_b32 v232, 16, v160
    v_and_b32 v233, s37, v160
    v_lshlrev_b32 v234, 16, v161
    v_and_b32 v235, s37, v161
    v_lshlrev_b32 v236, 16, v162
    v_and_b32 v237, s37, v162
    v_lshlrev_b32 v238, 16, v163
    v_and_b32 v239, s37, v163
    v_mul_f32 v232, s38, v232
    v_mul_f32 v233, s38, v233
    v_mul_f32 v234, s38, v234
    v_mul_f32 v235, s38, v235
    v_mul_f32 v236, s38, v236
    v_mul_f32 v237, s38, v237
    v_mul_f32 v238, s38, v238
    v_mul_f32 v239, s38, v239
    v_cvt_pk_bf16_f32 v160, v232, v233
    v_cvt_pk_bf16_f32 v161, v234, v235
    v_cvt_pk_bf16_f32 v162, v236, v237
    v_cvt_pk_bf16_f32 v163, v238, v239
    v_accvgpr_write_b32 a144, v160
    v_accvgpr_write_b32 a145, v161
    v_mfma_f32_16x16x32_bf16 v[8:11], a[0:3], v[160:163], 0
    v_accvgpr_write_b32 a146, v162
    v_accvgpr_write_b32 a147, v163
    v_mfma_f32_16x16x32_bf16 v[72:75], a[4:7], v[160:163], 0
    s_waitcnt vmcnt(8)
    v_lshlrev_b32 v240, 16, v164
    v_and_b32 v241, s37, v164
    v_mfma_f32_16x16x32_bf16 v[24:27], a[8:11], v[160:163], 0
    v_lshlrev_b32 v242, 16, v165
    v_and_b32 v243, s37, v165
    v_mfma_f32_16x16x32_bf16 v[88:91], a[12:15], v[160:163], 0
    v_lshlrev_b32 v244, 16, v166
    v_and_b32 v245, s37, v166
    v_lshlrev_b32 v246, 16, v167
    v_and_b32 v247, s37, v167
    v_mul_f32 v240, s38, v240
    v_mul_f32 v241, s38, v241
    v_mul_f32 v242, s38, v242
    v_mul_f32 v243, s38, v243
    v_mul_f32 v244, s38, v244
    v_mul_f32 v245, s38, v245
    v_mul_f32 v246, s38, v246
    v_mul_f32 v247, s38, v247
    v_cvt_pk_bf16_f32 v164, v240, v241
    v_cvt_pk_bf16_f32 v165, v242, v243
    v_cvt_pk_bf16_f32 v166, v244, v245
    v_cvt_pk_bf16_f32 v167, v246, v247
    v_accvgpr_write_b32 a148, v164
    v_accvgpr_write_b32 a149, v165
    v_mfma_f32_16x16x32_bf16 v[8:11], a[16:19], v[164:167], v[8:11]
    v_accvgpr_write_b32 a150, v166
    v_accvgpr_write_b32 a151, v167
    v_mfma_f32_16x16x32_bf16 v[72:75], a[20:23], v[164:167], v[72:75]
    buffer_load_dwordx4 v[200:203], v225, s[16:19], s75 offen offset:256
    v_mfma_f32_16x16x32_bf16 v[24:27], a[24:27], v[164:167], v[24:27]
    s_waitcnt vmcnt(8)
    v_lshlrev_b32 v232, 16, v168
    v_and_b32 v233, s37, v168
    v_mfma_f32_16x16x32_bf16 v[88:91], a[28:31], v[164:167], v[88:91]
    v_lshlrev_b32 v234, 16, v169
    v_and_b32 v235, s37, v169
    v_lshlrev_b32 v236, 16, v170
    v_and_b32 v237, s37, v170
    v_lshlrev_b32 v238, 16, v171
    v_and_b32 v239, s37, v171
    v_mul_f32 v232, s38, v232
    v_mul_f32 v233, s38, v233
    v_mul_f32 v234, s38, v234
    v_mul_f32 v235, s38, v235
    v_mul_f32 v236, s38, v236
    v_mul_f32 v237, s38, v237
    v_mul_f32 v238, s38, v238
    v_mul_f32 v239, s38, v239
    v_cvt_pk_bf16_f32 v168, v232, v233
    v_cvt_pk_bf16_f32 v169, v234, v235
    v_cvt_pk_bf16_f32 v170, v236, v237
    v_cvt_pk_bf16_f32 v171, v238, v239
    v_accvgpr_write_b32 a152, v168
    v_accvgpr_write_b32 a153, v169
    v_mfma_f32_16x16x32_bf16 v[8:11], a[32:35], v[168:171], v[8:11]
    v_accvgpr_write_b32 a154, v170
    v_accvgpr_write_b32 a155, v171
    v_mfma_f32_16x16x32_bf16 v[72:75], a[36:39], v[168:171], v[72:75]
    v_mfma_f32_16x16x32_bf16 v[24:27], a[40:43], v[168:171], v[24:27]
    v_mfma_f32_16x16x32_bf16 v[88:91], a[44:47], v[168:171], v[88:91]
    buffer_load_dwordx4 v[204:207], v225, s[16:19], s75 offen offset:320
    s_waitcnt vmcnt(8)
    v_lshlrev_b32 v240, 16, v172
    v_and_b32 v241, s37, v172
    v_lshlrev_b32 v242, 16, v173
    v_and_b32 v243, s37, v173
    v_lshlrev_b32 v244, 16, v174
    v_and_b32 v245, s37, v174
    v_lshlrev_b32 v246, 16, v175
    v_and_b32 v247, s37, v175
    v_mul_f32 v240, s38, v240
    v_mul_f32 v241, s38, v241
    v_mul_f32 v242, s38, v242
    v_mul_f32 v243, s38, v243
    v_mul_f32 v244, s38, v244
    v_mul_f32 v245, s38, v245
    v_mul_f32 v246, s38, v246
    v_mul_f32 v247, s38, v247
    v_cvt_pk_bf16_f32 v172, v240, v241
    v_cvt_pk_bf16_f32 v173, v242, v243
    v_cvt_pk_bf16_f32 v174, v244, v245
    v_cvt_pk_bf16_f32 v175, v246, v247
    v_accvgpr_write_b32 a156, v172
    v_accvgpr_write_b32 a157, v173
    v_mfma_f32_16x16x32_bf16 v[8:11], a[48:51], v[172:175], v[8:11]
    v_accvgpr_write_b32 a158, v174
    v_accvgpr_write_b32 a159, v175
    v_mfma_f32_16x16x32_bf16 v[72:75], a[52:55], v[172:175], v[72:75]
    v_mfma_f32_16x16x32_bf16 v[24:27], a[56:59], v[172:175], v[24:27]
    v_mfma_f32_16x16x32_bf16 v[88:91], a[60:63], v[172:175], v[88:91]
    v_mfma_f32_32x32x16_bf16 v[160:175], v[228:231], v[228:231], 0
    buffer_load_dwordx4 v214, s[20:23], s33 offen offset:0  lds
    s_waitcnt vmcnt(8)
    v_lshlrev_b32 v232, 16, v176
    v_and_b32 v233, s37, v176
    v_lshlrev_b32 v234, 16, v177
    v_and_b32 v235, s37, v177
    v_lshlrev_b32 v236, 16, v178
    v_and_b32 v237, s37, v178
    v_lshlrev_b32 v238, 16, v179
    v_and_b32 v239, s37, v179
    v_mul_f32 v232, s38, v232
    v_mul_f32 v233, s38, v233
    v_mul_f32 v234, s38, v234
    v_mul_f32 v235, s38, v235
    v_mul_f32 v236, s38, v236
    v_mul_f32 v237, s38, v237
    v_mul_f32 v238, s38, v238
    v_mul_f32 v239, s38, v239
    v_cvt_pk_bf16_f32 v176, v232, v233
    v_cvt_pk_bf16_f32 v177, v234, v235
    v_cvt_pk_bf16_f32 v178, v236, v237
    v_cvt_pk_bf16_f32 v179, v238, v239
    v_accvgpr_write_b32 a160, v176
    v_accvgpr_write_b32 a161, v177
    v_mfma_f32_16x16x32_bf16 v[8:11], a[64:67], v[176:179], v[8:11]
    v_accvgpr_write_b32 a162, v178
    v_accvgpr_write_b32 a163, v179
    v_mfma_f32_16x16x32_bf16 v[72:75], a[68:71], v[176:179], v[72:75]
    v_mfma_f32_16x16x32_bf16 v[24:27], a[72:75], v[176:179], v[24:27]
    v_mfma_f32_16x16x32_bf16 v[88:91], a[76:79], v[176:179], v[88:91]
    buffer_load_dwordx4 v215, s[20:23], s33 offen offset:1024  lds
    s_waitcnt vmcnt(8)
    v_lshlrev_b32 v240, 16, v180
    v_and_b32 v241, s37, v180
    v_lshlrev_b32 v242, 16, v181
    v_and_b32 v243, s37, v181
    v_lshlrev_b32 v244, 16, v182
    v_and_b32 v245, s37, v182
    v_lshlrev_b32 v246, 16, v183
    v_and_b32 v247, s37, v183
    v_mul_f32 v240, s38, v240
    v_mul_f32 v241, s38, v241
    v_mul_f32 v242, s38, v242
    v_mul_f32 v243, s38, v243
    v_mul_f32 v244, s38, v244
    v_mul_f32 v245, s38, v245
    v_mul_f32 v246, s38, v246
    v_mul_f32 v247, s38, v247
    v_cvt_pk_bf16_f32 v180, v240, v241
    v_cvt_pk_bf16_f32 v181, v242, v243
    v_cvt_pk_bf16_f32 v182, v244, v245
    v_cvt_pk_bf16_f32 v183, v246, v247
    v_accvgpr_write_b32 a164, v180
    v_accvgpr_write_b32 a165, v181
    v_mfma_f32_16x16x32_bf16 v[8:11], a[80:83], v[180:183], v[8:11]
    v_accvgpr_write_b32 a166, v182
    v_accvgpr_write_b32 a167, v183
    v_mfma_f32_16x16x32_bf16 v[72:75], a[84:87], v[180:183], v[72:75]
    v_mfma_f32_16x16x32_bf16 v[24:27], a[88:91], v[180:183], v[24:27]
    v_mfma_f32_16x16x32_bf16 v[88:91], a[92:95], v[180:183], v[88:91]
    s_nop 2
    v_max3_f32 v248, v8, v9, v10
    s_nop 1
    v_max3_f32 v249, v11, v72, v73
    v_max3_f32 v249, v249, v74, v75
    v_max3_f32 v248, v248, v24, v25
    v_max3_f32 v249, v249, v26, v27
    v_max3_f32 v248, v248, v88, v89
    v_max3_f32 v249, v249, v90, v91
    v_max_f32 v248, v248, v249
    v_mov_b32 v249, v248
    s_nop 1
    v_permlane32_swap_b32 v248, v249
    s_nop 0
    v_max_f32 v248, v248, v249
    v_mov_b32 v249, v248
    s_nop 1
    v_permlane16_swap_b32 v248, v249
    s_nop 0
    v_max_f32 v248, v248, v249
    v_sub_f32 v8, v8, v248
    v_sub_f32 v9, v9, v248
    v_sub_f32 v10, v10, v248
    v_sub_f32 v11, v11, v248
    v_sub_f32 v72, v72, v248
    v_sub_f32 v73, v73, v248
    v_sub_f32 v74, v74, v248
    v_sub_f32 v75, v75, v248
    v_sub_f32 v24, v24, v248
    buffer_load_dwordx4 v216, s[20:23], s33 offen offset:2048  lds
    s_add_u32 s33, s33, 12288
    s_add_u32 m0, s32, 36864
    v_sub_f32 v25, v25, v248
    v_sub_f32 v26, v26, v248
    v_sub_f32 v27, v27, v248
    v_sub_f32 v88, v88, v248
    v_sub_f32 v89, v89, v248
    v_sub_f32 v90, v90, v248
    v_sub_f32 v91, v91, v248
    v_sub_f32 v104, 0, v248
    v_sub_f32 v105, 0, v248
    v_sub_f32 v106, 0, v248
    v_sub_f32 v107, 0, v248
    v_exp_f32 v8, v8
    v_exp_f32 v9, v9
    v_exp_f32 v10, v10
    v_exp_f32 v11, v11
    v_add_f32 v222, v222, v8
    v_add_f32 v222, v222, v9
    v_cvt_pk_bf16_f32 v8, v8, v9
    v_add_f32 v222, v222, v10
    v_add_f32 v222, v222, v11
    v_cvt_pk_bf16_f32 v9, v10, v11
    v_exp_f32 v72, v72
    v_exp_f32 v73, v73
    v_exp_f32 v74, v74
    v_exp_f32 v75, v75
    v_add_f32 v222, v222, v72
    v_add_f32 v222, v222, v73
    v_cvt_pk_bf16_f32 v10, v72, v73
    v_add_f32 v222, v222, v74
    v_add_f32 v222, v222, v75
    v_cvt_pk_bf16_f32 v11, v74, v75
    v_exp_f32 v24, v24
    v_exp_f32 v25, v25
    v_exp_f32 v26, v26
    v_exp_f32 v27, v27
    v_add_f32 v222, v222, v24
    v_add_f32 v222, v222, v25
    v_cvt_pk_bf16_f32 v24, v24, v25
    v_add_f32 v222, v222, v26
    v_add_f32 v222, v222, v27
    v_cvt_pk_bf16_f32 v25, v26, v27
    v_exp_f32 v88, v88
    v_exp_f32 v89, v89
    v_exp_f32 v90, v90
    v_exp_f32 v91, v91
    v_add_f32 v222, v222, v88
    v_add_f32 v222, v222, v89
    v_cvt_pk_bf16_f32 v26, v88, v89
    buffer_load_dwordx4 v214, s[20:23], s33 offen offset:0  lds
    v_add_f32 v222, v222, v90
    v_add_f32 v222, v222, v91
    v_cvt_pk_bf16_f32 v27, v90, v91
    s_waitcnt vmcnt(9)
    v_lshlrev_b32 v232, 16, v184
    v_and_b32 v233, s37, v184
    v_lshlrev_b32 v234, 16, v185
    v_and_b32 v235, s37, v185
    v_lshlrev_b32 v236, 16, v186
    v_and_b32 v237, s37, v186
    v_lshlrev_b32 v238, 16, v187
    v_and_b32 v239, s37, v187
    v_mul_f32 v232, s38, v232
    v_mul_f32 v233, s38, v233
    v_mul_f32 v234, s38, v234
    v_mul_f32 v235, s38, v235
    v_mul_f32 v236, s38, v236
    v_mul_f32 v237, s38, v237
    v_mul_f32 v238, s38, v238
    v_mul_f32 v239, s38, v239
    v_cvt_pk_bf16_f32 v184, v232, v233
    v_cvt_pk_bf16_f32 v185, v234, v235
    v_cvt_pk_bf16_f32 v186, v236, v237
    v_cvt_pk_bf16_f32 v187, v238, v239
    v_accvgpr_write_b32 a168, v184
    v_accvgpr_write_b32 a169, v185
    v_mfma_f32_16x16x32_bf16 v[12:15], a[0:3], v[184:187], 0
    v_accvgpr_write_b32 a170, v186
    v_accvgpr_write_b32 a171, v187
    v_mfma_f32_16x16x32_bf16 v[76:79], a[4:7], v[184:187], 0
    s_waitcnt vmcnt(8)
    v_lshlrev_b32 v240, 16, v188
    v_and_b32 v241, s37, v188
    v_mfma_f32_16x16x32_bf16 v[28:31], a[8:11], v[184:187], 0
    v_lshlrev_b32 v242, 16, v189
    v_and_b32 v243, s37, v189
    v_mfma_f32_16x16x32_bf16 v[92:95], a[12:15], v[184:187], 0
    v_lshlrev_b32 v244, 16, v190
    v_and_b32 v245, s37, v190
    v_mfma_f32_32x32x16_bf16 a[0:15], v[228:231], v[228:231], 0
    v_lshlrev_b32 v246, 16, v191
    v_and_b32 v247, s37, v191
    v_mul_f32 v240, s38, v240
    v_mul_f32 v241, s38, v241
    v_mul_f32 v242, s38, v242
    v_mul_f32 v243, s38, v243
    v_mul_f32 v244, s38, v244
    v_mul_f32 v245, s38, v245
    v_mul_f32 v246, s38, v246
    v_mul_f32 v247, s38, v247
    v_cvt_pk_bf16_f32 v188, v240, v241
    v_cvt_pk_bf16_f32 v189, v242, v243
    v_cvt_pk_bf16_f32 v190, v244, v245
    v_cvt_pk_bf16_f32 v191, v246, v247
    v_accvgpr_write_b32 a172, v188
    v_accvgpr_write_b32 a173, v189
    v_mfma_f32_16x16x32_bf16 v[12:15], a[16:19], v[188:191], v[12:15]
    v_accvgpr_write_b32 a174, v190
    v_accvgpr_write_b32 a175, v191
    v_mfma_f32_16x16x32_bf16 v[76:79], a[20:23], v[188:191], v[76:79]
    buffer_load_dwordx4 v215, s[20:23], s33 offen offset:1024  lds
    v_mfma_f32_16x16x32_bf16 v[28:31], a[24:27], v[188:191], v[28:31]
    s_waitcnt vmcnt(8)
    v_lshlrev_b32 v232, 16, v192
    v_and_b32 v233, s37, v192
    v_mfma_f32_16x16x32_bf16 v[92:95], a[28:31], v[188:191], v[92:95]
    v_lshlrev_b32 v234, 16, v193
    v_and_b32 v235, s37, v193
    v_mfma_f32_32x32x16_bf16 v[176:191], v[228:231], v[228:231], 0
    v_lshlrev_b32 v236, 16, v194
    v_and_b32 v237, s37, v194
    v_lshlrev_b32 v238, 16, v195
    v_and_b32 v239, s37, v195
    v_mul_f32 v232, s38, v232
    v_mul_f32 v233, s38, v233
    v_mfma_f32_32x32x16_bf16 a[16:31], v[228:231], v[228:231], 0
    v_mul_f32 v234, s38, v234
    v_mul_f32 v235, s38, v235
    v_mul_f32 v236, s38, v236
    v_mul_f32 v237, s38, v237
    v_mul_f32 v238, s38, v238
    v_mul_f32 v239, s38, v239
    v_cvt_pk_bf16_f32 v192, v232, v233
    v_cvt_pk_bf16_f32 v193, v234, v235
    v_cvt_pk_bf16_f32 v194, v236, v237
    v_cvt_pk_bf16_f32 v195, v238, v239
    v_accvgpr_write_b32 a176, v192
    v_accvgpr_write_b32 a177, v193
    v_mfma_f32_16x16x32_bf16 v[12:15], a[32:35], v[192:195], v[12:15]
    v_accvgpr_write_b32 a178, v194
    v_accvgpr_write_b32 a179, v195
    v_mfma_f32_16x16x32_bf16 v[76:79], a[36:39], v[192:195], v[76:79]
    v_mfma_f32_16x16x32_bf16 v[28:31], a[40:43], v[192:195], v[28:31]
    v_mfma_f32_16x16x32_bf16 v[92:95], a[44:47], v[192:195], v[92:95]
    v_mfma_f32_32x32x16_bf16 a[32:47], v[228:231], v[228:231], 0
    buffer_load_dwordx4 v216, s[20:23], s33 offen offset:2048  lds
    s_add_u32 s33, s33, 12288
    s_add_u32 m0, s32, 0
    s_waitcnt vmcnt(8)
    v_lshlrev_b32 v240, 16, v196
    v_and_b32 v241, s37, v196
    v_lshlrev_b32 v242, 16, v197
    v_and_b32 v243, s37, v197
    v_lshlrev_b32 v244, 16, v198
    v_and_b32 v245, s37, v198
    v_lshlrev_b32 v246, 16, v199
    v_and_b32 v247, s37, v199
    v_mul_f32 v240, s38, v240
    v_mul_f32 v241, s38, v241
    v_mul_f32 v242, s38, v242
    v_mul_f32 v243, s38, v243
    v_mul_f32 v244, s38, v244
    v_mul_f32 v245, s38, v245
    v_mul_f32 v246, s38, v246
    v_mul_f32 v247, s38, v247
    v_cvt_pk_bf16_f32 v196, v240, v241
    v_cvt_pk_bf16_f32 v197, v242, v243
    v_cvt_pk_bf16_f32 v198, v244, v245
    v_cvt_pk_bf16_f32 v199, v246, v247
    v_accvgpr_write_b32 a180, v196
    v_accvgpr_write_b32 a181, v197
    v_mfma_f32_16x16x32_bf16 v[12:15], a[48:51], v[196:199], v[12:15]
    v_accvgpr_write_b32 a182, v198
    v_accvgpr_write_b32 a183, v199
    v_mfma_f32_16x16x32_bf16 v[76:79], a[52:55], v[196:199], v[76:79]
    v_mfma_f32_16x16x32_bf16 v[28:31], a[56:59], v[196:199], v[28:31]
    v_mfma_f32_16x16x32_bf16 v[92:95], a[60:63], v[196:199], v[92:95]
    v_mfma_f32_32x32x16_bf16 a[48:63], v[228:231], v[228:231], 0
    s_waitcnt vmcnt(7)
    v_lshlrev_b32 v232, 16, v200
    v_and_b32 v233, s37, v200
    v_lshlrev_b32 v234, 16, v201
    v_and_b32 v235, s37, v201
    v_lshlrev_b32 v236, 16, v202
    v_and_b32 v237, s37, v202
    v_lshlrev_b32 v238, 16, v203
    v_and_b32 v239, s37, v203
    v_mul_f32 v232, s38, v232
    v_mul_f32 v233, s38, v233
    v_mul_f32 v234, s38, v234
    v_mul_f32 v235, s38, v235
    v_mul_f32 v236, s38, v236
    v_mul_f32 v237, s38, v237
    v_mul_f32 v238, s38, v238
    v_mul_f32 v239, s38, v239
    v_cvt_pk_bf16_f32 v200, v232, v233
    v_cvt_pk_bf16_f32 v201, v234, v235
    v_cvt_pk_bf16_f32 v202, v236, v237
    v_cvt_pk_bf16_f32 v203, v238, v239
    v_accvgpr_write_b32 a184, v200
    v_accvgpr_write_b32 a185, v201
    v_mfma_f32_16x16x32_bf16 v[12:15], a[64:67], v[200:203], v[12:15]
    v_accvgpr_write_b32 a186, v202
    v_accvgpr_write_b32 a187, v203
    v_mfma_f32_16x16x32_bf16 v[76:79], a[68:71], v[200:203], v[76:79]
    v_mfma_f32_16x16x32_bf16 v[28:31], a[72:75], v[200:203], v[28:31]
    v_mfma_f32_16x16x32_bf16 v[92:95], a[76:79], v[200:203], v[92:95]
    v_mfma_f32_32x32x16_bf16 a[64:79], v[228:231], v[228:231], 0
    s_waitcnt vmcnt(6)
    v_lshlrev_b32 v240, 16, v204
    v_and_b32 v241, s37, v204
    v_lshlrev_b32 v242, 16, v205
    v_and_b32 v243, s37, v205
    v_lshlrev_b32 v244, 16, v206
    v_and_b32 v245, s37, v206
    v_lshlrev_b32 v246, 16, v207
    v_and_b32 v247, s37, v207
    v_mul_f32 v240, s38, v240
    v_mul_f32 v241, s38, v241
    v_mul_f32 v242, s38, v242
    v_mul_f32 v243, s38, v243
    v_mul_f32 v244, s38, v244
    v_mul_f32 v245, s38, v245
    v_mul_f32 v246, s38, v246
    v_mul_f32 v247, s38, v247
    v_cvt_pk_bf16_f32 v204, v240, v241
    v_cvt_pk_bf16_f32 v205, v242, v243
    v_cvt_pk_bf16_f32 v206, v244, v245
    v_cvt_pk_bf16_f32 v207, v246, v247
    v_accvgpr_write_b32 a188, v204
    v_accvgpr_write_b32 a189, v205
    v_mfma_f32_16x16x32_bf16 v[12:15], a[80:83], v[204:207], v[12:15]
    v_accvgpr_write_b32 a190, v206
    v_accvgpr_write_b32 a191, v207
    v_mfma_f32_16x16x32_bf16 v[76:79], a[84:87], v[204:207], v[76:79]
    v_mfma_f32_16x16x32_bf16 v[28:31], a[88:91], v[204:207], v[28:31]
    v_mfma_f32_16x16x32_bf16 v[92:95], a[92:95], v[204:207], v[92:95]
    v_mfma_f32_32x32x16_bf16 a[80:95], v[228:231], v[228:231], 0
    s_nop 1
    v_max3_f32 v248, v12, v13, v14
    s_nop 1
    v_max3_f32 v249, v15, v76, v77
    v_max3_f32 v249, v249, v78, v79
    v_max3_f32 v248, v248, v28, v29
    v_max3_f32 v249, v249, v30, v31
    v_max3_f32 v248, v248, v92, v93
    v_max3_f32 v249, v249, v94, v95
    v_max_f32 v248, v248, v249
    v_mov_b32 v249, v248
    s_nop 1
    v_permlane32_swap_b32 v248, v249
    s_nop 0
    v_max_f32 v248, v248, v249
    v_mov_b32 v249, v248
    s_nop 1
    v_permlane16_swap_b32 v248, v249
    s_nop 0
    v_max_f32 v248, v248, v249
    v_sub_f32 v12, v12, v248
    v_sub_f32 v13, v13, v248
    v_sub_f32 v14, v14, v248
    v_sub_f32 v15, v15, v248
    v_sub_f32 v76, v76, v248
    v_sub_f32 v77, v77, v248
    v_sub_f32 v78, v78, v248
    v_sub_f32 v79, v79, v248
    v_sub_f32 v28, v28, v248
    v_sub_f32 v29, v29, v248
    v_sub_f32 v30, v30, v248
    v_sub_f32 v31, v31, v248
    v_sub_f32 v92, v92, v248
    v_sub_f32 v93, v93, v248
    v_sub_f32 v94, v94, v248
    v_sub_f32 v95, v95, v248
    v_sub_f32 v108, 0, v248
    v_sub_f32 v109, 0, v248
    v_sub_f32 v110, 0, v248
    v_sub_f32 v111, 0, v248
    v_exp_f32 v12, v12
    v_exp_f32 v13, v13
    v_exp_f32 v14, v14
    v_exp_f32 v15, v15
    v_add_f32 v223, v223, v12
    v_add_f32 v223, v223, v13
    v_cvt_pk_bf16_f32 v12, v12, v13
    v_add_f32 v223, v223, v14
    v_add_f32 v223, v223, v15
    v_cvt_pk_bf16_f32 v13, v14, v15
    v_exp_f32 v76, v76
    v_exp_f32 v77, v77
    v_exp_f32 v78, v78
    v_exp_f32 v79, v79
    v_add_f32 v223, v223, v76
    v_add_f32 v223, v223, v77
    v_cvt_pk_bf16_f32 v14, v76, v77
    v_add_f32 v223, v223, v78
    v_add_f32 v223, v223, v79
    v_cvt_pk_bf16_f32 v15, v78, v79
    v_exp_f32 v28, v28
    v_exp_f32 v29, v29
    v_exp_f32 v30, v30
    v_exp_f32 v31, v31
    v_add_f32 v223, v223, v28
    v_add_f32 v223, v223, v29
    v_cvt_pk_bf16_f32 v28, v28, v29
    v_add_f32 v223, v223, v30
    v_add_f32 v223, v223, v31
    v_cvt_pk_bf16_f32 v29, v30, v31
    v_exp_f32 v92, v92
    v_exp_f32 v93, v93
    v_exp_f32 v94, v94
    v_exp_f32 v95, v95
    v_add_f32 v223, v223, v92
    v_add_f32 v223, v223, v93
    v_cvt_pk_bf16_f32 v30, v92, v93
    v_add_f32 v223, v223, v94
    v_add_f32 v223, v223, v95
    v_cvt_pk_bf16_f32 v31, v94, v95
    s_waitcnt vmcnt(0)
    s_barrier
    ds_read_b128 a[192:195], v208 offset:24576
    ds_read_b128 a[196:199], v209 offset:24576
    ds_read_b128 a[200:203], v208 offset:24704
    ds_read_b128 a[204:207], v209 offset:24704
    ds_read_b128 a[208:211], v208 offset:24832
    ds_read_b128 a[212:215], v209 offset:24832
    buffer_load_dwordx4 v214, s[20:23], s33 offen offset:0  lds
    buffer_load_dwordx4 v215, s[20:23], s33 offen offset:1024  lds
    buffer_load_dwordx4 v216, s[20:23], s33 offen offset:2048  lds
    s_add_u32 s33, s33, 12288
    s_add_u32 m0, s32, 12288
    s_nop 0
    buffer_load_dwordx4 v214, s[20:23], s33 offen offset:0  lds
    buffer_load_dwordx4 v215, s[20:23], s33 offen offset:1024  lds
    buffer_load_dwordx4 v216, s[20:23], s33 offen offset:2048  lds
    s_add_u32 s33, s33, 12288
    s_waitcnt lgkmcnt(0)
    s_branch L_loop
L_patch:
    s_mov_b32 s20, s24
    s_mov_b32 s21, s25
    s_mov_b32 s33, 737280
    v_mov_b32 v214, v217
    v_mov_b32 v215, v218
    v_mov_b32 v216, v219
    s_branch L_mid
.p2align 6
L_loop:
    v_mfma_f32_16x16x32_bf16 v[32:35], a[192:195], a[96:99], v[96:99]
    v_exp_f32 v82, v82
    v_mfma_f32_16x16x32_bf16 v[32:35], a[196:199], a[100:103], v[32:35]
    ds_read_b128 a[216:219], v208 offset:30720
    ds_read_b128 a[220:223], v209 offset:30720
    v_mfma_f32_16x16x32_bf16 v[32:35], a[200:203], a[104:107], v[32:35]
    v_add_f32 v220, v220, v82
    v_mfma_f32_16x16x32_bf16 v[32:35], a[204:207], a[108:111], v[32:35]
    s_add_u32 m0, s32, 49152
    v_mfma_f32_16x16x32_bf16 v[32:35], a[208:211], a[112:115], v[32:35]
    buffer_load_dwordx4 v217, s[24:27], s34 offen offset:0  lds
    v_mfma_f32_16x16x32_bf16 v[32:35], a[212:215], a[116:119], v[32:35]
    v_exp_f32 v83, v83
    v_mfma_f32_16x16x32_bf16 v[36:39], a[212:215], a[140:143], v[100:103]
    v_add_f32 v220, v220, v83
    v_cvt_pk_bf16_f32 v19, v82, v83
    v_mfma_f32_16x16x32_bf16 v[36:39], a[208:211], a[136:139], v[36:39]
    ds_read_b128 a[224:227], v208 offset:30848
    ds_read_b128 a[228:231], v209 offset:30848
    v_mfma_f32_16x16x32_bf16 v[36:39], a[204:207], a[132:135], v[36:39]
    v_mfma_f32_16x16x32_bf16 v[36:39], a[200:203], a[128:131], v[36:39]
    v_mfma_f32_16x16x32_bf16 v[36:39], a[196:199], a[124:127], v[36:39]
    buffer_load_dwordx4 v218, s[24:27], s34 offen offset:1024  lds
    v_mfma_f32_16x16x32_bf16 v[36:39], a[192:195], a[120:123], v[36:39]
    v_mfma_f32_16x16x32_bf16 v[40:43], a[192:195], a[144:147], v[104:107]
    v_exp_f32 v32, v32
    v_mfma_f32_16x16x32_bf16 v[40:43], a[196:199], a[148:151], v[40:43]
    ds_read_b128 a[232:235], v208 offset:30976
    ds_read_b128 a[236:239], v209 offset:30976
    v_mfma_f32_16x16x32_bf16 v[40:43], a[200:203], a[152:155], v[40:43]
    v_add_f32 v220, v220, v32
    v_mfma_f32_16x16x32_bf16 v[40:43], a[204:207], a[156:159], v[40:43]
    v_exp_f32 v33, v33
    v_mfma_f32_16x16x32_bf16 v[40:43], a[208:211], a[160:163], v[40:43]
    buffer_load_dwordx4 v219, s[24:27], s34 offen offset:2048  lds
    v_mfma_f32_16x16x32_bf16 v[40:43], a[212:215], a[164:167], v[40:43]
    v_exp_f32 v34, v34
    v_mfma_f32_16x16x32_bf16 v[44:47], a[212:215], a[188:191], v[108:111]
    v_add_f32 v220, v220, v33
    v_cvt_pk_bf16_f32 v32, v32, v33
    v_mfma_f32_16x16x32_bf16 v[44:47], a[208:211], a[184:187], v[44:47]
    v_add_f32 v220, v220, v34
    v_mfma_f32_16x16x32_bf16 v[44:47], a[204:207], a[180:183], v[44:47]
    v_exp_f32 v35, v35
    v_mfma_f32_16x16x32_bf16 v[44:47], a[200:203], a[176:179], v[44:47]
    s_add_u32 s34, s34, 12288
    s_add_u32 m0, s32, 61440
    v_mfma_f32_16x16x32_bf16 v[44:47], a[196:199], a[172:175], v[44:47]
    v_exp_f32 v36, v36
    v_mfma_f32_16x16x32_bf16 v[44:47], a[192:195], a[168:171], v[44:47]
    v_add_f32 v220, v220, v35
    s_waitcnt lgkmcnt(0)
    v_mfma_f32_16x16x32_bf16 v[76:79], a[216:219], a[168:171], v[108:111]
    v_cvt_pk_bf16_f32 v33, v34, v35
    v_add_f32 v221, v221, v36
    v_mfma_f32_16x16x32_bf16 v[76:79], a[220:223], a[172:175], v[76:79]
    ds_read_b128 a[192:195], v208 offset:36864
    ds_read_b128 a[196:199], v209 offset:36864
    v_mfma_f32_16x16x32_bf16 v[76:79], a[224:227], a[176:179], v[76:79]
    v_exp_f32 v37, v37
    v_mfma_f32_16x16x32_bf16 v[76:79], a[228:231], a[180:183], v[76:79]
    v_exp_f32 v38, v38
    v_mfma_f32_16x16x32_bf16 v[76:79], a[232:235], a[184:187], v[76:79]
    buffer_load_dwordx4 v217, s[24:27], s34 offen offset:0  lds
    v_mfma_f32_16x16x32_bf16 v[76:79], a[236:239], a[188:191], v[76:79]
    v_add_f32 v221, v221, v37
    v_cvt_pk_bf16_f32 v36, v36, v37
    v_mfma_f32_16x16x32_bf16 v[72:75], a[236:239], a[164:167], v[104:107]
    v_exp_f32 v39, v39
    v_mfma_f32_16x16x32_bf16 v[72:75], a[232:235], a[160:163], v[72:75]
    ds_read_b128 a[200:203], v208 offset:36992
    ds_read_b128 a[204:207], v209 offset:36992
    v_mfma_f32_16x16x32_bf16 v[72:75], a[228:231], a[156:159], v[72:75]
    v_exp_f32 v40, v40
    v_mfma_f32_16x16x32_bf16 v[72:75], a[224:227], a[152:155], v[72:75]
    v_add_f32 v221, v221, v38
    v_add_f32 v221, v221, v39
    v_mfma_f32_16x16x32_bf16 v[72:75], a[220:223], a[148:151], v[72:75]
    buffer_load_dwordx4 v218, s[24:27], s34 offen offset:1024  lds
    v_mfma_f32_16x16x32_bf16 v[72:75], a[216:219], a[144:147], v[72:75]
    v_exp_f32 v41, v41
    v_mfma_f32_16x16x32_bf16 v[68:71], a[216:219], a[120:123], v[100:103]
    v_cvt_pk_bf16_f32 v37, v38, v39
    v_add_f32 v222, v222, v40
    v_mfma_f32_16x16x32_bf16 v[68:71], a[220:223], a[124:127], v[68:71]
    ds_read_b128 a[208:211], v208 offset:37120
    ds_read_b128 a[212:215], v209 offset:37120
    v_mfma_f32_16x16x32_bf16 v[68:71], a[224:227], a[128:131], v[68:71]
    v_exp_f32 v42, v42
    v_mfma_f32_16x16x32_bf16 v[68:71], a[228:231], a[132:135], v[68:71]
    v_add_f32 v222, v222, v41
    v_cvt_pk_bf16_f32 v40, v40, v41
    v_mfma_f32_16x16x32_bf16 v[68:71], a[232:235], a[136:139], v[68:71]
    buffer_load_dwordx4 v219, s[24:27], s34 offen offset:2048  lds
    v_mfma_f32_16x16x32_bf16 v[68:71], a[236:239], a[140:143], v[68:71]
    v_exp_f32 v43, v43
    v_mfma_f32_16x16x32_bf16 v[64:67], a[236:239], a[116:119], v[96:99]
    v_add_f32 v222, v222, v42
    v_add_f32 v222, v222, v43
    v_mfma_f32_16x16x32_bf16 v[64:67], a[232:235], a[112:115], v[64:67]
    v_exp_f32 v44, v44
    v_mfma_f32_16x16x32_bf16 v[64:67], a[228:231], a[108:111], v[64:67]
    v_cvt_pk_bf16_f32 v41, v42, v43
    v_add_f32 v223, v223, v44
    v_mfma_f32_16x16x32_bf16 v[64:67], a[224:227], a[104:107], v[64:67]
    s_add_u32 s34, s34, 12288
    s_add_u32 m0, s32, 73728
    v_mfma_f32_16x16x32_bf16 v[64:67], a[220:223], a[100:103], v[64:67]
    v_exp_f32 v45, v45
    v_mfma_f32_16x16x32_bf16 v[64:67], a[216:219], a[96:99], v[64:67]
    v_add_f32 v223, v223, v45
    s_waitcnt lgkmcnt(0)
    v_mfma_f32_16x16x32_bf16 v[48:51], a[192:195], a[96:99], v[96:99]
    v_exp_f32 v46, v46
    v_mfma_f32_16x16x32_bf16 v[48:51], a[196:199], a[100:103], v[48:51]
    ds_read_b128 a[216:219], v208 offset:43008
    ds_read_b128 a[220:223], v209 offset:43008
    v_mfma_f32_16x16x32_bf16 v[48:51], a[200:203], a[104:107], v[48:51]
    v_exp_f32 v47, v47
    v_mfma_f32_16x16x32_bf16 v[48:51], a[204:207], a[108:111], v[48:51]
    v_cvt_pk_bf16_f32 v44, v44, v45
    v_add_f32 v223, v223, v46
    v_mfma_f32_16x16x32_bf16 v[48:51], a[208:211], a[112:115], v[48:51]
    buffer_load_dwordx4 v217, s[24:27], s34 offen offset:0  lds
    v_mfma_f32_16x16x32_bf16 v[48:51], a[212:215], a[116:119], v[48:51]
    v_exp_f32 v76, v76
    v_mfma_f32_16x16x32_bf16 v[52:55], a[212:215], a[140:143], v[100:103]
    v_add_f32 v223, v223, v47
    v_cvt_pk_bf16_f32 v45, v46, v47
    v_mfma_f32_16x16x32_bf16 v[52:55], a[208:211], a[136:139], v[52:55]
    ds_read_b128 a[224:227], v208 offset:43136
    ds_read_b128 a[228:231], v209 offset:43136
    v_mfma_f32_16x16x32_bf16 v[52:55], a[204:207], a[132:135], v[52:55]
    v_exp_f32 v77, v77
    v_mfma_f32_16x16x32_bf16 v[52:55], a[200:203], a[128:131], v[52:55]
    v_add_f32 v223, v223, v76
    v_add_f32 v223, v223, v77
    v_mfma_f32_16x16x32_bf16 v[52:55], a[196:199], a[124:127], v[52:55]
    buffer_load_dwordx4 v218, s[24:27], s34 offen offset:1024  lds
    v_mfma_f32_16x16x32_bf16 v[52:55], a[192:195], a[120:123], v[52:55]
    v_exp_f32 v78, v78
    v_mfma_f32_16x16x32_bf16 v[56:59], a[192:195], a[144:147], v[104:107]
    v_cvt_pk_bf16_f32 v46, v76, v77
    v_add_f32 v223, v223, v78
    v_mfma_f32_16x16x32_bf16 v[56:59], a[196:199], a[148:151], v[56:59]
    ds_read_b128 a[232:235], v208 offset:43264
    ds_read_b128 a[236:239], v209 offset:43264
    v_mfma_f32_16x16x32_bf16 v[56:59], a[200:203], a[152:155], v[56:59]
    v_exp_f32 v79, v79
    v_mfma_f32_16x16x32_bf16 v[56:59], a[204:207], a[156:159], v[56:59]
    v_exp_f32 v72, v72
    v_mfma_f32_16x16x32_bf16 v[56:59], a[208:211], a[160:163], v[56:59]
    buffer_load_dwordx4 v219, s[24:27], s34 offen offset:2048  lds
    v_mfma_f32_16x16x32_bf16 v[56:59], a[212:215], a[164:167], v[56:59]
    v_add_f32 v223, v223, v79
    v_cvt_pk_bf16_f32 v47, v78, v79
    v_mfma_f32_16x16x32_bf16 v[60:63], a[212:215], a[188:191], v[108:111]
    v_exp_f32 v73, v73
    v_mfma_f32_16x16x32_bf16 v[60:63], a[208:211], a[184:187], v[60:63]
    v_add_f32 v222, v222, v72
    v_add_f32 v222, v222, v73
    v_mfma_f32_16x16x32_bf16 v[60:63], a[204:207], a[180:183], v[60:63]
    v_exp_f32 v74, v74
    v_mfma_f32_16x16x32_bf16 v[60:63], a[200:203], a[176:179], v[60:63]
    s_add_u32 s34, s34, 12288
    s_add_u32 m0, s32, 86016
    v_mfma_f32_16x16x32_bf16 v[60:63], a[196:199], a[172:175], v[60:63]
    v_cvt_pk_bf16_f32 v42, v72, v73
    v_add_f32 v222, v222, v74
    v_mfma_f32_16x16x32_bf16 v[60:63], a[192:195], a[168:171], v[60:63]
    s_waitcnt vmcnt(9) lgkmcnt(0)
    s_barrier
    v_mfma_f32_16x16x32_bf16 v[92:95], a[216:219], a[168:171], v[108:111]
    v_exp_f32 v75, v75
    v_mfma_f32_16x16x32_bf16 v[92:95], a[220:223], a[172:175], v[92:95]
    ds_read_b128 a[192:195], v208 offset:0
    ds_read_b128 a[196:199], v209 offset:0
    v_mfma_f32_16x16x32_bf16 v[92:95], a[224:227], a[176:179], v[92:95]
    v_exp_f32 v68, v68
    v_mfma_f32_16x16x32_bf16 v[92:95], a[228:231], a[180:183], v[92:95]
    v_add_f32 v222, v222, v75
    v_cvt_pk_bf16_f32 v43, v74, v75
    v_mfma_f32_16x16x32_bf16 v[92:95], a[232:235], a[184:187], v[92:95]
    buffer_load_dwordx4 v217, s[24:27], s34 offen offset:0  lds
    v_mfma_f32_16x16x32_bf16 v[92:95], a[236:239], a[188:191], v[92:95]
    v_exp_f32 v69, v69
    v_mfma_f32_16x16x32_bf16 v[88:91], a[236:239], a[164:167], v[104:107]
    v_add_f32 v221, v221, v68
    v_add_f32 v221, v221, v69
    v_mfma_f32_16x16x32_bf16 v[88:91], a[232:235], a[160:163], v[88:91]
    ds_read_b128 a[200:203], v208 offset:128
    ds_read_b128 a[204:207], v209 offset:128
    v_mfma_f32_16x16x32_bf16 v[88:91], a[228:231], a[156:159], v[88:91]
    v_exp_f32 v70, v70
    v_mfma_f32_16x16x32_bf16 v[88:91], a[224:227], a[152:155], v[88:91]
    v_exp_f32 v71, v71
    v_mfma_f32_16x16x32_bf16 v[88:91], a[220:223], a[148:151], v[88:91]
    buffer_load_dwordx4 v218, s[24:27], s34 offen offset:1024  lds
    v_mfma_f32_16x16x32_bf16 v[88:91], a[216:219], a[144:147], v[88:91]
    v_cvt_pk_bf16_f32 v38, v68, v69
    v_add_f32 v221, v221, v70
    v_mfma_f32_16x16x32_bf16 v[84:87], a[216:219], a[120:123], v[100:103]
    v_exp_f32 v64, v64
    v_mfma_f32_16x16x32_bf16 v[84:87], a[220:223], a[124:127], v[84:87]
    ds_read_b128 a[208:211], v208 offset:256
    ds_read_b128 a[212:215], v209 offset:256
    v_mfma_f32_16x16x32_bf16 v[84:87], a[224:227], a[128:131], v[84:87]
    v_exp_f32 v65, v65
    v_mfma_f32_16x16x32_bf16 v[84:87], a[228:231], a[132:135], v[84:87]
    v_add_f32 v221, v221, v71
    v_cvt_pk_bf16_f32 v39, v70, v71
    v_mfma_f32_16x16x32_bf16 v[84:87], a[232:235], a[136:139], v[84:87]
    buffer_load_dwordx4 v219, s[24:27], s34 offen offset:2048  lds
    v_mfma_f32_16x16x32_bf16 v[84:87], a[236:239], a[140:143], v[84:87]
    v_exp_f32 v66, v66
    v_mfma_f32_16x16x32_bf16 v[80:83], a[236:239], a[116:119], v[96:99]
    v_add_f32 v220, v220, v64
    v_add_f32 v220, v220, v65
    v_mfma_f32_16x16x32_bf16 v[80:83], a[232:235], a[112:115], v[80:83]
    v_exp_f32 v67, v67
    v_mfma_f32_16x16x32_bf16 v[80:83], a[228:231], a[108:111], v[80:83]
    v_cvt_pk_bf16_f32 v34, v64, v65
    v_add_f32 v220, v220, v66
    v_mfma_f32_16x16x32_bf16 v[80:83], a[224:227], a[104:107], v[80:83]
    s_add_u32 s34, s34, 12288
    v_add_f32 v220, v220, v67
    v_mfma_f32_16x16x32_bf16 v[80:83], a[220:223], a[100:103], v[80:83]
    v_exp_f32 v48, v48
    v_mfma_f32_16x16x32_bf16 v[80:83], a[216:219], a[96:99], v[80:83]
    v_cvt_pk_bf16_f32 v35, v66, v67
    s_waitcnt lgkmcnt(0)
    v_mfma_f32_16x16x32_bf16 v[192:195], a[192:195], a[96:99], v[96:99]
    v_add_f32 v220, v220, v48
    v_mfma_f32_16x16x32_bf16 v[192:195], a[196:199], a[100:103], v[192:195]
    ds_read_b128 a[216:219], v208 offset:6144
    ds_read_b128 a[220:223], v209 offset:6144
    v_mfma_f32_16x16x32_bf16 v[192:195], a[200:203], a[104:107], v[192:195]
    v_exp_f32 v49, v49
    v_mfma_f32_16x16x32_bf16 v[192:195], a[204:207], a[108:111], v[192:195]
    v_exp_f32 v50, v50
    v_mfma_f32_16x16x32_bf16 v[192:195], a[208:211], a[112:115], v[192:195]
    v_add_f32 v220, v220, v49
    v_cvt_pk_bf16_f32 v48, v48, v49
    v_mfma_f32_16x16x32_bf16 v[192:195], a[212:215], a[116:119], v[192:195]
    v_add_f32 v220, v220, v50
    v_mfma_f32_16x16x32_bf16 v[196:199], a[212:215], a[140:143], v[100:103]
    v_exp_f32 v51, v51
    v_mfma_f32_16x16x32_bf16 v[196:199], a[208:211], a[136:139], v[196:199]
    ds_read_b128 a[224:227], v208 offset:6272
    ds_read_b128 a[228:231], v209 offset:6272
    v_mfma_f32_16x16x32_bf16 v[196:199], a[204:207], a[132:135], v[196:199]
    v_exp_f32 v52, v52
    v_mfma_f32_16x16x32_bf16 v[196:199], a[200:203], a[128:131], v[196:199]
    v_add_f32 v220, v220, v51
    v_cvt_pk_bf16_f32 v49, v50, v51
    v_mfma_f32_16x16x32_bf16 v[196:199], a[196:199], a[124:127], v[196:199]
    v_add_f32 v221, v221, v52
    v_mfma_f32_16x16x32_bf16 v[196:199], a[192:195], a[120:123], v[196:199]
    v_exp_f32 v53, v53
    v_mfma_f32_16x16x32_bf16 v[200:203], a[192:195], a[144:147], v[104:107]
    v_add_f32 v221, v221, v53
    v_cvt_pk_bf16_f32 v52, v52, v53
    v_mfma_f32_16x16x32_bf16 v[200:203], a[196:199], a[148:151], v[200:203]
    ds_read_b128 a[232:235], v208 offset:6400
    ds_read_b128 a[236:239], v209 offset:6400
    v_mfma_f32_16x16x32_bf16 v[200:203], a[200:203], a[152:155], v[200:203]
    v_exp_f32 v54, v54
    v_mfma_f32_16x16x32_bf16 v[200:203], a[204:207], a[156:159], v[200:203]
    v_add_f32 v221, v221, v54
    v_mfma_f32_16x16x32_bf16 v[200:203], a[208:211], a[160:163], v[200:203]
    v_exp_f32 v55, v55
    v_mfma_f32_16x16x32_bf16 v[200:203], a[212:215], a[164:167], v[200:203]
    v_add_f32 v221, v221, v55
    v_cvt_pk_bf16_f32 v53, v54, v55
    v_mfma_f32_16x16x32_bf16 v[204:207], a[212:215], a[188:191], v[108:111]
    v_exp_f32 v56, v56
    v_mfma_f32_16x16x32_bf16 v[204:207], a[208:211], a[184:187], v[204:207]
    v_add_f32 v222, v222, v56
    v_mfma_f32_16x16x32_bf16 v[204:207], a[204:207], a[180:183], v[204:207]
    v_mfma_f32_16x16x32_bf16 v[204:207], a[200:203], a[176:179], v[204:207]
    v_exp_f32 v57, v57
    v_mfma_f32_16x16x32_bf16 v[204:207], a[196:199], a[172:175], v[204:207]
    v_add_f32 v222, v222, v57
    v_cvt_pk_bf16_f32 v56, v56, v57
    v_mfma_f32_16x16x32_bf16 v[204:207], a[192:195], a[168:171], v[204:207]
    s_waitcnt lgkmcnt(0)
    v_mfma_f32_16x16x32_bf16 v[76:79], a[216:219], a[168:171], v[108:111]
    v_exp_f32 v58, v58
    v_mfma_f32_16x16x32_bf16 v[76:79], a[220:223], a[172:175], v[76:79]
    ds_read_b128 a[192:195], v208 offset:12288
    ds_read_b128 a[196:199], v209 offset:12288
    v_mfma_f32_16x16x32_bf16 v[76:79], a[224:227], a[176:179], v[76:79]
    v_exp_f32 v59, v59
    v_mfma_f32_16x16x32_bf16 v[76:79], a[228:231], a[180:183], v[76:79]
    v_add_f32 v222, v222, v58
    v_add_f32 v222, v222, v59
    v_mfma_f32_16x16x32_bf16 v[76:79], a[232:235], a[184:187], v[76:79]
    v_cvt_pk_bf16_f32 v57, v58, v59
    v_mfma_f32_16x16x32_bf16 v[76:79], a[236:239], a[188:191], v[76:79]
    v_exp_f32 v60, v60
    v_mfma_f32_16x16x32_bf16 v[72:75], a[236:239], a[164:167], v[104:107]
    v_add_f32 v223, v223, v60
    v_mfma_f32_16x16x32_bf16 v[72:75], a[232:235], a[160:163], v[72:75]
    ds_read_b128 a[200:203], v208 offset:12416
    ds_read_b128 a[204:207], v209 offset:12416
    v_mfma_f32_16x16x32_bf16 v[72:75], a[228:231], a[156:159], v[72:75]
    v_exp_f32 v61, v61
    v_mfma_f32_16x16x32_bf16 v[72:75], a[224:227], a[152:155], v[72:75]
    v_add_f32 v223, v223, v61
    v_cvt_pk_bf16_f32 v60, v60, v61
    v_mfma_f32_16x16x32_bf16 v[72:75], a[220:223], a[148:151], v[72:75]
    v_exp_f32 v62, v62
    v_mfma_f32_16x16x32_bf16 v[72:75], a[216:219], a[144:147], v[72:75]
    v_add_f32 v223, v223, v62
    v_mfma_f32_16x16x32_bf16 v[68:71], a[216:219], a[120:123], v[100:103]
    v_exp_f32 v63, v63
    v_mfma_f32_16x16x32_bf16 v[68:71], a[220:223], a[124:127], v[68:71]
    ds_read_b128 a[208:211], v208 offset:12544
    ds_read_b128 a[212:215], v209 offset:12544
    v_mfma_f32_16x16x32_bf16 v[68:71], a[224:227], a[128:131], v[68:71]
    v_add_f32 v223, v223, v63
    v_cvt_pk_bf16_f32 v61, v62, v63
    v_mfma_f32_16x16x32_bf16 v[68:71], a[228:231], a[132:135], v[68:71]
    v_exp_f32 v92, v92
    v_mfma_f32_16x16x32_bf16 v[68:71], a[232:235], a[136:139], v[68:71]
    v_add_f32 v223, v223, v92
    v_mfma_f32_16x16x32_bf16 v[68:71], a[236:239], a[140:143], v[68:71]
    v_mfma_f32_16x16x32_bf16 v[64:67], a[236:239], a[116:119], v[96:99]
    v_exp_f32 v93, v93
    v_mfma_f32_16x16x32_bf16 v[64:67], a[232:235], a[112:115], v[64:67]
    v_add_f32 v223, v223, v93
    v_cvt_pk_bf16_f32 v62, v92, v93
    v_mfma_f32_16x16x32_bf16 v[64:67], a[228:231], a[108:111], v[64:67]
    v_exp_f32 v94, v94
    v_mfma_f32_16x16x32_bf16 v[64:67], a[224:227], a[104:107], v[64:67]
    v_add_f32 v223, v223, v94
    v_mfma_f32_16x16x32_bf16 v[64:67], a[220:223], a[100:103], v[64:67]
    v_mfma_f32_16x16x32_bf16 v[64:67], a[216:219], a[96:99], v[64:67]
    s_waitcnt lgkmcnt(0)
    v_mfma_f32_16x16x32_bf16 v[240:243], a[192:195], a[96:99], v[96:99]
    v_exp_f32 v95, v95
    v_mfma_f32_16x16x32_bf16 v[240:243], a[196:199], a[100:103], v[240:243]
    ds_read_b128 a[216:219], v208 offset:18432
    ds_read_b128 a[220:223], v209 offset:18432
    v_mfma_f32_16x16x32_bf16 v[240:243], a[200:203], a[104:107], v[240:243]
    v_exp_f32 v88, v88
    v_mfma_f32_16x16x32_bf16 v[240:243], a[204:207], a[108:111], v[240:243]
    v_add_f32 v223, v223, v95
    v_cvt_pk_bf16_f32 v63, v94, v95
    v_mfma_f32_16x16x32_bf16 v[240:243], a[208:211], a[112:115], v[240:243]
    v_exp_f32 v89, v89
    v_mfma_f32_16x16x32_bf16 v[240:243], a[212:215], a[116:119], v[240:243]
    v_add_f32 v222, v222, v88
    v_add_f32 v222, v222, v89
    v_mfma_f32_16x16x32_bf16 v[244:247], a[212:215], a[140:143], v[100:103]
    v_exp_f32 v90, v90
    v_mfma_f32_16x16x32_bf16 v[244:247], a[208:211], a[136:139], v[244:247]
    ds_read_b128 a[224:227], v208 offset:18560
    ds_read_b128 a[228:231], v209 offset:18560
    v_mfma_f32_16x16x32_bf16 v[244:247], a[204:207], a[132:135], v[244:247]
    v_cvt_pk_bf16_f32 v58, v88, v89
    v_add_f32 v222, v222, v90
    v_mfma_f32_16x16x32_bf16 v[244:247], a[200:203], a[128:131], v[244:247]
    v_exp_f32 v91, v91
    v_mfma_f32_16x16x32_bf16 v[244:247], a[196:199], a[124:127], v[244:247]
    v_add_f32 v222, v222, v91
    v_cvt_pk_bf16_f32 v59, v90, v91
    v_mfma_f32_16x16x32_bf16 v[244:247], a[192:195], a[120:123], v[244:247]
    v_exp_f32 v84, v84
    v_mfma_f32_16x16x32_bf16 v[248:251], a[192:195], a[144:147], v[104:107]
    v_add_f32 v221, v221, v84
    v_mfma_f32_16x16x32_bf16 v[248:251], a[196:199], a[148:151], v[248:251]
    ds_read_b128 a[232:235], v208 offset:18688
    ds_read_b128 a[236:239], v209 offset:18688
    v_mfma_f32_16x16x32_bf16 v[248:251], a[200:203], a[152:155], v[248:251]
    v_exp_f32 v85, v85
    v_mfma_f32_16x16x32_bf16 v[248:251], a[204:207], a[156:159], v[248:251]
    v_add_f32 v221, v221, v85
    v_cvt_pk_bf16_f32 v54, v84, v85
    v_mfma_f32_16x16x32_bf16 v[248:251], a[208:211], a[160:163], v[248:251]
    v_mfma_f32_16x16x32_bf16 v[248:251], a[212:215], a[164:167], v[248:251]
    v_exp_f32 v86, v86
    v_mfma_f32_16x16x32_bf16 v[252:255], a[212:215], a[188:191], v[108:111]
    v_add_f32 v221, v221, v86
    v_mfma_f32_16x16x32_bf16 v[252:255], a[208:211], a[184:187], v[252:255]
    v_exp_f32 v87, v87
    v_mfma_f32_16x16x32_bf16 v[252:255], a[204:207], a[180:183], v[252:255]
    v_add_f32 v221, v221, v87
    v_cvt_pk_bf16_f32 v55, v86, v87
    v_mfma_f32_16x16x32_bf16 v[252:255], a[200:203], a[176:179], v[252:255]
    v_mfma_f32_16x16x32_bf16 v[252:255], a[196:199], a[172:175], v[252:255]
    v_exp_f32 v80, v80
    v_mfma_f32_16x16x32_bf16 v[252:255], a[192:195], a[168:171], v[252:255]
    s_waitcnt vmcnt(0) lgkmcnt(0)
    s_barrier
    v_mfma_f32_16x16x32_bf16 v[92:95], a[216:219], a[168:171], v[108:111]
    ds_read_b64_tr_b16 a[192:193], v210 offset:0
    ds_read_b64_tr_b16 a[194:195], v210 offset:6144
    v_mfma_f32_16x16x32_bf16 v[92:95], a[220:223], a[172:175], v[92:95]
    v_exp_f32 v81, v81
    v_mfma_f32_16x16x32_bf16 v[92:95], a[224:227], a[176:179], v[92:95]
    buffer_load_dword v226, v227, s[76:79], s82 offen
    v_mfma_f32_16x16x32_bf16 v[92:95], a[228:231], a[180:183], v[92:95]
    v_exp_f32 v82, v82
    v_mfma_f32_16x16x32_bf16 v[92:95], a[232:235], a[184:187], v[92:95]
    ds_read_b64_tr_b16 a[196:197], v210 offset:12288
    ds_read_b64_tr_b16 a[198:199], v210 offset:18432
    v_mfma_f32_16x16x32_bf16 v[92:95], a[236:239], a[188:191], v[92:95]
    v_exp_f32 v83, v83
    v_mfma_f32_16x16x32_bf16 v[88:91], a[236:239], a[164:167], v[104:107]
    s_add_u32 s82, s82, 65536
    s_add_u32 s35, s35, 1
    v_mfma_f32_16x16x32_bf16 v[88:91], a[232:235], a[160:163], v[88:91]
    v_add_f32 v220, v220, v80
    v_add_f32 v220, v220, v81
    v_mfma_f32_16x16x32_bf16 v[88:91], a[228:231], a[156:159], v[88:91]
    ds_read_b64_tr_b16 a[200:201], v210 offset:24576
    ds_read_b64_tr_b16 a[202:203], v210 offset:30720
    v_mfma_f32_16x16x32_bf16 v[88:91], a[224:227], a[152:155], v[88:91]
    v_cvt_pk_bf16_f32 v50, v80, v81
    v_add_f32 v220, v220, v82
    v_mfma_f32_16x16x32_bf16 v[88:91], a[220:223], a[148:151], v[88:91]
    v_add_f32 v220, v220, v83
    v_cvt_pk_bf16_f32 v51, v82, v83
    v_mfma_f32_16x16x32_bf16 v[88:91], a[216:219], a[144:147], v[88:91]
    v_mfma_f32_16x16x32_bf16 v[84:87], a[216:219], a[120:123], v[100:103]
    ds_read_b64_tr_b16 a[204:205], v210 offset:36864
    ds_read_b64_tr_b16 a[206:207], v210 offset:43008
    v_mfma_f32_16x16x32_bf16 v[84:87], a[220:223], a[124:127], v[84:87]
    v_exp_f32 v192, v192
    v_mfma_f32_16x16x32_bf16 v[84:87], a[224:227], a[128:131], v[84:87]
    v_add_f32 v220, v220, v192
    v_mfma_f32_16x16x32_bf16 v[84:87], a[228:231], a[132:135], v[84:87]
    v_exp_f32 v193, v193
    v_mfma_f32_16x16x32_bf16 v[84:87], a[232:235], a[136:139], v[84:87]
    ds_read_b64_tr_b16 a[208:209], v211 offset:0
    ds_read_b64_tr_b16 a[210:211], v211 offset:6144
    v_mfma_f32_16x16x32_bf16 v[84:87], a[236:239], a[140:143], v[84:87]
    v_add_f32 v220, v220, v193
    v_cvt_pk_bf16_f32 v192, v192, v193
    v_mfma_f32_16x16x32_bf16 v[80:83], a[236:239], a[116:119], v[96:99]
    v_mfma_f32_16x16x32_bf16 v[80:83], a[232:235], a[112:115], v[80:83]
    v_exp_f32 v194, v194
    v_mfma_f32_16x16x32_bf16 v[80:83], a[228:231], a[108:111], v[80:83]
    ds_read_b64_tr_b16 a[212:213], v211 offset:12288
    ds_read_b64_tr_b16 a[214:215], v211 offset:18432
    v_mfma_f32_16x16x32_bf16 v[80:83], a[224:227], a[104:107], v[80:83]
    v_add_f32 v220, v220, v194
    v_mfma_f32_16x16x32_bf16 v[80:83], a[220:223], a[100:103], v[80:83]
    v_exp_f32 v195, v195
    v_mfma_f32_16x16x32_bf16 v[80:83], a[216:219], a[96:99], v[80:83]
    v_add_f32 v220, v220, v195
    s_waitcnt lgkmcnt(4)
    v_mfma_f32_16x16x32_bf16 v[112:115], a[192:195], v[0:3], v[112:115]
    ds_read_b64_tr_b16 a[216:217], v211 offset:24576
    ds_read_b64_tr_b16 a[218:219], v211 offset:30720
    v_mfma_f32_16x16x32_bf16 v[112:115], a[196:199], v[16:19], v[112:115]
    ds_read_b64_tr_b16 a[220:221], v211 offset:36864
    ds_read_b64_tr_b16 a[222:223], v211 offset:43008
    v_mfma_f32_16x16x32_bf16 v[112:115], a[200:203], v[32:35], v[112:115]
    v_exp_f32 v196, v196
    v_mfma_f32_16x16x32_bf16 v[112:115], a[204:207], v[48:51], v[112:115]
    v_cvt_pk_bf16_f32 v193, v194, v195
    v_add_f32 v221, v221, v196
    v_mfma_f32_16x16x32_bf16 v[160:163], a[204:207], v[52:55], v[160:163]
    ds_read_b64_tr_b16 a[224:225], v212 offset:0
    ds_read_b64_tr_b16 a[226:227], v212 offset:6144
    v_mfma_f32_16x16x32_bf16 v[160:163], a[200:203], v[36:39], v[160:163]
    v_exp_f32 v197, v197
    v_mfma_f32_16x16x32_bf16 v[160:163], a[196:199], v[20:23], v[160:163]
    v_add_f32 v221, v221, v197
    v_cvt_pk_bf16_f32 v196, v196, v197
    v_mfma_f32_16x16x32_bf16 v[160:163], a[192:195], v[4:7], v[160:163]
    ds_read_b64_tr_b16 a[228:229], v212 offset:12288
    ds_read_b64_tr_b16 a[230:231], v212 offset:18432
    v_mfma_f32_16x16x32_bf16 a[0:3], a[192:195], v[8:11], a[0:3]
    v_exp_f32 v198, v198
    v_mfma_f32_16x16x32_bf16 a[0:3], a[196:199], v[24:27], a[0:3]
    v_add_f32 v221, v221, v198
    v_mfma_f32_16x16x32_bf16 a[0:3], a[200:203], v[40:43], a[0:3]
    ds_read_b64_tr_b16 a[232:233], v212 offset:24576
    ds_read_b64_tr_b16 a[234:235], v212 offset:30720
    v_mfma_f32_16x16x32_bf16 a[0:3], a[204:207], v[56:59], a[0:3]
    v_exp_f32 v199, v199
    v_mfma_f32_16x16x32_bf16 a[48:51], a[204:207], v[60:63], a[48:51]
    v_add_f32 v221, v221, v199
    v_cvt_pk_bf16_f32 v197, v198, v199
    v_mfma_f32_16x16x32_bf16 a[48:51], a[200:203], v[44:47], a[48:51]
    ds_read_b64_tr_b16 a[236:237], v212 offset:36864
    ds_read_b64_tr_b16 a[238:239], v212 offset:43008
    v_mfma_f32_16x16x32_bf16 a[48:51], a[196:199], v[28:31], a[48:51]
    v_exp_f32 v200, v200
    v_mfma_f32_16x16x32_bf16 a[48:51], a[192:195], v[12:15], a[48:51]
    v_add_f32 v222, v222, v200
    s_waitcnt lgkmcnt(8)
    v_mfma_f32_16x16x32_bf16 a[52:55], a[208:211], v[12:15], a[52:55]
    ds_read_b64_tr_b16 a[192:193], v213 offset:0
    ds_read_b64_tr_b16 a[194:195], v213 offset:6144
    v_mfma_f32_16x16x32_bf16 a[52:55], a[212:215], v[28:31], a[52:55]
    s_add_u32 m0, s32, 24576
    v_mfma_f32_16x16x32_bf16 a[52:55], a[216:219], v[44:47], a[52:55]
    buffer_load_dwordx4 v214, s[20:23], s33 offen offset:0  lds
    v_mfma_f32_16x16x32_bf16 a[52:55], a[220:223], v[60:63], a[52:55]
    v_exp_f32 v201, v201
    v_mfma_f32_16x16x32_bf16 a[4:7], a[220:223], v[56:59], a[4:7]
    ds_read_b64_tr_b16 a[196:197], v213 offset:12288
    ds_read_b64_tr_b16 a[198:199], v213 offset:18432
    v_mfma_f32_16x16x32_bf16 a[4:7], a[216:219], v[40:43], a[4:7]
    v_exp_f32 v202, v202
    v_mfma_f32_16x16x32_bf16 a[4:7], a[212:215], v[24:27], a[4:7]
    v_add_f32 v222, v222, v201
    v_cvt_pk_bf16_f32 v200, v200, v201
    v_mfma_f32_16x16x32_bf16 a[4:7], a[208:211], v[8:11], a[4:7]
    v_add_f32 v222, v222, v202
    v_mfma_f32_16x16x32_bf16 v[164:167], a[208:211], v[4:7], v[164:167]
    ds_read_b64_tr_b16 a[200:201], v213 offset:24576
    ds_read_b64_tr_b16 a[202:203], v213 offset:30720
    v_mfma_f32_16x16x32_bf16 v[164:167], a[212:215], v[20:23], v[164:167]
    v_exp_f32 v203, v203
    v_mfma_f32_16x16x32_bf16 v[164:167], a[216:219], v[36:39], v[164:167]
    buffer_load_dwordx4 v215, s[20:23], s33 offen offset:1024  lds
    v_mfma_f32_16x16x32_bf16 v[164:167], a[220:223], v[52:55], v[164:167]
    v_exp_f32 v204, v204
    v_mfma_f32_16x16x32_bf16 v[116:119], a[220:223], v[48:51], v[116:119]
    ds_read_b64_tr_b16 a[204:205], v213 offset:36864
    ds_read_b64_tr_b16 a[206:207], v213 offset:43008
    v_mfma_f32_16x16x32_bf16 v[116:119], a[216:219], v[32:35], v[116:119]
    v_add_f32 v222, v222, v203
    v_cvt_pk_bf16_f32 v201, v202, v203
    v_mfma_f32_16x16x32_bf16 v[116:119], a[212:215], v[16:19], v[116:119]
    v_add_f32 v223, v223, v204
    v_mfma_f32_16x16x32_bf16 v[116:119], a[208:211], v[0:3], v[116:119]
    s_waitcnt lgkmcnt(8)
    v_mfma_f32_16x16x32_bf16 v[120:123], a[224:227], v[0:3], v[120:123]
    ds_read_b64_tr_b16 a[208:209], v210 offset:128
    ds_read_b64_tr_b16 a[210:211], v210 offset:6272
    v_mfma_f32_16x16x32_bf16 v[120:123], a[228:231], v[16:19], v[120:123]
    v_exp_f32 v205, v205
    v_mfma_f32_16x16x32_bf16 v[120:123], a[232:235], v[32:35], v[120:123]
    buffer_load_dwordx4 v216, s[20:23], s33 offen offset:2048  lds
    v_mfma_f32_16x16x32_bf16 v[120:123], a[236:239], v[48:51], v[120:123]
    v_exp_f32 v206, v206
    v_mfma_f32_16x16x32_bf16 v[168:171], a[236:239], v[52:55], v[168:171]
    ds_read_b64_tr_b16 a[212:213], v210 offset:12416
    ds_read_b64_tr_b16 a[214:215], v210 offset:18560
    v_mfma_f32_16x16x32_bf16 v[168:171], a[232:235], v[36:39], v[168:171]
    v_exp_f32 v207, v207
    v_mfma_f32_16x16x32_bf16 v[168:171], a[228:231], v[20:23], v[168:171]
    s_add_u32 s33, s33, 12288
    s_add_u32 m0, s32, 36864
    v_mfma_f32_16x16x32_bf16 v[168:171], a[224:227], v[4:7], v[168:171]
    v_add_f32 v223, v223, v205
    v_cvt_pk_bf16_f32 v204, v204, v205
    v_mfma_f32_16x16x32_bf16 a[8:11], a[224:227], v[8:11], a[8:11]
    ds_read_b64_tr_b16 a[216:217], v210 offset:24704
    ds_read_b64_tr_b16 a[218:219], v210 offset:30848
    v_mfma_f32_16x16x32_bf16 a[8:11], a[228:231], v[24:27], a[8:11]
    v_exp_f32 v76, v76
    v_mfma_f32_16x16x32_bf16 a[8:11], a[232:235], v[40:43], a[8:11]
    buffer_load_dwordx4 v214, s[20:23], s33 offen offset:0  lds
    v_mfma_f32_16x16x32_bf16 a[8:11], a[236:239], v[56:59], a[8:11]
    v_add_f32 v223, v223, v206
    v_add_f32 v223, v223, v207
    v_mfma_f32_16x16x32_bf16 a[56:59], a[236:239], v[60:63], a[56:59]
    ds_read_b64_tr_b16 a[220:221], v210 offset:36992
    ds_read_b64_tr_b16 a[222:223], v210 offset:43136
    v_mfma_f32_16x16x32_bf16 a[56:59], a[232:235], v[44:47], a[56:59]
    v_exp_f32 v77, v77
    v_mfma_f32_16x16x32_bf16 a[56:59], a[228:231], v[28:31], a[56:59]
    v_cvt_pk_bf16_f32 v205, v206, v207
    v_add_f32 v223, v223, v76
    v_mfma_f32_16x16x32_bf16 a[56:59], a[224:227], v[12:15], a[56:59]
    v_add_f32 v223, v223, v77
    s_waitcnt lgkmcnt(8)
    v_mfma_f32_16x16x32_bf16 a[60:63], a[192:195], v[12:15], a[60:63]
    ds_read_b64_tr_b16 a[224:225], v211 offset:128
    ds_read_b64_tr_b16 a[226:227], v211 offset:6272
    v_mfma_f32_16x16x32_bf16 a[60:63], a[196:199], v[28:31], a[60:63]
    v_exp_f32 v78, v78
    v_mfma_f32_16x16x32_bf16 a[60:63], a[200:203], v[44:47], a[60:63]
    buffer_load_dwordx4 v215, s[20:23], s33 offen offset:1024  lds
    v_mfma_f32_16x16x32_bf16 a[60:63], a[204:207], v[60:63], a[60:63]
    v_exp_f32 v79, v79
    v_mfma_f32_16x16x32_bf16 a[12:15], a[204:207], v[56:59], a[12:15]
    ds_read_b64_tr_b16 a[228:229], v211 offset:12416
    ds_read_b64_tr_b16 a[230:231], v211 offset:18560
    v_mfma_f32_16x16x32_bf16 a[12:15], a[200:203], v[40:43], a[12:15]
    v_cvt_pk_bf16_f32 v206, v76, v77
    v_add_f32 v223, v223, v78
    v_mfma_f32_16x16x32_bf16 a[12:15], a[196:199], v[24:27], a[12:15]
    v_exp_f32 v72, v72
    v_mfma_f32_16x16x32_bf16 a[12:15], a[192:195], v[8:11], a[12:15]
    v_add_f32 v223, v223, v79
    v_cvt_pk_bf16_f32 v207, v78, v79
    v_mfma_f32_16x16x32_bf16 v[172:175], a[192:195], v[4:7], v[172:175]
    ds_read_b64_tr_b16 a[232:233], v211 offset:24704
    ds_read_b64_tr_b16 a[234:235], v211 offset:30848
    v_mfma_f32_16x16x32_bf16 v[172:175], a[196:199], v[20:23], v[172:175]
    v_exp_f32 v73, v73
    v_mfma_f32_16x16x32_bf16 v[172:175], a[200:203], v[36:39], v[172:175]
    buffer_load_dwordx4 v216, s[20:23], s33 offen offset:2048  lds
    v_mfma_f32_16x16x32_bf16 v[172:175], a[204:207], v[52:55], v[172:175]
    v_add_f32 v222, v222, v72
    v_add_f32 v222, v222, v73
    v_mfma_f32_16x16x32_bf16 v[124:127], a[204:207], v[48:51], v[124:127]
    ds_read_b64_tr_b16 a[236:237], v211 offset:36992
    ds_read_b64_tr_b16 a[238:239], v211 offset:43136
    v_mfma_f32_16x16x32_bf16 v[124:127], a[200:203], v[32:35], v[124:127]
    s_add_u32 s33, s33, 12288
    v_cvt_pk_bf16_f32 v202, v72, v73
    v_mfma_f32_16x16x32_bf16 v[124:127], a[196:199], v[16:19], v[124:127]
    s_cmp_eq_u32 s35, 8
    v_mfma_f32_16x16x32_bf16 v[124:127], a[192:195], v[0:3], v[124:127]
    s_waitcnt lgkmcnt(8)
    s_cbranch_scc1 L_patch
L_mid:
    v_mfma_f32_16x16x32_bf16 v[128:131], a[208:211], v[0:3], v[128:131]
    ds_read_b64_tr_b16 a[192:193], v212 offset:128
    ds_read_b64_tr_b16 a[194:195], v212 offset:6272
    v_mfma_f32_16x16x32_bf16 v[128:131], a[212:215], v[16:19], v[128:131]
    s_add_u32 m0, s32, 0
    v_mfma_f32_16x16x32_bf16 v[128:131], a[216:219], v[32:35], v[128:131]
    buffer_load_dwordx4 v214, s[20:23], s33 offen offset:0  lds
    v_mfma_f32_16x16x32_bf16 v[128:131], a[220:223], v[48:51], v[128:131]
    v_exp_f32 v74, v74
    v_mfma_f32_16x16x32_bf16 v[176:179], a[220:223], v[52:55], v[176:179]
    ds_read_b64_tr_b16 a[196:197], v212 offset:12416
    ds_read_b64_tr_b16 a[198:199], v212 offset:18560
    v_mfma_f32_16x16x32_bf16 v[176:179], a[216:219], v[36:39], v[176:179]
    v_exp_f32 v75, v75
    v_mfma_f32_16x16x32_bf16 v[176:179], a[212:215], v[20:23], v[176:179]
    v_exp_f32 v68, v68
    v_mfma_f32_16x16x32_bf16 v[176:179], a[208:211], v[4:7], v[176:179]
    v_exp_f32 v69, v69
    v_mfma_f32_16x16x32_bf16 a[16:19], a[208:211], v[8:11], a[16:19]
    ds_read_b64_tr_b16 a[200:201], v212 offset:24704
    ds_read_b64_tr_b16 a[202:203], v212 offset:30848
    v_mfma_f32_16x16x32_bf16 a[16:19], a[212:215], v[24:27], a[16:19]
    v_exp_f32 v70, v70
    v_mfma_f32_16x16x32_bf16 a[16:19], a[216:219], v[40:43], a[16:19]
    buffer_load_dwordx4 v215, s[20:23], s33 offen offset:1024  lds
    v_mfma_f32_16x16x32_bf16 a[16:19], a[220:223], v[56:59], a[16:19]
    v_add_f32 v222, v222, v74
    v_add_f32 v222, v222, v75
    v_mfma_f32_16x16x32_bf16 a[64:67], a[220:223], v[60:63], a[64:67]
    ds_read_b64_tr_b16 a[204:205], v212 offset:36992
    ds_read_b64_tr_b16 a[206:207], v212 offset:43136
    v_mfma_f32_16x16x32_bf16 a[64:67], a[216:219], v[44:47], a[64:67]
    v_exp_f32 v71, v71
    v_mfma_f32_16x16x32_bf16 a[64:67], a[212:215], v[28:31], a[64:67]
    v_cvt_pk_bf16_f32 v203, v74, v75
    v_add_f32 v221, v221, v68
    v_mfma_f32_16x16x32_bf16 a[64:67], a[208:211], v[12:15], a[64:67]
    v_add_f32 v221, v221, v69
    s_waitcnt lgkmcnt(8)
    v_mfma_f32_16x16x32_bf16 a[68:71], a[224:227], v[12:15], a[68:71]
    ds_read_b64_tr_b16 a[208:209], v213 offset:128
    ds_read_b64_tr_b16 a[210:211], v213 offset:6272
    v_mfma_f32_16x16x32_bf16 a[68:71], a[228:231], v[28:31], a[68:71]
    v_exp_f32 v64, v64
    v_mfma_f32_16x16x32_bf16 a[68:71], a[232:235], v[44:47], a[68:71]
    buffer_load_dwordx4 v216, s[20:23], s33 offen offset:2048  lds
    v_mfma_f32_16x16x32_bf16 a[68:71], a[236:239], v[60:63], a[68:71]
    v_exp_f32 v65, v65
    v_mfma_f32_16x16x32_bf16 a[20:23], a[236:239], v[56:59], a[20:23]
    ds_read_b64_tr_b16 a[212:213], v213 offset:12416
    ds_read_b64_tr_b16 a[214:215], v213 offset:18560
    v_mfma_f32_16x16x32_bf16 a[20:23], a[232:235], v[40:43], a[20:23]
    v_cvt_pk_bf16_f32 v198, v68, v69
    v_add_f32 v221, v221, v70
    v_mfma_f32_16x16x32_bf16 a[20:23], a[228:231], v[24:27], a[20:23]
    s_add_u32 s33, s33, 12288
    s_add_u32 m0, s32, 12288
    v_mfma_f32_16x16x32_bf16 a[20:23], a[224:227], v[8:11], a[20:23]
    v_exp_f32 v66, v66
    v_mfma_f32_16x16x32_bf16 v[180:183], a[224:227], v[4:7], v[180:183]
    ds_read_b64_tr_b16 a[216:217], v213 offset:24704
    ds_read_b64_tr_b16 a[218:219], v213 offset:30848
    v_mfma_f32_16x16x32_bf16 v[180:183], a[228:231], v[20:23], v[180:183]
    v_add_f32 v221, v221, v71
    v_cvt_pk_bf16_f32 v199, v70, v71
    v_mfma_f32_16x16x32_bf16 v[180:183], a[232:235], v[36:39], v[180:183]
    buffer_load_dwordx4 v214, s[20:23], s33 offen offset:0  lds
    v_mfma_f32_16x16x32_bf16 v[180:183], a[236:239], v[52:55], v[180:183]
    v_exp_f32 v67, v67
    v_mfma_f32_16x16x32_bf16 v[132:135], a[236:239], v[48:51], v[132:135]
    ds_read_b64_tr_b16 a[220:221], v213 offset:36992
    ds_read_b64_tr_b16 a[222:223], v213 offset:43136
    v_mfma_f32_16x16x32_bf16 v[132:135], a[232:235], v[32:35], v[132:135]
    v_exp_f32 v240, v240
    v_mfma_f32_16x16x32_bf16 v[132:135], a[228:231], v[16:19], v[132:135]
    v_add_f32 v220, v220, v64
    v_add_f32 v220, v220, v65
    v_mfma_f32_16x16x32_bf16 v[132:135], a[224:227], v[0:3], v[132:135]
    v_cvt_pk_bf16_f32 v194, v64, v65
    s_waitcnt lgkmcnt(8)
    v_mfma_f32_16x16x32_bf16 v[136:139], a[192:195], v[0:3], v[136:139]
    ds_read_b64_tr_b16 a[224:225], v210 offset:256
    ds_read_b64_tr_b16 a[226:227], v210 offset:6400
    v_mfma_f32_16x16x32_bf16 v[136:139], a[196:199], v[16:19], v[136:139]
    v_exp_f32 v241, v241
    v_mfma_f32_16x16x32_bf16 v[136:139], a[200:203], v[32:35], v[136:139]
    buffer_load_dwordx4 v215, s[20:23], s33 offen offset:1024  lds
    v_mfma_f32_16x16x32_bf16 v[136:139], a[204:207], v[48:51], v[136:139]
    v_add_f32 v220, v220, v66
    v_add_f32 v220, v220, v67
    v_mfma_f32_16x16x32_bf16 v[184:187], a[204:207], v[52:55], v[184:187]
    ds_read_b64_tr_b16 a[228:229], v210 offset:12544
    ds_read_b64_tr_b16 a[230:231], v210 offset:18688
    v_mfma_f32_16x16x32_bf16 v[184:187], a[200:203], v[36:39], v[184:187]
    v_exp_f32 v242, v242
    v_mfma_f32_16x16x32_bf16 v[184:187], a[196:199], v[20:23], v[184:187]
    v_cvt_pk_bf16_f32 v195, v66, v67
    v_add_f32 v220, v220, v240
    v_mfma_f32_16x16x32_bf16 v[184:187], a[192:195], v[4:7], v[184:187]
    v_exp_f32 v243, v243
    v_mfma_f32_16x16x32_bf16 a[24:27], a[192:195], v[8:11], a[24:27]
    ds_read_b64_tr_b16 a[232:233], v210 offset:24832
    ds_read_b64_tr_b16 a[234:235], v210 offset:30976
    v_mfma_f32_16x16x32_bf16 a[24:27], a[196:199], v[24:27], a[24:27]
    v_add_f32 v220, v220, v241
    v_cvt_pk_bf16_f32 v240, v240, v241
    v_mfma_f32_16x16x32_bf16 a[24:27], a[200:203], v[40:43], a[24:27]
    buffer_load_dwordx4 v216, s[20:23], s33 offen offset:2048  lds
    v_mfma_f32_16x16x32_bf16 a[24:27], a[204:207], v[56:59], a[24:27]
    v_exp_f32 v244, v244
    v_mfma_f32_16x16x32_bf16 a[72:75], a[204:207], v[60:63], a[72:75]
    ds_read_b64_tr_b16 a[236:237], v210 offset:37120
    ds_read_b64_tr_b16 a[238:239], v210 offset:43264
    v_mfma_f32_16x16x32_bf16 a[72:75], a[200:203], v[44:47], a[72:75]
    v_exp_f32 v245, v245
    v_mfma_f32_16x16x32_bf16 a[72:75], a[196:199], v[28:31], a[72:75]
    s_add_u32 s33, s33, 12288
    v_add_f32 v220, v220, v242
    v_mfma_f32_16x16x32_bf16 a[72:75], a[192:195], v[12:15], a[72:75]
    v_add_f32 v220, v220, v243
    s_waitcnt lgkmcnt(8)
    v_mfma_f32_16x16x32_bf16 a[76:79], a[208:211], v[12:15], a[76:79]
    ds_read_b64_tr_b16 a[192:193], v211 offset:256
    ds_read_b64_tr_b16 a[194:195], v211 offset:6400
    v_mfma_f32_16x16x32_bf16 a[76:79], a[212:215], v[28:31], a[76:79]
    v_exp_f32 v246, v246
    v_mfma_f32_16x16x32_bf16 a[76:79], a[216:219], v[44:47], a[76:79]
    v_cvt_pk_bf16_f32 v241, v242, v243
    v_add_f32 v221, v221, v244
    v_mfma_f32_16x16x32_bf16 a[76:79], a[220:223], v[60:63], a[76:79]
    v_add_f32 v221, v221, v245
    v_cvt_pk_bf16_f32 v244, v244, v245
    v_mfma_f32_16x16x32_bf16 a[28:31], a[220:223], v[56:59], a[28:31]
    ds_read_b64_tr_b16 a[196:197], v211 offset:12544
    ds_read_b64_tr_b16 a[198:199], v211 offset:18688
    v_mfma_f32_16x16x32_bf16 a[28:31], a[216:219], v[40:43], a[28:31]
    v_exp_f32 v247, v247
    v_mfma_f32_16x16x32_bf16 a[28:31], a[212:215], v[24:27], a[28:31]
    v_add_f32 v221, v221, v246
    v_add_f32 v221, v221, v247
    v_mfma_f32_16x16x32_bf16 a[28:31], a[208:211], v[8:11], a[28:31]
    v_exp_f32 v248, v248
    v_mfma_f32_16x16x32_bf16 v[188:191], a[208:211], v[4:7], v[188:191]
    ds_read_b64_tr_b16 a[200:201], v211 offset:24832
    ds_read_b64_tr_b16 a[202:203], v211 offset:30976
    v_mfma_f32_16x16x32_bf16 v[188:191], a[212:215], v[20:23], v[188:191]
    v_cvt_pk_bf16_f32 v245, v246, v247
    v_add_f32 v222, v222, v248
    v_mfma_f32_16x16x32_bf16 v[188:191], a[216:219], v[36:39], v[188:191]
    v_mfma_f32_16x16x32_bf16 v[188:191], a[220:223], v[52:55], v[188:191]
    v_exp_f32 v249, v249
    v_mfma_f32_16x16x32_bf16 v[140:143], a[220:223], v[48:51], v[140:143]
    ds_read_b64_tr_b16 a[204:205], v211 offset:37120
    ds_read_b64_tr_b16 a[206:207], v211 offset:43264
    v_mfma_f32_16x16x32_bf16 v[140:143], a[216:219], v[32:35], v[140:143]
    v_add_f32 v222, v222, v249
    v_cvt_pk_bf16_f32 v248, v248, v249
    v_mfma_f32_16x16x32_bf16 v[140:143], a[212:215], v[16:19], v[140:143]
    v_exp_f32 v250, v250
    v_mfma_f32_16x16x32_bf16 v[140:143], a[208:211], v[0:3], v[140:143]
    v_add_f32 v222, v222, v250
    s_waitcnt lgkmcnt(8)
    v_mfma_f32_16x16x32_bf16 v[144:147], a[224:227], v[0:3], v[144:147]
    ds_read_b64_tr_b16 a[208:209], v212 offset:256
    ds_read_b64_tr_b16 a[210:211], v212 offset:6400
    v_mfma_f32_16x16x32_bf16 v[144:147], a[228:231], v[16:19], v[144:147]
    v_exp_f32 v251, v251
    v_mfma_f32_16x16x32_bf16 v[144:147], a[232:235], v[32:35], v[144:147]
    v_add_f32 v222, v222, v251
    v_cvt_pk_bf16_f32 v249, v250, v251
    v_mfma_f32_16x16x32_bf16 v[144:147], a[236:239], v[48:51], v[144:147]
    v_mfma_f32_16x16x32_bf16 a[240:243], a[236:239], v[52:55], a[240:243]
    ds_read_b64_tr_b16 a[212:213], v212 offset:12544
    ds_read_b64_tr_b16 a[214:215], v212 offset:18688
    v_mfma_f32_16x16x32_bf16 a[240:243], a[232:235], v[36:39], a[240:243]
    v_exp_f32 v252, v252
    v_mfma_f32_16x16x32_bf16 a[240:243], a[228:231], v[20:23], a[240:243]
    v_add_f32 v223, v223, v252
    v_mfma_f32_16x16x32_bf16 a[240:243], a[224:227], v[4:7], a[240:243]
    v_mfma_f32_16x16x32_bf16 a[32:35], a[224:227], v[8:11], a[32:35]
    ds_read_b64_tr_b16 a[216:217], v212 offset:24832
    ds_read_b64_tr_b16 a[218:219], v212 offset:30976
    v_mfma_f32_16x16x32_bf16 a[32:35], a[228:231], v[24:27], a[32:35]
    v_exp_f32 v253, v253
    v_mfma_f32_16x16x32_bf16 a[32:35], a[232:235], v[40:43], a[32:35]
    v_add_f32 v223, v223, v253
    v_cvt_pk_bf16_f32 v252, v252, v253
    v_mfma_f32_16x16x32_bf16 a[32:35], a[236:239], v[56:59], a[32:35]
    v_exp_f32 v254, v254
    v_mfma_f32_16x16x32_bf16 a[80:83], a[236:239], v[60:63], a[80:83]
    ds_read_b64_tr_b16 a[220:221], v212 offset:37120
    ds_read_b64_tr_b16 a[222:223], v212 offset:43264
    v_mfma_f32_16x16x32_bf16 a[80:83], a[232:235], v[44:47], a[80:83]
    v_add_f32 v223, v223, v254
    v_mfma_f32_16x16x32_bf16 a[80:83], a[228:231], v[28:31], a[80:83]
    v_exp_f32 v255, v255
    v_mfma_f32_16x16x32_bf16 a[80:83], a[224:227], v[12:15], a[80:83]
    v_add_f32 v223, v223, v255
    s_waitcnt lgkmcnt(8)
    v_mfma_f32_16x16x32_bf16 a[84:87], a[192:195], v[12:15], a[84:87]
    ds_read_b64_tr_b16 a[224:225], v213 offset:256
    ds_read_b64_tr_b16 a[226:227], v213 offset:6400
    v_mfma_f32_16x16x32_bf16 a[84:87], a[196:199], v[28:31], a[84:87]
    v_exp_f32 v92, v92
    v_mfma_f32_16x16x32_bf16 a[84:87], a[200:203], v[44:47], a[84:87]
    v_cvt_pk_bf16_f32 v253, v254, v255
    v_add_f32 v223, v223, v92
    v_mfma_f32_16x16x32_bf16 a[84:87], a[204:207], v[60:63], a[84:87]
    v_mfma_f32_16x16x32_bf16 a[36:39], a[204:207], v[56:59], a[36:39]
    ds_read_b64_tr_b16 a[228:229], v213 offset:12544
    ds_read_b64_tr_b16 a[230:231], v213 offset:18688
    v_mfma_f32_16x16x32_bf16 a[36:39], a[200:203], v[40:43], a[36:39]
    v_exp_f32 v93, v93
    v_mfma_f32_16x16x32_bf16 a[36:39], a[196:199], v[24:27], a[36:39]
    v_add_f32 v223, v223, v93
    v_cvt_pk_bf16_f32 v254, v92, v93
    v_mfma_f32_16x16x32_bf16 a[36:39], a[192:195], v[8:11], a[36:39]
    v_mfma_f32_16x16x32_bf16 a[244:247], a[192:195], v[4:7], a[244:247]
    ds_read_b64_tr_b16 a[232:233], v213 offset:24832
    ds_read_b64_tr_b16 a[234:235], v213 offset:30976
    v_mfma_f32_16x16x32_bf16 a[244:247], a[196:199], v[20:23], a[244:247]
    v_exp_f32 v94, v94
    v_mfma_f32_16x16x32_bf16 a[244:247], a[200:203], v[36:39], a[244:247]
    v_add_f32 v223, v223, v94
    v_mfma_f32_16x16x32_bf16 a[244:247], a[204:207], v[52:55], a[244:247]
    v_exp_f32 v95, v95
    v_mfma_f32_16x16x32_bf16 v[148:151], a[204:207], v[48:51], v[148:151]
    ds_read_b64_tr_b16 a[236:237], v213 offset:37120
    ds_read_b64_tr_b16 a[238:239], v213 offset:43264
    v_mfma_f32_16x16x32_bf16 v[148:151], a[200:203], v[32:35], v[148:151]
    v_add_f32 v223, v223, v95
    v_cvt_pk_bf16_f32 v255, v94, v95
    v_mfma_f32_16x16x32_bf16 v[148:151], a[196:199], v[16:19], v[148:151]
    v_mfma_f32_16x16x32_bf16 v[148:151], a[192:195], v[0:3], v[148:151]
    s_waitcnt lgkmcnt(8)
    v_mfma_f32_16x16x32_bf16 v[152:155], a[208:211], v[0:3], v[152:155]
    v_exp_f32 v88, v88
    v_mfma_f32_16x16x32_bf16 v[152:155], a[212:215], v[16:19], v[152:155]
    v_add_f32 v222, v222, v88
    v_mfma_f32_16x16x32_bf16 v[152:155], a[216:219], v[32:35], v[152:155]
    v_exp_f32 v89, v89
    v_mfma_f32_16x16x32_bf16 v[152:155], a[220:223], v[48:51], v[152:155]
    v_add_f32 v222, v222, v89
    v_cvt_pk_bf16_f32 v250, v88, v89
    v_mfma_f32_16x16x32_bf16 a[248:251], a[220:223], v[52:55], a[248:251]
    v_mfma_f32_16x16x32_bf16 a[248:251], a[216:219], v[36:39], a[248:251]
    v_exp_f32 v90, v90
    v_mfma_f32_16x16x32_bf16 a[248:251], a[212:215], v[20:23], a[248:251]
    v_add_f32 v222, v222, v90
    v_mfma_f32_16x16x32_bf16 a[248:251], a[208:211], v[4:7], a[248:251]
    v_mfma_f32_16x16x32_bf16 a[40:43], a[208:211], v[8:11], a[40:43]
    v_exp_f32 v91, v91
    v_mfma_f32_16x16x32_bf16 a[40:43], a[212:215], v[24:27], a[40:43]
    v_add_f32 v222, v222, v91
    v_cvt_pk_bf16_f32 v251, v90, v91
    v_mfma_f32_16x16x32_bf16 a[40:43], a[216:219], v[40:43], a[40:43]
    v_mfma_f32_16x16x32_bf16 a[40:43], a[220:223], v[56:59], a[40:43]
    v_mfma_f32_16x16x32_bf16 a[88:91], a[220:223], v[60:63], a[88:91]
    v_exp_f32 v84, v84
    v_mfma_f32_16x16x32_bf16 a[88:91], a[216:219], v[44:47], a[88:91]
    v_add_f32 v221, v221, v84
    v_mfma_f32_16x16x32_bf16 a[88:91], a[212:215], v[28:31], a[88:91]
    v_mfma_f32_16x16x32_bf16 a[88:91], a[208:211], v[12:15], a[88:91]
    s_waitcnt vmcnt(6) lgkmcnt(0)
    s_barrier
    v_mfma_f32_16x16x32_bf16 a[92:95], a[224:227], v[12:15], a[92:95]
    ds_read_b128 a[192:195], v208 offset:24576
    ds_read_b128 a[196:199], v209 offset:24576
    v_mfma_f32_16x16x32_bf16 a[92:95], a[228:231], v[28:31], a[92:95]
    v_exp_f32 v85, v85
    v_mfma_f32_16x16x32_bf16 a[92:95], a[232:235], v[44:47], a[92:95]
    v_exp_f32 v86, v86
    v_mfma_f32_16x16x32_bf16 a[92:95], a[236:239], v[60:63], a[92:95]
    ds_read_b128 a[200:203], v208 offset:24704
    ds_read_b128 a[204:207], v209 offset:24704
    v_mfma_f32_16x16x32_bf16 a[44:47], a[236:239], v[56:59], a[44:47]
    v_add_f32 v221, v221, v85
    v_cvt_pk_bf16_f32 v246, v84, v85
    v_mfma_f32_16x16x32_bf16 a[44:47], a[232:235], v[40:43], a[44:47]
    v_add_f32 v221, v221, v86
    v_mfma_f32_16x16x32_bf16 a[44:47], a[228:231], v[24:27], a[44:47]
    ds_read_b128 a[208:211], v208 offset:24832
    ds_read_b128 a[212:215], v209 offset:24832
    v_mfma_f32_16x16x32_bf16 a[44:47], a[224:227], v[8:11], a[44:47]
    v_exp_f32 v87, v87
    v_mfma_f32_16x16x32_bf16 a[252:255], a[224:227], v[4:7], a[252:255]
    v_add_f32 v221, v221, v87
    v_cvt_pk_bf16_f32 v247, v86, v87
    v_mfma_f32_16x16x32_bf16 a[252:255], a[228:231], v[20:23], a[252:255]
    v_exp_f32 v80, v80
    v_mfma_f32_16x16x32_bf16 a[252:255], a[232:235], v[36:39], a[252:255]
    v_add_f32 v220, v220, v80
    v_mfma_f32_16x16x32_bf16 a[252:255], a[236:239], v[52:55], a[252:255]
    v_mfma_f32_16x16x32_bf16 v[156:159], a[236:239], v[48:51], v[156:159]
    s_cmp_eq_u32 s35, 8
    v_mfma_f32_16x16x32_bf16 v[156:159], a[232:235], v[32:35], v[156:159]
    v_exp_f32 v81, v81
    v_mfma_f32_16x16x32_bf16 v[156:159], a[228:231], v[16:19], v[156:159]
    v_add_f32 v220, v220, v81
    v_cvt_pk_bf16_f32 v242, v80, v81
    v_mfma_f32_16x16x32_bf16 v[156:159], a[224:227], v[0:3], v[156:159]
    s_waitcnt lgkmcnt(0)
    s_cbranch_scc1 L_tail
    v_mfma_f32_16x16x32_bf16 v[32:35], a[192:195], a[96:99], v[96:99]
    v_exp_f32 v82, v82
    v_mfma_f32_16x16x32_bf16 v[32:35], a[196:199], a[100:103], v[32:35]
    ds_read_b128 a[216:219], v208 offset:30720
    ds_read_b128 a[220:223], v209 offset:30720
    v_mfma_f32_16x16x32_bf16 v[32:35], a[200:203], a[104:107], v[32:35]
    v_add_f32 v220, v220, v82
    v_mfma_f32_16x16x32_bf16 v[32:35], a[204:207], a[108:111], v[32:35]
    s_add_u32 m0, s32, 49152
    v_mfma_f32_16x16x32_bf16 v[32:35], a[208:211], a[112:115], v[32:35]
    buffer_load_dwordx4 v217, s[24:27], s34 offen offset:0  lds
    v_mfma_f32_16x16x32_bf16 v[32:35], a[212:215], a[116:119], v[32:35]
    v_exp_f32 v83, v83
    v_mfma_f32_16x16x32_bf16 v[36:39], a[212:215], a[140:143], v[100:103]
    v_add_f32 v220, v220, v83
    v_cvt_pk_bf16_f32 v243, v82, v83
    v_mfma_f32_16x16x32_bf16 v[36:39], a[208:211], a[136:139], v[36:39]
    ds_read_b128 a[224:227], v208 offset:30848
    ds_read_b128 a[228:231], v209 offset:30848
    v_mfma_f32_16x16x32_bf16 v[36:39], a[204:207], a[132:135], v[36:39]
    v_mfma_f32_16x16x32_bf16 v[36:39], a[200:203], a[128:131], v[36:39]
    v_mfma_f32_16x16x32_bf16 v[36:39], a[196:199], a[124:127], v[36:39]
    buffer_load_dwordx4 v218, s[24:27], s34 offen offset:1024  lds
    v_mfma_f32_16x16x32_bf16 v[36:39], a[192:195], a[120:123], v[36:39]
    v_mfma_f32_16x16x32_bf16 v[40:43], a[192:195], a[144:147], v[104:107]
    v_exp_f32 v32, v32
    v_mfma_f32_16x16x32_bf16 v[40:43], a[196:199], a[148:151], v[40:43]
    ds_read_b128 a[232:235], v208 offset:30976
    ds_read_b128 a[236:239], v209 offset:30976
    v_mfma_f32_16x16x32_bf16 v[40:43], a[200:203], a[152:155], v[40:43]
    v_add_f32 v220, v220, v32
    v_mfma_f32_16x16x32_bf16 v[40:43], a[204:207], a[156:159], v[40:43]
    v_exp_f32 v33, v33
    v_mfma_f32_16x16x32_bf16 v[40:43], a[208:211], a[160:163], v[40:43]
    buffer_load_dwordx4 v219, s[24:27], s34 offen offset:2048  lds
    v_mfma_f32_16x16x32_bf16 v[40:43], a[212:215], a[164:167], v[40:43]
    v_exp_f32 v34, v34
    v_mfma_f32_16x16x32_bf16 v[44:47], a[212:215], a[188:191], v[108:111]
    v_add_f32 v220, v220, v33
    v_cvt_pk_bf16_f32 v32, v32, v33
    v_mfma_f32_16x16x32_bf16 v[44:47], a[208:211], a[184:187], v[44:47]
    v_add_f32 v220, v220, v34
    v_mfma_f32_16x16x32_bf16 v[44:47], a[204:207], a[180:183], v[44:47]
    v_exp_f32 v35, v35
    v_mfma_f32_16x16x32_bf16 v[44:47], a[200:203], a[176:179], v[44:47]
    s_add_u32 s34, s34, 12288
    s_add_u32 m0, s32, 61440
    v_mfma_f32_16x16x32_bf16 v[44:47], a[196:199], a[172:175], v[44:47]
    v_exp_f32 v36, v36
    v_mfma_f32_16x16x32_bf16 v[44:47], a[192:195], a[168:171], v[44:47]
    v_add_f32 v220, v220, v35
    s_waitcnt lgkmcnt(0)
    v_mfma_f32_16x16x32_bf16 v[76:79], a[216:219], a[168:171], v[108:111]
    v_cvt_pk_bf16_f32 v33, v34, v35
    v_add_f32 v221, v221, v36
    v_mfma_f32_16x16x32_bf16 v[76:79], a[220:223], a[172:175], v[76:79]
    ds_read_b128 a[192:195], v208 offset:36864
    ds_read_b128 a[196:199], v209 offset:36864
    v_mfma_f32_16x16x32_bf16 v[76:79], a[224:227], a[176:179], v[76:79]
    v_exp_f32 v37, v37
    v_mfma_f32_16x16x32_bf16 v[76:79], a[228:231], a[180:183], v[76:79]
    v_exp_f32 v38, v38
    v_mfma_f32_16x16x32_bf16 v[76:79], a[232:235], a[184:187], v[76:79]
    buffer_load_dwordx4 v217, s[24:27], s34 offen offset:0  lds
    v_mfma_f32_16x16x32_bf16 v[76:79], a[236:239], a[188:191], v[76:79]
    v_add_f32 v221, v221, v37
    v_cvt_pk_bf16_f32 v36, v36, v37
    v_mfma_f32_16x16x32_bf16 v[72:75], a[236:239], a[164:167], v[104:107]
    v_exp_f32 v39, v39
    v_mfma_f32_16x16x32_bf16 v[72:75], a[232:235], a[160:163], v[72:75]
    ds_read_b128 a[200:203], v208 offset:36992
    ds_read_b128 a[204:207], v209 offset:36992
    v_mfma_f32_16x16x32_bf16 v[72:75], a[228:231], a[156:159], v[72:75]
    v_exp_f32 v40, v40
    v_mfma_f32_16x16x32_bf16 v[72:75], a[224:227], a[152:155], v[72:75]
    v_add_f32 v221, v221, v38
    v_add_f32 v221, v221, v39
    v_mfma_f32_16x16x32_bf16 v[72:75], a[220:223], a[148:151], v[72:75]
    buffer_load_dwordx4 v218, s[24:27], s34 offen offset:1024  lds
    v_mfma_f32_16x16x32_bf16 v[72:75], a[216:219], a[144:147], v[72:75]
    v_exp_f32 v41, v41
    v_mfma_f32_16x16x32_bf16 v[68:71], a[216:219], a[120:123], v[100:103]
    v_cvt_pk_bf16_f32 v37, v38, v39
    v_add_f32 v222, v222, v40
    v_mfma_f32_16x16x32_bf16 v[68:71], a[220:223], a[124:127], v[68:71]
    ds_read_b128 a[208:211], v208 offset:37120
    ds_read_b128 a[212:215], v209 offset:37120
    v_mfma_f32_16x16x32_bf16 v[68:71], a[224:227], a[128:131], v[68:71]
    v_exp_f32 v42, v42
    v_mfma_f32_16x16x32_bf16 v[68:71], a[228:231], a[132:135], v[68:71]
    v_add_f32 v222, v222, v41
    v_cvt_pk_bf16_f32 v40, v40, v41
    v_mfma_f32_16x16x32_bf16 v[68:71], a[232:235], a[136:139], v[68:71]
    buffer_load_dwordx4 v219, s[24:27], s34 offen offset:2048  lds
    v_mfma_f32_16x16x32_bf16 v[68:71], a[236:239], a[140:143], v[68:71]
    v_exp_f32 v43, v43
    v_mfma_f32_16x16x32_bf16 v[64:67], a[236:239], a[116:119], v[96:99]
    v_add_f32 v222, v222, v42
    v_add_f32 v222, v222, v43
    v_mfma_f32_16x16x32_bf16 v[64:67], a[232:235], a[112:115], v[64:67]
    v_exp_f32 v44, v44
    v_mfma_f32_16x16x32_bf16 v[64:67], a[228:231], a[108:111], v[64:67]
    v_cvt_pk_bf16_f32 v41, v42, v43
    v_add_f32 v223, v223, v44
    v_mfma_f32_16x16x32_bf16 v[64:67], a[224:227], a[104:107], v[64:67]
    s_add_u32 s34, s34, 12288
    s_add_u32 m0, s32, 73728
    v_mfma_f32_16x16x32_bf16 v[64:67], a[220:223], a[100:103], v[64:67]
    v_exp_f32 v45, v45
    v_mfma_f32_16x16x32_bf16 v[64:67], a[216:219], a[96:99], v[64:67]
    v_add_f32 v223, v223, v45
    s_waitcnt lgkmcnt(0)
    v_mfma_f32_16x16x32_bf16 v[48:51], a[192:195], a[96:99], v[96:99]
    v_exp_f32 v46, v46
    v_mfma_f32_16x16x32_bf16 v[48:51], a[196:199], a[100:103], v[48:51]
    ds_read_b128 a[216:219], v208 offset:43008
    ds_read_b128 a[220:223], v209 offset:43008
    v_mfma_f32_16x16x32_bf16 v[48:51], a[200:203], a[104:107], v[48:51]
    v_exp_f32 v47, v47
    v_mfma_f32_16x16x32_bf16 v[48:51], a[204:207], a[108:111], v[48:51]
    v_cvt_pk_bf16_f32 v44, v44, v45
    v_add_f32 v223, v223, v46
    v_mfma_f32_16x16x32_bf16 v[48:51], a[208:211], a[112:115], v[48:51]
    buffer_load_dwordx4 v217, s[24:27], s34 offen offset:0  lds
    v_mfma_f32_16x16x32_bf16 v[48:51], a[212:215], a[116:119], v[48:51]
    v_exp_f32 v76, v76
    v_mfma_f32_16x16x32_bf16 v[52:55], a[212:215], a[140:143], v[100:103]
    v_add_f32 v223, v223, v47
    v_cvt_pk_bf16_f32 v45, v46, v47
    v_mfma_f32_16x16x32_bf16 v[52:55], a[208:211], a[136:139], v[52:55]
    ds_read_b128 a[224:227], v208 offset:43136
    ds_read_b128 a[228:231], v209 offset:43136
    v_mfma_f32_16x16x32_bf16 v[52:55], a[204:207], a[132:135], v[52:55]
    v_exp_f32 v77, v77
    v_mfma_f32_16x16x32_bf16 v[52:55], a[200:203], a[128:131], v[52:55]
    v_add_f32 v223, v223, v76
    v_add_f32 v223, v223, v77
    v_mfma_f32_16x16x32_bf16 v[52:55], a[196:199], a[124:127], v[52:55]
    buffer_load_dwordx4 v218, s[24:27], s34 offen offset:1024  lds
    v_mfma_f32_16x16x32_bf16 v[52:55], a[192:195], a[120:123], v[52:55]
    v_exp_f32 v78, v78
    v_mfma_f32_16x16x32_bf16 v[56:59], a[192:195], a[144:147], v[104:107]
    v_cvt_pk_bf16_f32 v46, v76, v77
    v_add_f32 v223, v223, v78
    v_mfma_f32_16x16x32_bf16 v[56:59], a[196:199], a[148:151], v[56:59]
    ds_read_b128 a[232:235], v208 offset:43264
    ds_read_b128 a[236:239], v209 offset:43264
    v_mfma_f32_16x16x32_bf16 v[56:59], a[200:203], a[152:155], v[56:59]
    v_exp_f32 v79, v79
    v_mfma_f32_16x16x32_bf16 v[56:59], a[204:207], a[156:159], v[56:59]
    v_exp_f32 v72, v72
    v_mfma_f32_16x16x32_bf16 v[56:59], a[208:211], a[160:163], v[56:59]
    buffer_load_dwordx4 v219, s[24:27], s34 offen offset:2048  lds
    v_mfma_f32_16x16x32_bf16 v[56:59], a[212:215], a[164:167], v[56:59]
    v_add_f32 v223, v223, v79
    v_cvt_pk_bf16_f32 v47, v78, v79
    v_mfma_f32_16x16x32_bf16 v[60:63], a[212:215], a[188:191], v[108:111]
    v_exp_f32 v73, v73
    v_mfma_f32_16x16x32_bf16 v[60:63], a[208:211], a[184:187], v[60:63]
    v_add_f32 v222, v222, v72
    v_add_f32 v222, v222, v73
    v_mfma_f32_16x16x32_bf16 v[60:63], a[204:207], a[180:183], v[60:63]
    v_exp_f32 v74, v74
    v_mfma_f32_16x16x32_bf16 v[60:63], a[200:203], a[176:179], v[60:63]
    s_add_u32 s34, s34, 12288
    s_add_u32 m0, s32, 86016
    v_mfma_f32_16x16x32_bf16 v[60:63], a[196:199], a[172:175], v[60:63]
    v_cvt_pk_bf16_f32 v42, v72, v73
    v_add_f32 v222, v222, v74
    v_mfma_f32_16x16x32_bf16 v[60:63], a[192:195], a[168:171], v[60:63]
    s_waitcnt vmcnt(9) lgkmcnt(0)
    s_barrier
    v_mfma_f32_16x16x32_bf16 v[92:95], a[216:219], a[168:171], v[108:111]
    v_exp_f32 v75, v75
    v_mfma_f32_16x16x32_bf16 v[92:95], a[220:223], a[172:175], v[92:95]
    ds_read_b128 a[192:195], v208 offset:0
    ds_read_b128 a[196:199], v209 offset:0
    v_mfma_f32_16x16x32_bf16 v[92:95], a[224:227], a[176:179], v[92:95]
    v_exp_f32 v68, v68
    v_mfma_f32_16x16x32_bf16 v[92:95], a[228:231], a[180:183], v[92:95]
    v_add_f32 v222, v222, v75
    v_cvt_pk_bf16_f32 v43, v74, v75
    v_mfma_f32_16x16x32_bf16 v[92:95], a[232:235], a[184:187], v[92:95]
    buffer_load_dwordx4 v217, s[24:27], s34 offen offset:0  lds
    v_mfma_f32_16x16x32_bf16 v[92:95], a[236:239], a[188:191], v[92:95]
    v_exp_f32 v69, v69
    v_mfma_f32_16x16x32_bf16 v[88:91], a[236:239], a[164:167], v[104:107]
    v_add_f32 v221, v221, v68
    v_add_f32 v221, v221, v69
    v_mfma_f32_16x16x32_bf16 v[88:91], a[232:235], a[160:163], v[88:91]
    ds_read_b128 a[200:203], v208 offset:128
    ds_read_b128 a[204:207], v209 offset:128
    v_mfma_f32_16x16x32_bf16 v[88:91], a[228:231], a[156:159], v[88:91]
    v_exp_f32 v70, v70
    v_mfma_f32_16x16x32_bf16 v[88:91], a[224:227], a[152:155], v[88:91]
    v_exp_f32 v71, v71
    v_mfma_f32_16x16x32_bf16 v[88:91], a[220:223], a[148:151], v[88:91]
    buffer_load_dwordx4 v218, s[24:27], s34 offen offset:1024  lds
    v_mfma_f32_16x16x32_bf16 v[88:91], a[216:219], a[144:147], v[88:91]
    v_cvt_pk_bf16_f32 v38, v68, v69
    v_add_f32 v221, v221, v70
    v_mfma_f32_16x16x32_bf16 v[84:87], a[216:219], a[120:123], v[100:103]
    v_exp_f32 v64, v64
    v_mfma_f32_16x16x32_bf16 v[84:87], a[220:223], a[124:127], v[84:87]
    ds_read_b128 a[208:211], v208 offset:256
    ds_read_b128 a[212:215], v209 offset:256
    v_mfma_f32_16x16x32_bf16 v[84:87], a[224:227], a[128:131], v[84:87]
    v_exp_f32 v65, v65
    v_mfma_f32_16x16x32_bf16 v[84:87], a[228:231], a[132:135], v[84:87]
    v_add_f32 v221, v221, v71
    v_cvt_pk_bf16_f32 v39, v70, v71
    v_mfma_f32_16x16x32_bf16 v[84:87], a[232:235], a[136:139], v[84:87]
    buffer_load_dwordx4 v219, s[24:27], s34 offen offset:2048  lds
    v_mfma_f32_16x16x32_bf16 v[84:87], a[236:239], a[140:143], v[84:87]
    v_exp_f32 v66, v66
    v_mfma_f32_16x16x32_bf16 v[80:83], a[236:239], a[116:119], v[96:99]
    v_add_f32 v220, v220, v64
    v_add_f32 v220, v220, v65
    v_mfma_f32_16x16x32_bf16 v[80:83], a[232:235], a[112:115], v[80:83]
    v_exp_f32 v67, v67
    v_mfma_f32_16x16x32_bf16 v[80:83], a[228:231], a[108:111], v[80:83]
    v_cvt_pk_bf16_f32 v34, v64, v65
    v_add_f32 v220, v220, v66
    v_mfma_f32_16x16x32_bf16 v[80:83], a[224:227], a[104:107], v[80:83]
    s_add_u32 s34, s34, 12288
    v_add_f32 v220, v220, v67
    v_mfma_f32_16x16x32_bf16 v[80:83], a[220:223], a[100:103], v[80:83]
    v_exp_f32 v48, v48
    v_mfma_f32_16x16x32_bf16 v[80:83], a[216:219], a[96:99], v[80:83]
    v_cvt_pk_bf16_f32 v35, v66, v67
    s_waitcnt lgkmcnt(0)
    v_mfma_f32_16x16x32_bf16 v[0:3], a[192:195], a[96:99], v[96:99]
    v_add_f32 v220, v220, v48
    v_mfma_f32_16x16x32_bf16 v[0:3], a[196:199], a[100:103], v[0:3]
    ds_read_b128 a[216:219], v208 offset:6144
    ds_read_b128 a[220:223], v209 offset:6144
    v_mfma_f32_16x16x32_bf16 v[0:3], a[200:203], a[104:107], v[0:3]
    v_exp_f32 v49, v49
    v_mfma_f32_16x16x32_bf16 v[0:3], a[204:207], a[108:111], v[0:3]
    v_exp_f32 v50, v50
    v_mfma_f32_16x16x32_bf16 v[0:3], a[208:211], a[112:115], v[0:3]
    v_add_f32 v220, v220, v49
    v_cvt_pk_bf16_f32 v48, v48, v49
    v_mfma_f32_16x16x32_bf16 v[0:3], a[212:215], a[116:119], v[0:3]
    v_add_f32 v220, v220, v50
    v_mfma_f32_16x16x32_bf16 v[4:7], a[212:215], a[140:143], v[100:103]
    v_exp_f32 v51, v51
    v_mfma_f32_16x16x32_bf16 v[4:7], a[208:211], a[136:139], v[4:7]
    ds_read_b128 a[224:227], v208 offset:6272
    ds_read_b128 a[228:231], v209 offset:6272
    v_mfma_f32_16x16x32_bf16 v[4:7], a[204:207], a[132:135], v[4:7]
    v_exp_f32 v52, v52
    v_mfma_f32_16x16x32_bf16 v[4:7], a[200:203], a[128:131], v[4:7]
    v_add_f32 v220, v220, v51
    v_cvt_pk_bf16_f32 v49, v50, v51
    v_mfma_f32_16x16x32_bf16 v[4:7], a[196:199], a[124:127], v[4:7]
    v_add_f32 v221, v221, v52
    v_mfma_f32_16x16x32_bf16 v[4:7], a[192:195], a[120:123], v[4:7]
    v_exp_f32 v53, v53
    v_mfma_f32_16x16x32_bf16 v[8:11], a[192:195], a[144:147], v[104:107]
    v_add_f32 v221, v221, v53
    v_cvt_pk_bf16_f32 v52, v52, v53
    v_mfma_f32_16x16x32_bf16 v[8:11], a[196:199], a[148:151], v[8:11]
    ds_read_b128 a[232:235], v208 offset:6400
    ds_read_b128 a[236:239], v209 offset:6400
    v_mfma_f32_16x16x32_bf16 v[8:11], a[200:203], a[152:155], v[8:11]
    v_exp_f32 v54, v54
    v_mfma_f32_16x16x32_bf16 v[8:11], a[204:207], a[156:159], v[8:11]
    v_add_f32 v221, v221, v54
    v_mfma_f32_16x16x32_bf16 v[8:11], a[208:211], a[160:163], v[8:11]
    v_exp_f32 v55, v55
    v_mfma_f32_16x16x32_bf16 v[8:11], a[212:215], a[164:167], v[8:11]
    v_add_f32 v221, v221, v55
    v_cvt_pk_bf16_f32 v53, v54, v55
    v_mfma_f32_16x16x32_bf16 v[12:15], a[212:215], a[188:191], v[108:111]
    v_exp_f32 v56, v56
    v_mfma_f32_16x16x32_bf16 v[12:15], a[208:211], a[184:187], v[12:15]
    v_add_f32 v222, v222, v56
    v_mfma_f32_16x16x32_bf16 v[12:15], a[204:207], a[180:183], v[12:15]
    v_mfma_f32_16x16x32_bf16 v[12:15], a[200:203], a[176:179], v[12:15]
    v_exp_f32 v57, v57
    v_mfma_f32_16x16x32_bf16 v[12:15], a[196:199], a[172:175], v[12:15]
    v_add_f32 v222, v222, v57
    v_cvt_pk_bf16_f32 v56, v56, v57
    v_mfma_f32_16x16x32_bf16 v[12:15], a[192:195], a[168:171], v[12:15]
    s_waitcnt lgkmcnt(0)
    v_mfma_f32_16x16x32_bf16 v[76:79], a[216:219], a[168:171], v[108:111]
    v_exp_f32 v58, v58
    v_mfma_f32_16x16x32_bf16 v[76:79], a[220:223], a[172:175], v[76:79]
    ds_read_b128 a[192:195], v208 offset:12288
    ds_read_b128 a[196:199], v209 offset:12288
    v_mfma_f32_16x16x32_bf16 v[76:79], a[224:227], a[176:179], v[76:79]
    v_exp_f32 v59, v59
    v_mfma_f32_16x16x32_bf16 v[76:79], a[228:231], a[180:183], v[76:79]
    v_add_f32 v222, v222, v58
    v_add_f32 v222, v222, v59
    v_mfma_f32_16x16x32_bf16 v[76:79], a[232:235], a[184:187], v[76:79]
    v_cvt_pk_bf16_f32 v57, v58, v59
    v_mfma_f32_16x16x32_bf16 v[76:79], a[236:239], a[188:191], v[76:79]
    v_exp_f32 v60, v60
    v_mfma_f32_16x16x32_bf16 v[72:75], a[236:239], a[164:167], v[104:107]
    v_add_f32 v223, v223, v60
    v_mfma_f32_16x16x32_bf16 v[72:75], a[232:235], a[160:163], v[72:75]
    ds_read_b128 a[200:203], v208 offset:12416
    ds_read_b128 a[204:207], v209 offset:12416
    v_mfma_f32_16x16x32_bf16 v[72:75], a[228:231], a[156:159], v[72:75]
    v_exp_f32 v61, v61
    v_mfma_f32_16x16x32_bf16 v[72:75], a[224:227], a[152:155], v[72:75]
    v_add_f32 v223, v223, v61
    v_cvt_pk_bf16_f32 v60, v60, v61
    v_mfma_f32_16x16x32_bf16 v[72:75], a[220:223], a[148:151], v[72:75]
    v_exp_f32 v62, v62
    v_mfma_f32_16x16x32_bf16 v[72:75], a[216:219], a[144:147], v[72:75]
    v_add_f32 v223, v223, v62
    v_mfma_f32_16x16x32_bf16 v[68:71], a[216:219], a[120:123], v[100:103]
    v_exp_f32 v63, v63
    v_mfma_f32_16x16x32_bf16 v[68:71], a[220:223], a[124:127], v[68:71]
    ds_read_b128 a[208:211], v208 offset:12544
    ds_read_b128 a[212:215], v209 offset:12544
    v_mfma_f32_16x16x32_bf16 v[68:71], a[224:227], a[128:131], v[68:71]
    v_add_f32 v223, v223, v63
    v_cvt_pk_bf16_f32 v61, v62, v63
    v_mfma_f32_16x16x32_bf16 v[68:71], a[228:231], a[132:135], v[68:71]
    v_exp_f32 v92, v92
    v_mfma_f32_16x16x32_bf16 v[68:71], a[232:235], a[136:139], v[68:71]
    v_add_f32 v223, v223, v92
    v_mfma_f32_16x16x32_bf16 v[68:71], a[236:239], a[140:143], v[68:71]
    v_mfma_f32_16x16x32_bf16 v[64:67], a[236:239], a[116:119], v[96:99]
    v_exp_f32 v93, v93
    v_mfma_f32_16x16x32_bf16 v[64:67], a[232:235], a[112:115], v[64:67]
    v_add_f32 v223, v223, v93
    v_cvt_pk_bf16_f32 v62, v92, v93
    v_mfma_f32_16x16x32_bf16 v[64:67], a[228:231], a[108:111], v[64:67]
    v_exp_f32 v94, v94
    v_mfma_f32_16x16x32_bf16 v[64:67], a[224:227], a[104:107], v[64:67]
    v_add_f32 v223, v223, v94
    v_mfma_f32_16x16x32_bf16 v[64:67], a[220:223], a[100:103], v[64:67]
    v_mfma_f32_16x16x32_bf16 v[64:67], a[216:219], a[96:99], v[64:67]
    s_waitcnt lgkmcnt(0)
    v_mfma_f32_16x16x32_bf16 v[16:19], a[192:195], a[96:99], v[96:99]
    v_exp_f32 v95, v95
    v_mfma_f32_16x16x32_bf16 v[16:19], a[196:199], a[100:103], v[16:19]
    ds_read_b128 a[216:219], v208 offset:18432
    ds_read_b128 a[220:223], v209 offset:18432
    v_mfma_f32_16x16x32_bf16 v[16:19], a[200:203], a[104:107], v[16:19]
    v_exp_f32 v88, v88
    v_mfma_f32_16x16x32_bf16 v[16:19], a[204:207], a[108:111], v[16:19]
    v_add_f32 v223, v223, v95
    v_cvt_pk_bf16_f32 v63, v94, v95
    v_mfma_f32_16x16x32_bf16 v[16:19], a[208:211], a[112:115], v[16:19]
    v_exp_f32 v89, v89
    v_mfma_f32_16x16x32_bf16 v[16:19], a[212:215], a[116:119], v[16:19]
    v_add_f32 v222, v222, v88
    v_add_f32 v222, v222, v89
    v_mfma_f32_16x16x32_bf16 v[20:23], a[212:215], a[140:143], v[100:103]
    v_exp_f32 v90, v90
    v_mfma_f32_16x16x32_bf16 v[20:23], a[208:211], a[136:139], v[20:23]
    ds_read_b128 a[224:227], v208 offset:18560
    ds_read_b128 a[228:231], v209 offset:18560
    v_mfma_f32_16x16x32_bf16 v[20:23], a[204:207], a[132:135], v[20:23]
    v_cvt_pk_bf16_f32 v58, v88, v89
    v_add_f32 v222, v222, v90
    v_mfma_f32_16x16x32_bf16 v[20:23], a[200:203], a[128:131], v[20:23]
    v_exp_f32 v91, v91
    v_mfma_f32_16x16x32_bf16 v[20:23], a[196:199], a[124:127], v[20:23]
    v_add_f32 v222, v222, v91
    v_cvt_pk_bf16_f32 v59, v90, v91
    v_mfma_f32_16x16x32_bf16 v[20:23], a[192:195], a[120:123], v[20:23]
    v_exp_f32 v84, v84
    v_mfma_f32_16x16x32_bf16 v[24:27], a[192:195], a[144:147], v[104:107]
    v_add_f32 v221, v221, v84
    v_mfma_f32_16x16x32_bf16 v[24:27], a[196:199], a[148:151], v[24:27]
    ds_read_b128 a[232:235], v208 offset:18688
    ds_read_b128 a[236:239], v209 offset:18688
    v_mfma_f32_16x16x32_bf16 v[24:27], a[200:203], a[152:155], v[24:27]
    v_exp_f32 v85, v85
    v_mfma_f32_16x16x32_bf16 v[24:27], a[204:207], a[156:159], v[24:27]
    v_add_f32 v221, v221, v85
    v_cvt_pk_bf16_f32 v54, v84, v85
    v_mfma_f32_16x16x32_bf16 v[24:27], a[208:211], a[160:163], v[24:27]
    v_mfma_f32_16x16x32_bf16 v[24:27], a[212:215], a[164:167], v[24:27]
    v_exp_f32 v86, v86
    v_mfma_f32_16x16x32_bf16 v[28:31], a[212:215], a[188:191], v[108:111]
    v_add_f32 v221, v221, v86
    v_mfma_f32_16x16x32_bf16 v[28:31], a[208:211], a[184:187], v[28:31]
    v_exp_f32 v87, v87
    v_mfma_f32_16x16x32_bf16 v[28:31], a[204:207], a[180:183], v[28:31]
    v_add_f32 v221, v221, v87
    v_cvt_pk_bf16_f32 v55, v86, v87
    v_mfma_f32_16x16x32_bf16 v[28:31], a[200:203], a[176:179], v[28:31]
    v_mfma_f32_16x16x32_bf16 v[28:31], a[196:199], a[172:175], v[28:31]
    v_exp_f32 v80, v80
    v_mfma_f32_16x16x32_bf16 v[28:31], a[192:195], a[168:171], v[28:31]
    s_waitcnt vmcnt(0) lgkmcnt(0)
    s_barrier
    v_mfma_f32_16x16x32_bf16 v[92:95], a[216:219], a[168:171], v[108:111]
    ds_read_b64_tr_b16 a[192:193], v210 offset:0
    ds_read_b64_tr_b16 a[194:195], v210 offset:6144
    v_mfma_f32_16x16x32_bf16 v[92:95], a[220:223], a[172:175], v[92:95]
    v_exp_f32 v81, v81
    v_mfma_f32_16x16x32_bf16 v[92:95], a[224:227], a[176:179], v[92:95]
    buffer_load_dword v226, v227, s[76:79], s82 offen
    v_mfma_f32_16x16x32_bf16 v[92:95], a[228:231], a[180:183], v[92:95]
    v_exp_f32 v82, v82
    v_mfma_f32_16x16x32_bf16 v[92:95], a[232:235], a[184:187], v[92:95]
    ds_read_b64_tr_b16 a[196:197], v210 offset:12288
    ds_read_b64_tr_b16 a[198:199], v210 offset:18432
    v_mfma_f32_16x16x32_bf16 v[92:95], a[236:239], a[188:191], v[92:95]
    v_exp_f32 v83, v83
    v_mfma_f32_16x16x32_bf16 v[88:91], a[236:239], a[164:167], v[104:107]
    s_add_u32 s82, s82, 65536
    v_mfma_f32_16x16x32_bf16 v[88:91], a[232:235], a[160:163], v[88:91]
    v_add_f32 v220, v220, v80
    v_add_f32 v220, v220, v81
    v_mfma_f32_16x16x32_bf16 v[88:91], a[228:231], a[156:159], v[88:91]
    ds_read_b64_tr_b16 a[200:201], v210 offset:24576
    ds_read_b64_tr_b16 a[202:203], v210 offset:30720
    v_mfma_f32_16x16x32_bf16 v[88:91], a[224:227], a[152:155], v[88:91]
    v_cvt_pk_bf16_f32 v50, v80, v81
    v_add_f32 v220, v220, v82
    v_mfma_f32_16x16x32_bf16 v[88:91], a[220:223], a[148:151], v[88:91]
    v_add_f32 v220, v220, v83
    v_cvt_pk_bf16_f32 v51, v82, v83
    v_mfma_f32_16x16x32_bf16 v[88:91], a[216:219], a[144:147], v[88:91]
    v_mfma_f32_16x16x32_bf16 v[84:87], a[216:219], a[120:123], v[100:103]
    ds_read_b64_tr_b16 a[204:205], v210 offset:36864
    ds_read_b64_tr_b16 a[206:207], v210 offset:43008
    v_mfma_f32_16x16x32_bf16 v[84:87], a[220:223], a[124:127], v[84:87]
    v_exp_f32 v0, v0
    v_mfma_f32_16x16x32_bf16 v[84:87], a[224:227], a[128:131], v[84:87]
    v_add_f32 v220, v220, v0
    v_mfma_f32_16x16x32_bf16 v[84:87], a[228:231], a[132:135], v[84:87]
    v_exp_f32 v1, v1
    v_mfma_f32_16x16x32_bf16 v[84:87], a[232:235], a[136:139], v[84:87]
    ds_read_b64_tr_b16 a[208:209], v211 offset:0
    ds_read_b64_tr_b16 a[210:211], v211 offset:6144
    v_mfma_f32_16x16x32_bf16 v[84:87], a[236:239], a[140:143], v[84:87]
    v_add_f32 v220, v220, v1
    v_cvt_pk_bf16_f32 v0, v0, v1
    v_mfma_f32_16x16x32_bf16 v[80:83], a[236:239], a[116:119], v[96:99]
    v_mfma_f32_16x16x32_bf16 v[80:83], a[232:235], a[112:115], v[80:83]
    v_exp_f32 v2, v2
    v_mfma_f32_16x16x32_bf16 v[80:83], a[228:231], a[108:111], v[80:83]
    ds_read_b64_tr_b16 a[212:213], v211 offset:12288
    ds_read_b64_tr_b16 a[214:215], v211 offset:18432
    v_mfma_f32_16x16x32_bf16 v[80:83], a[224:227], a[104:107], v[80:83]
    v_add_f32 v220, v220, v2
    v_mfma_f32_16x16x32_bf16 v[80:83], a[220:223], a[100:103], v[80:83]
    v_exp_f32 v3, v3
    v_mfma_f32_16x16x32_bf16 v[80:83], a[216:219], a[96:99], v[80:83]
    v_add_f32 v220, v220, v3
    s_waitcnt lgkmcnt(4)
    v_mfma_f32_16x16x32_bf16 v[112:115], a[192:195], v[192:195], v[112:115]
    ds_read_b64_tr_b16 a[216:217], v211 offset:24576
    ds_read_b64_tr_b16 a[218:219], v211 offset:30720
    v_mfma_f32_16x16x32_bf16 v[112:115], a[196:199], v[240:243], v[112:115]
    ds_read_b64_tr_b16 a[220:221], v211 offset:36864
    ds_read_b64_tr_b16 a[222:223], v211 offset:43008
    v_mfma_f32_16x16x32_bf16 v[112:115], a[200:203], v[32:35], v[112:115]
    v_exp_f32 v4, v4
    v_mfma_f32_16x16x32_bf16 v[112:115], a[204:207], v[48:51], v[112:115]
    v_cvt_pk_bf16_f32 v1, v2, v3
    v_add_f32 v221, v221, v4
    v_mfma_f32_16x16x32_bf16 v[160:163], a[204:207], v[52:55], v[160:163]
    ds_read_b64_tr_b16 a[224:225], v212 offset:0
    ds_read_b64_tr_b16 a[226:227], v212 offset:6144
    v_mfma_f32_16x16x32_bf16 v[160:163], a[200:203], v[36:39], v[160:163]
    v_exp_f32 v5, v5
    v_mfma_f32_16x16x32_bf16 v[160:163], a[196:199], v[244:247], v[160:163]
    v_add_f32 v221, v221, v5
    v_cvt_pk_bf16_f32 v4, v4, v5
    v_mfma_f32_16x16x32_bf16 v[160:163], a[192:195], v[196:199], v[160:163]
    ds_read_b64_tr_b16 a[228:229], v212 offset:12288
    ds_read_b64_tr_b16 a[230:231], v212 offset:18432
    v_mfma_f32_16x16x32_bf16 a[0:3], a[192:195], v[200:203], a[0:3]
    v_exp_f32 v6, v6
    v_mfma_f32_16x16x32_bf16 a[0:3], a[196:199], v[248:251], a[0:3]
    v_add_f32 v221, v221, v6
    v_mfma_f32_16x16x32_bf16 a[0:3], a[200:203], v[40:43], a[0:3]
    ds_read_b64_tr_b16 a[232:233], v212 offset:24576
    ds_read_b64_tr_b16 a[234:235], v212 offset:30720
    v_mfma_f32_16x16x32_bf16 a[0:3], a[204:207], v[56:59], a[0:3]
    v_exp_f32 v7, v7
    v_mfma_f32_16x16x32_bf16 a[48:51], a[204:207], v[60:63], a[48:51]
    v_add_f32 v221, v221, v7
    v_cvt_pk_bf16_f32 v5, v6, v7
    v_mfma_f32_16x16x32_bf16 a[48:51], a[200:203], v[44:47], a[48:51]
    ds_read_b64_tr_b16 a[236:237], v212 offset:36864
    ds_read_b64_tr_b16 a[238:239], v212 offset:43008
    v_mfma_f32_16x16x32_bf16 a[48:51], a[196:199], v[252:255], a[48:51]
    v_exp_f32 v8, v8
    v_mfma_f32_16x16x32_bf16 a[48:51], a[192:195], v[204:207], a[48:51]
    v_add_f32 v222, v222, v8
    s_waitcnt lgkmcnt(8)
    v_mfma_f32_16x16x32_bf16 a[52:55], a[208:211], v[204:207], a[52:55]
    ds_read_b64_tr_b16 a[192:193], v213 offset:0
    ds_read_b64_tr_b16 a[194:195], v213 offset:6144
    v_mfma_f32_16x16x32_bf16 a[52:55], a[212:215], v[252:255], a[52:55]
    s_add_u32 m0, s32, 24576
    v_mfma_f32_16x16x32_bf16 a[52:55], a[216:219], v[44:47], a[52:55]
    buffer_load_dwordx4 v214, s[20:23], s33 offen offset:0  lds
    v_mfma_f32_16x16x32_bf16 a[52:55], a[220:223], v[60:63], a[52:55]
    v_exp_f32 v9, v9
    v_mfma_f32_16x16x32_bf16 a[4:7], a[220:223], v[56:59], a[4:7]
    ds_read_b64_tr_b16 a[196:197], v213 offset:12288
    ds_read_b64_tr_b16 a[198:199], v213 offset:18432
    v_mfma_f32_16x16x32_bf16 a[4:7], a[216:219], v[40:43], a[4:7]
    v_exp_f32 v10, v10
    v_mfma_f32_16x16x32_bf16 a[4:7], a[212:215], v[248:251], a[4:7]
    v_add_f32 v222, v222, v9
    v_cvt_pk_bf16_f32 v8, v8, v9
    v_mfma_f32_16x16x32_bf16 a[4:7], a[208:211], v[200:203], a[4:7]
    v_add_f32 v222, v222, v10
    v_mfma_f32_16x16x32_bf16 v[164:167], a[208:211], v[196:199], v[164:167]
    ds_read_b64_tr_b16 a[200:201], v213 offset:24576
    ds_read_b64_tr_b16 a[202:203], v213 offset:30720
    v_mfma_f32_16x16x32_bf16 v[164:167], a[212:215], v[244:247], v[164:167]
    v_exp_f32 v11, v11
    v_mfma_f32_16x16x32_bf16 v[164:167], a[216:219], v[36:39], v[164:167]
    buffer_load_dwordx4 v215, s[20:23], s33 offen offset:1024  lds
    v_mfma_f32_16x16x32_bf16 v[164:167], a[220:223], v[52:55], v[164:167]
    v_exp_f32 v12, v12
    v_mfma_f32_16x16x32_bf16 v[116:119], a[220:223], v[48:51], v[116:119]
    ds_read_b64_tr_b16 a[204:205], v213 offset:36864
    ds_read_b64_tr_b16 a[206:207], v213 offset:43008
    v_mfma_f32_16x16x32_bf16 v[116:119], a[216:219], v[32:35], v[116:119]
    v_add_f32 v222, v222, v11
    v_cvt_pk_bf16_f32 v9, v10, v11
    v_mfma_f32_16x16x32_bf16 v[116:119], a[212:215], v[240:243], v[116:119]
    v_add_f32 v223, v223, v12
    v_mfma_f32_16x16x32_bf16 v[116:119], a[208:211], v[192:195], v[116:119]
    s_waitcnt lgkmcnt(8)
    v_mfma_f32_16x16x32_bf16 v[120:123], a[224:227], v[192:195], v[120:123]
    ds_read_b64_tr_b16 a[208:209], v210 offset:128
    ds_read_b64_tr_b16 a[210:211], v210 offset:6272
    v_mfma_f32_16x16x32_bf16 v[120:123], a[228:231], v[240:243], v[120:123]
    v_exp_f32 v13, v13
    v_mfma_f32_16x16x32_bf16 v[120:123], a[232:235], v[32:35], v[120:123]
    buffer_load_dwordx4 v216, s[20:23], s33 offen offset:2048  lds
    v_mfma_f32_16x16x32_bf16 v[120:123], a[236:239], v[48:51], v[120:123]
    v_exp_f32 v14, v14
    v_mfma_f32_16x16x32_bf16 v[168:171], a[236:239], v[52:55], v[168:171]
    ds_read_b64_tr_b16 a[212:213], v210 offset:12416
    ds_read_b64_tr_b16 a[214:215], v210 offset:18560
    v_mfma_f32_16x16x32_bf16 v[168:171], a[232:235], v[36:39], v[168:171]
    v_exp_f32 v15, v15
    v_mfma_f32_16x16x32_bf16 v[168:171], a[228:231], v[244:247], v[168:171]
    s_add_u32 s33, s33, 12288
    s_add_u32 m0, s32, 36864
    v_mfma_f32_16x16x32_bf16 v[168:171], a[224:227], v[196:199], v[168:171]
    v_add_f32 v223, v223, v13
    v_cvt_pk_bf16_f32 v12, v12, v13
    v_mfma_f32_16x16x32_bf16 a[8:11], a[224:227], v[200:203], a[8:11]
    ds_read_b64_tr_b16 a[216:217], v210 offset:24704
    ds_read_b64_tr_b16 a[218:219], v210 offset:30848
    v_mfma_f32_16x16x32_bf16 a[8:11], a[228:231], v[248:251], a[8:11]
    v_exp_f32 v76, v76
    v_mfma_f32_16x16x32_bf16 a[8:11], a[232:235], v[40:43], a[8:11]
    buffer_load_dwordx4 v214, s[20:23], s33 offen offset:0  lds
    v_mfma_f32_16x16x32_bf16 a[8:11], a[236:239], v[56:59], a[8:11]
    v_add_f32 v223, v223, v14
    v_add_f32 v223, v223, v15
    v_mfma_f32_16x16x32_bf16 a[56:59], a[236:239], v[60:63], a[56:59]
    ds_read_b64_tr_b16 a[220:221], v210 offset:36992
    ds_read_b64_tr_b16 a[222:223], v210 offset:43136
    v_mfma_f32_16x16x32_bf16 a[56:59], a[232:235], v[44:47], a[56:59]
    v_exp_f32 v77, v77
    v_mfma_f32_16x16x32_bf16 a[56:59], a[228:231], v[252:255], a[56:59]
    v_cvt_pk_bf16_f32 v13, v14, v15
    v_add_f32 v223, v223, v76
    v_mfma_f32_16x16x32_bf16 a[56:59], a[224:227], v[204:207], a[56:59]
    v_add_f32 v223, v223, v77
    s_waitcnt lgkmcnt(8)
    v_mfma_f32_16x16x32_bf16 a[60:63], a[192:195], v[204:207], a[60:63]
    ds_read_b64_tr_b16 a[224:225], v211 offset:128
    ds_read_b64_tr_b16 a[226:227], v211 offset:6272
    v_mfma_f32_16x16x32_bf16 a[60:63], a[196:199], v[252:255], a[60:63]
    v_exp_f32 v78, v78
    v_mfma_f32_16x16x32_bf16 a[60:63], a[200:203], v[44:47], a[60:63]
    buffer_load_dwordx4 v215, s[20:23], s33 offen offset:1024  lds
    v_mfma_f32_16x16x32_bf16 a[60:63], a[204:207], v[60:63], a[60:63]
    v_exp_f32 v79, v79
    v_mfma_f32_16x16x32_bf16 a[12:15], a[204:207], v[56:59], a[12:15]
    ds_read_b64_tr_b16 a[228:229], v211 offset:12416
    ds_read_b64_tr_b16 a[230:231], v211 offset:18560
    v_mfma_f32_16x16x32_bf16 a[12:15], a[200:203], v[40:43], a[12:15]
    v_cvt_pk_bf16_f32 v14, v76, v77
    v_add_f32 v223, v223, v78
    v_mfma_f32_16x16x32_bf16 a[12:15], a[196:199], v[248:251], a[12:15]
    v_exp_f32 v72, v72
    v_mfma_f32_16x16x32_bf16 a[12:15], a[192:195], v[200:203], a[12:15]
    v_add_f32 v223, v223, v79
    v_cvt_pk_bf16_f32 v15, v78, v79
    v_mfma_f32_16x16x32_bf16 v[172:175], a[192:195], v[196:199], v[172:175]
    ds_read_b64_tr_b16 a[232:233], v211 offset:24704
    ds_read_b64_tr_b16 a[234:235], v211 offset:30848
    v_mfma_f32_16x16x32_bf16 v[172:175], a[196:199], v[244:247], v[172:175]
    v_exp_f32 v73, v73
    v_mfma_f32_16x16x32_bf16 v[172:175], a[200:203], v[36:39], v[172:175]
    buffer_load_dwordx4 v216, s[20:23], s33 offen offset:2048  lds
    v_mfma_f32_16x16x32_bf16 v[172:175], a[204:207], v[52:55], v[172:175]
    v_add_f32 v222, v222, v72
    v_add_f32 v222, v222, v73
    v_mfma_f32_16x16x32_bf16 v[124:127], a[204:207], v[48:51], v[124:127]
    ds_read_b64_tr_b16 a[236:237], v211 offset:36992
    ds_read_b64_tr_b16 a[238:239], v211 offset:43136
    v_mfma_f32_16x16x32_bf16 v[124:127], a[200:203], v[32:35], v[124:127]
    s_add_u32 s33, s33, 12288
    v_cvt_pk_bf16_f32 v10, v72, v73
    v_mfma_f32_16x16x32_bf16 v[124:127], a[196:199], v[240:243], v[124:127]
    v_mfma_f32_16x16x32_bf16 v[124:127], a[192:195], v[192:195], v[124:127]
    s_waitcnt lgkmcnt(8)
    v_mfma_f32_16x16x32_bf16 v[128:131], a[208:211], v[192:195], v[128:131]
    ds_read_b64_tr_b16 a[192:193], v212 offset:128
    ds_read_b64_tr_b16 a[194:195], v212 offset:6272
    v_mfma_f32_16x16x32_bf16 v[128:131], a[212:215], v[240:243], v[128:131]
    s_add_u32 m0, s32, 0
    v_mfma_f32_16x16x32_bf16 v[128:131], a[216:219], v[32:35], v[128:131]
    buffer_load_dwordx4 v214, s[20:23], s33 offen offset:0  lds
    v_mfma_f32_16x16x32_bf16 v[128:131], a[220:223], v[48:51], v[128:131]
    v_exp_f32 v74, v74
    v_mfma_f32_16x16x32_bf16 v[176:179], a[220:223], v[52:55], v[176:179]
    ds_read_b64_tr_b16 a[196:197], v212 offset:12416
    ds_read_b64_tr_b16 a[198:199], v212 offset:18560
    v_mfma_f32_16x16x32_bf16 v[176:179], a[216:219], v[36:39], v[176:179]
    v_exp_f32 v75, v75
    v_mfma_f32_16x16x32_bf16 v[176:179], a[212:215], v[244:247], v[176:179]
    v_exp_f32 v68, v68
    v_mfma_f32_16x16x32_bf16 v[176:179], a[208:211], v[196:199], v[176:179]
    v_exp_f32 v69, v69
    v_mfma_f32_16x16x32_bf16 a[16:19], a[208:211], v[200:203], a[16:19]
    ds_read_b64_tr_b16 a[200:201], v212 offset:24704
    ds_read_b64_tr_b16 a[202:203], v212 offset:30848
    v_mfma_f32_16x16x32_bf16 a[16:19], a[212:215], v[248:251], a[16:19]
    v_exp_f32 v70, v70
    v_mfma_f32_16x16x32_bf16 a[16:19], a[216:219], v[40:43], a[16:19]
    buffer_load_dwordx4 v215, s[20:23], s33 offen offset:1024  lds
    v_mfma_f32_16x16x32_bf16 a[16:19], a[220:223], v[56:59], a[16:19]
    v_add_f32 v222, v222, v74
    v_add_f32 v222, v222, v75
    v_mfma_f32_16x16x32_bf16 a[64:67], a[220:223], v[60:63], a[64:67]
    ds_read_b64_tr_b16 a[204:205], v212 offset:36992
    ds_read_b64_tr_b16 a[206:207], v212 offset:43136
    v_mfma_f32_16x16x32_bf16 a[64:67], a[216:219], v[44:47], a[64:67]
    v_exp_f32 v71, v71
    v_mfma_f32_16x16x32_bf16 a[64:67], a[212:215], v[252:255], a[64:67]
    v_cvt_pk_bf16_f32 v11, v74, v75
    v_add_f32 v221, v221, v68
    v_mfma_f32_16x16x32_bf16 a[64:67], a[208:211], v[204:207], a[64:67]
    v_add_f32 v221, v221, v69
    s_waitcnt lgkmcnt(8)
    v_mfma_f32_16x16x32_bf16 a[68:71], a[224:227], v[204:207], a[68:71]
    ds_read_b64_tr_b16 a[208:209], v213 offset:128
    ds_read_b64_tr_b16 a[210:211], v213 offset:6272
    v_mfma_f32_16x16x32_bf16 a[68:71], a[228:231], v[252:255], a[68:71]
    v_exp_f32 v64, v64
    v_mfma_f32_16x16x32_bf16 a[68:71], a[232:235], v[44:47], a[68:71]
    buffer_load_dwordx4 v216, s[20:23], s33 offen offset:2048  lds
    v_mfma_f32_16x16x32_bf16 a[68:71], a[236:239], v[60:63], a[68:71]
    v_exp_f32 v65, v65
    v_mfma_f32_16x16x32_bf16 a[20:23], a[236:239], v[56:59], a[20:23]
    ds_read_b64_tr_b16 a[212:213], v213 offset:12416
    ds_read_b64_tr_b16 a[214:215], v213 offset:18560
    v_mfma_f32_16x16x32_bf16 a[20:23], a[232:235], v[40:43], a[20:23]
    v_cvt_pk_bf16_f32 v6, v68, v69
    v_add_f32 v221, v221, v70
    v_mfma_f32_16x16x32_bf16 a[20:23], a[228:231], v[248:251], a[20:23]
    s_add_u32 s33, s33, 12288
    s_add_u32 m0, s32, 12288
    v_mfma_f32_16x16x32_bf16 a[20:23], a[224:227], v[200:203], a[20:23]
    v_exp_f32 v66, v66
    v_mfma_f32_16x16x32_bf16 v[180:183], a[224:227], v[196:199], v[180:183]
    ds_read_b64_tr_b16 a[216:217], v213 offset:24704
    ds_read_b64_tr_b16 a[218:219], v213 offset:30848
    v_mfma_f32_16x16x32_bf16 v[180:183], a[228:231], v[244:247], v[180:183]
    v_add_f32 v221, v221, v71
    v_cvt_pk_bf16_f32 v7, v70, v71
    v_mfma_f32_16x16x32_bf16 v[180:183], a[232:235], v[36:39], v[180:183]
    buffer_load_dwordx4 v214, s[20:23], s33 offen offset:0  lds
    v_mfma_f32_16x16x32_bf16 v[180:183], a[236:239], v[52:55], v[180:183]
    v_exp_f32 v67, v67
    v_mfma_f32_16x16x32_bf16 v[132:135], a[236:239], v[48:51], v[132:135]
    ds_read_b64_tr_b16 a[220:221], v213 offset:36992
    ds_read_b64_tr_b16 a[222:223], v213 offset:43136
    v_mfma_f32_16x16x32_bf16 v[132:135], a[232:235], v[32:35], v[132:135]
    v_exp_f32 v16, v16
    v_mfma_f32_16x16x32_bf16 v[132:135], a[228:231], v[240:243], v[132:135]
    v_add_f32 v220, v220, v64
    v_add_f32 v220, v220, v65
    v_mfma_f32_16x16x32_bf16 v[132:135], a[224:227], v[192:195], v[132:135]
    v_cvt_pk_bf16_f32 v2, v64, v65
    s_waitcnt lgkmcnt(8)
    v_mfma_f32_16x16x32_bf16 v[136:139], a[192:195], v[192:195], v[136:139]
    ds_read_b64_tr_b16 a[224:225], v210 offset:256
    ds_read_b64_tr_b16 a[226:227], v210 offset:6400
    v_mfma_f32_16x16x32_bf16 v[136:139], a[196:199], v[240:243], v[136:139]
    v_exp_f32 v17, v17
    v_mfma_f32_16x16x32_bf16 v[136:139], a[200:203], v[32:35], v[136:139]
    buffer_load_dwordx4 v215, s[20:23], s33 offen offset:1024  lds
    v_mfma_f32_16x16x32_bf16 v[136:139], a[204:207], v[48:51], v[136:139]
    v_add_f32 v220, v220, v66
    v_add_f32 v220, v220, v67
    v_mfma_f32_16x16x32_bf16 v[184:187], a[204:207], v[52:55], v[184:187]
    ds_read_b64_tr_b16 a[228:229], v210 offset:12544
    ds_read_b64_tr_b16 a[230:231], v210 offset:18688
    v_mfma_f32_16x16x32_bf16 v[184:187], a[200:203], v[36:39], v[184:187]
    v_exp_f32 v18, v18
    v_mfma_f32_16x16x32_bf16 v[184:187], a[196:199], v[244:247], v[184:187]
    v_cvt_pk_bf16_f32 v3, v66, v67
    v_add_f32 v220, v220, v16
    v_mfma_f32_16x16x32_bf16 v[184:187], a[192:195], v[196:199], v[184:187]
    v_exp_f32 v19, v19
    v_mfma_f32_16x16x32_bf16 a[24:27], a[192:195], v[200:203], a[24:27]
    ds_read_b64_tr_b16 a[232:233], v210 offset:24832
    ds_read_b64_tr_b16 a[234:235], v210 offset:30976
    v_mfma_f32_16x16x32_bf16 a[24:27], a[196:199], v[248:251], a[24:27]
    v_add_f32 v220, v220, v17
    v_cvt_pk_bf16_f32 v16, v16, v17
    v_mfma_f32_16x16x32_bf16 a[24:27], a[200:203], v[40:43], a[24:27]
    buffer_load_dwordx4 v216, s[20:23], s33 offen offset:2048  lds
    v_mfma_f32_16x16x32_bf16 a[24:27], a[204:207], v[56:59], a[24:27]
    v_exp_f32 v20, v20
    v_mfma_f32_16x16x32_bf16 a[72:75], a[204:207], v[60:63], a[72:75]
    ds_read_b64_tr_b16 a[236:237], v210 offset:37120
    ds_read_b64_tr_b16 a[238:239], v210 offset:43264
    v_mfma_f32_16x16x32_bf16 a[72:75], a[200:203], v[44:47], a[72:75]
    v_exp_f32 v21, v21
    v_mfma_f32_16x16x32_bf16 a[72:75], a[196:199], v[252:255], a[72:75]
    s_add_u32 s33, s33, 12288
    v_add_f32 v220, v220, v18
    v_mfma_f32_16x16x32_bf16 a[72:75], a[192:195], v[204:207], a[72:75]
    v_add_f32 v220, v220, v19
    s_waitcnt lgkmcnt(8)
    v_mfma_f32_16x16x32_bf16 a[76:79], a[208:211], v[204:207], a[76:79]
    ds_read_b64_tr_b16 a[192:193], v211 offset:256
    ds_read_b64_tr_b16 a[194:195], v211 offset:6400
    v_mfma_f32_16x16x32_bf16 a[76:79], a[212:215], v[252:255], a[76:79]
    v_exp_f32 v22, v22
    v_mfma_f32_16x16x32_bf16 a[76:79], a[216:219], v[44:47], a[76:79]
    v_cvt_pk_bf16_f32 v17, v18, v19
    v_add_f32 v221, v221, v20
    v_mfma_f32_16x16x32_bf16 a[76:79], a[220:223], v[60:63], a[76:79]
    v_add_f32 v221, v221, v21
    v_cvt_pk_bf16_f32 v20, v20, v21
    v_mfma_f32_16x16x32_bf16 a[28:31], a[220:223], v[56:59], a[28:31]
    ds_read_b64_tr_b16 a[196:197], v211 offset:12544
    ds_read_b64_tr_b16 a[198:199], v211 offset:18688
    v_mfma_f32_16x16x32_bf16 a[28:31], a[216:219], v[40:43], a[28:31]
    v_exp_f32 v23, v23
    v_mfma_f32_16x16x32_bf16 a[28:31], a[212:215], v[248:251], a[28:31]
    v_add_f32 v221, v221, v22
    v_add_f32 v221, v221, v23
    v_mfma_f32_16x16x32_bf16 a[28:31], a[208:211], v[200:203], a[28:31]
    v_exp_f32 v24, v24
    v_mfma_f32_16x16x32_bf16 v[188:191], a[208:211], v[196:199], v[188:191]
    ds_read_b64_tr_b16 a[200:201], v211 offset:24832
    ds_read_b64_tr_b16 a[202:203], v211 offset:30976
    v_mfma_f32_16x16x32_bf16 v[188:191], a[212:215], v[244:247], v[188:191]
    v_cvt_pk_bf16_f32 v21, v22, v23
    v_add_f32 v222, v222, v24
    v_mfma_f32_16x16x32_bf16 v[188:191], a[216:219], v[36:39], v[188:191]
    v_mfma_f32_16x16x32_bf16 v[188:191], a[220:223], v[52:55], v[188:191]
    v_exp_f32 v25, v25
    v_mfma_f32_16x16x32_bf16 v[140:143], a[220:223], v[48:51], v[140:143]
    ds_read_b64_tr_b16 a[204:205], v211 offset:37120
    ds_read_b64_tr_b16 a[206:207], v211 offset:43264
    v_mfma_f32_16x16x32_bf16 v[140:143], a[216:219], v[32:35], v[140:143]
    v_add_f32 v222, v222, v25
    v_cvt_pk_bf16_f32 v24, v24, v25
    v_mfma_f32_16x16x32_bf16 v[140:143], a[212:215], v[240:243], v[140:143]
    v_exp_f32 v26, v26
    v_mfma_f32_16x16x32_bf16 v[140:143], a[208:211], v[192:195], v[140:143]
    v_add_f32 v222, v222, v26
    s_waitcnt lgkmcnt(8)
    v_mfma_f32_16x16x32_bf16 v[144:147], a[224:227], v[192:195], v[144:147]
    ds_read_b64_tr_b16 a[208:209], v212 offset:256
    ds_read_b64_tr_b16 a[210:211], v212 offset:6400
    v_mfma_f32_16x16x32_bf16 v[144:147], a[228:231], v[240:243], v[144:147]
    v_exp_f32 v27, v27
    v_mfma_f32_16x16x32_bf16 v[144:147], a[232:235], v[32:35], v[144:147]
    v_add_f32 v222, v222, v27
    v_cvt_pk_bf16_f32 v25, v26, v27
    v_mfma_f32_16x16x32_bf16 v[144:147], a[236:239], v[48:51], v[144:147]
    v_mfma_f32_16x16x32_bf16 a[240:243], a[236:239], v[52:55], a[240:243]
    ds_read_b64_tr_b16 a[212:213], v212 offset:12544
    ds_read_b64_tr_b16 a[214:215], v212 offset:18688
    v_mfma_f32_16x16x32_bf16 a[240:243], a[232:235], v[36:39], a[240:243]
    v_exp_f32 v28, v28
    v_mfma_f32_16x16x32_bf16 a[240:243], a[228:231], v[244:247], a[240:243]
    v_add_f32 v223, v223, v28
    v_mfma_f32_16x16x32_bf16 a[240:243], a[224:227], v[196:199], a[240:243]
    v_mfma_f32_16x16x32_bf16 a[32:35], a[224:227], v[200:203], a[32:35]
    ds_read_b64_tr_b16 a[216:217], v212 offset:24832
    ds_read_b64_tr_b16 a[218:219], v212 offset:30976
    v_mfma_f32_16x16x32_bf16 a[32:35], a[228:231], v[248:251], a[32:35]
    v_exp_f32 v29, v29
    v_mfma_f32_16x16x32_bf16 a[32:35], a[232:235], v[40:43], a[32:35]
    v_add_f32 v223, v223, v29
    v_cvt_pk_bf16_f32 v28, v28, v29
    v_mfma_f32_16x16x32_bf16 a[32:35], a[236:239], v[56:59], a[32:35]
    v_exp_f32 v30, v30
    v_mfma_f32_16x16x32_bf16 a[80:83], a[236:239], v[60:63], a[80:83]
    ds_read_b64_tr_b16 a[220:221], v212 offset:37120
    ds_read_b64_tr_b16 a[222:223], v212 offset:43264
    v_mfma_f32_16x16x32_bf16 a[80:83], a[232:235], v[44:47], a[80:83]
    v_add_f32 v223, v223, v30
    v_mfma_f32_16x16x32_bf16 a[80:83], a[228:231], v[252:255], a[80:83]
    v_exp_f32 v31, v31
    v_mfma_f32_16x16x32_bf16 a[80:83], a[224:227], v[204:207], a[80:83]
    v_add_f32 v223, v223, v31
    s_waitcnt lgkmcnt(8)
    v_mfma_f32_16x16x32_bf16 a[84:87], a[192:195], v[204:207], a[84:87]
    ds_read_b64_tr_b16 a[224:225], v213 offset:256
    ds_read_b64_tr_b16 a[226:227], v213 offset:6400
    v_mfma_f32_16x16x32_bf16 a[84:87], a[196:199], v[252:255], a[84:87]
    v_exp_f32 v92, v92
    v_mfma_f32_16x16x32_bf16 a[84:87], a[200:203], v[44:47], a[84:87]
    v_cvt_pk_bf16_f32 v29, v30, v31
    v_add_f32 v223, v223, v92
    v_mfma_f32_16x16x32_bf16 a[84:87], a[204:207], v[60:63], a[84:87]
    v_mfma_f32_16x16x32_bf16 a[36:39], a[204:207], v[56:59], a[36:39]
    ds_read_b64_tr_b16 a[228:229], v213 offset:12544
    ds_read_b64_tr_b16 a[230:231], v213 offset:18688
    v_mfma_f32_16x16x32_bf16 a[36:39], a[200:203], v[40:43], a[36:39]
    v_exp_f32 v93, v93
    v_mfma_f32_16x16x32_bf16 a[36:39], a[196:199], v[248:251], a[36:39]
    v_add_f32 v223, v223, v93
    v_cvt_pk_bf16_f32 v30, v92, v93
    v_mfma_f32_16x16x32_bf16 a[36:39], a[192:195], v[200:203], a[36:39]
    v_mfma_f32_16x16x32_bf16 a[244:247], a[192:195], v[196:199], a[244:247]
    ds_read_b64_tr_b16 a[232:233], v213 offset:24832
    ds_read_b64_tr_b16 a[234:235], v213 offset:30976
    v_mfma_f32_16x16x32_bf16 a[244:247], a[196:199], v[244:247], a[244:247]
    v_exp_f32 v94, v94
    v_mfma_f32_16x16x32_bf16 a[244:247], a[200:203], v[36:39], a[244:247]
    v_add_f32 v223, v223, v94
    v_mfma_f32_16x16x32_bf16 a[244:247], a[204:207], v[52:55], a[244:247]
    v_exp_f32 v95, v95
    v_mfma_f32_16x16x32_bf16 v[148:151], a[204:207], v[48:51], v[148:151]
    ds_read_b64_tr_b16 a[236:237], v213 offset:37120
    ds_read_b64_tr_b16 a[238:239], v213 offset:43264
    v_mfma_f32_16x16x32_bf16 v[148:151], a[200:203], v[32:35], v[148:151]
    v_add_f32 v223, v223, v95
    v_cvt_pk_bf16_f32 v31, v94, v95
    v_mfma_f32_16x16x32_bf16 v[148:151], a[196:199], v[240:243], v[148:151]
    v_mfma_f32_16x16x32_bf16 v[148:151], a[192:195], v[192:195], v[148:151]
    s_waitcnt lgkmcnt(8)
    v_mfma_f32_16x16x32_bf16 v[152:155], a[208:211], v[192:195], v[152:155]
    v_exp_f32 v88, v88
    v_mfma_f32_16x16x32_bf16 v[152:155], a[212:215], v[240:243], v[152:155]
    v_add_f32 v222, v222, v88
    v_mfma_f32_16x16x32_bf16 v[152:155], a[216:219], v[32:35], v[152:155]
    v_exp_f32 v89, v89
    v_mfma_f32_16x16x32_bf16 v[152:155], a[220:223], v[48:51], v[152:155]
    v_add_f32 v222, v222, v89
    v_cvt_pk_bf16_f32 v26, v88, v89
    v_mfma_f32_16x16x32_bf16 a[248:251], a[220:223], v[52:55], a[248:251]
    v_mfma_f32_16x16x32_bf16 a[248:251], a[216:219], v[36:39], a[248:251]
    v_exp_f32 v90, v90
    v_mfma_f32_16x16x32_bf16 a[248:251], a[212:215], v[244:247], a[248:251]
    v_add_f32 v222, v222, v90
    v_mfma_f32_16x16x32_bf16 a[248:251], a[208:211], v[196:199], a[248:251]
    v_mfma_f32_16x16x32_bf16 a[40:43], a[208:211], v[200:203], a[40:43]
    v_exp_f32 v91, v91
    v_mfma_f32_16x16x32_bf16 a[40:43], a[212:215], v[248:251], a[40:43]
    v_add_f32 v222, v222, v91
    v_cvt_pk_bf16_f32 v27, v90, v91
    v_mfma_f32_16x16x32_bf16 a[40:43], a[216:219], v[40:43], a[40:43]
    v_mfma_f32_16x16x32_bf16 a[40:43], a[220:223], v[56:59], a[40:43]
    v_mfma_f32_16x16x32_bf16 a[88:91], a[220:223], v[60:63], a[88:91]
    v_exp_f32 v84, v84
    v_mfma_f32_16x16x32_bf16 a[88:91], a[216:219], v[44:47], a[88:91]
    v_add_f32 v221, v221, v84
    v_mfma_f32_16x16x32_bf16 a[88:91], a[212:215], v[252:255], a[88:91]
    v_mfma_f32_16x16x32_bf16 a[88:91], a[208:211], v[204:207], a[88:91]
    s_waitcnt vmcnt(6) lgkmcnt(0)
    s_barrier
    v_mfma_f32_16x16x32_bf16 a[92:95], a[224:227], v[204:207], a[92:95]
    ds_read_b128 a[192:195], v208 offset:24576
    ds_read_b128 a[196:199], v209 offset:24576
    v_mfma_f32_16x16x32_bf16 a[92:95], a[228:231], v[252:255], a[92:95]
    v_exp_f32 v85, v85
    v_mfma_f32_16x16x32_bf16 a[92:95], a[232:235], v[44:47], a[92:95]
    v_exp_f32 v86, v86
    v_mfma_f32_16x16x32_bf16 a[92:95], a[236:239], v[60:63], a[92:95]
    ds_read_b128 a[200:203], v208 offset:24704
    ds_read_b128 a[204:207], v209 offset:24704
    v_mfma_f32_16x16x32_bf16 a[44:47], a[236:239], v[56:59], a[44:47]
    v_add_f32 v221, v221, v85
    v_cvt_pk_bf16_f32 v22, v84, v85
    v_mfma_f32_16x16x32_bf16 a[44:47], a[232:235], v[40:43], a[44:47]
    v_add_f32 v221, v221, v86
    v_mfma_f32_16x16x32_bf16 a[44:47], a[228:231], v[248:251], a[44:47]
    ds_read_b128 a[208:211], v208 offset:24832
    ds_read_b128 a[212:215], v209 offset:24832
    v_mfma_f32_16x16x32_bf16 a[44:47], a[224:227], v[200:203], a[44:47]
    v_exp_f32 v87, v87
    v_mfma_f32_16x16x32_bf16 a[252:255], a[224:227], v[196:199], a[252:255]
    v_add_f32 v221, v221, v87
    v_cvt_pk_bf16_f32 v23, v86, v87
    v_mfma_f32_16x16x32_bf16 a[252:255], a[228:231], v[244:247], a[252:255]
    v_exp_f32 v80, v80
    v_mfma_f32_16x16x32_bf16 a[252:255], a[232:235], v[36:39], a[252:255]
    v_add_f32 v220, v220, v80
    v_mfma_f32_16x16x32_bf16 a[252:255], a[236:239], v[52:55], a[252:255]
    v_mfma_f32_16x16x32_bf16 v[156:159], a[236:239], v[48:51], v[156:159]
    v_mfma_f32_16x16x32_bf16 v[156:159], a[232:235], v[32:35], v[156:159]
    v_exp_f32 v81, v81
    v_mfma_f32_16x16x32_bf16 v[156:159], a[228:231], v[240:243], v[156:159]
    v_add_f32 v220, v220, v81
    v_cvt_pk_bf16_f32 v18, v80, v81
    v_mfma_f32_16x16x32_bf16 v[156:159], a[224:227], v[192:195], v[156:159]
    s_waitcnt lgkmcnt(0)
    s_branch L_loop
L_tail:
    v_mfma_f32_16x16x32_bf16 v[44:47], a[192:195], a[168:171], v[108:111]
    s_add_u32 s34, s34, 24576
    s_add_u32 m0, s32, 73728
    v_mfma_f32_16x16x32_bf16 v[44:47], a[196:199], a[172:175], v[44:47]
    buffer_load_dwordx4 v217, s[24:27], s34 offen offset:0  lds
    v_mfma_f32_16x16x32_bf16 v[44:47], a[200:203], a[176:179], v[44:47]
    v_exp_f32 v82, v82
    v_mfma_f32_16x16x32_bf16 v[44:47], a[204:207], a[180:183], v[44:47]
    buffer_load_dwordx4 v218, s[24:27], s34 offen offset:1024  lds
    v_mfma_f32_16x16x32_bf16 v[44:47], a[208:211], a[184:187], v[44:47]
    buffer_load_dwordx4 v219, s[24:27], s34 offen offset:2048  lds
    v_mfma_f32_16x16x32_bf16 v[44:47], a[212:215], a[188:191], v[44:47]
    v_add_f32 v220, v220, v82
    v_add_u32 v214, 4294918144, v210
    v_mfma_f32_16x16x32_bf16 v[40:43], a[212:215], a[164:167], v[104:107]
    s_add_u32 s34, s34, 12288
    v_add_u32 v215, 4294918144, v211
    v_mfma_f32_16x16x32_bf16 v[40:43], a[208:211], a[160:163], v[40:43]
    s_add_u32 m0, s32, 86016
    v_add_u32 v216, 4294918144, v212
    v_mfma_f32_16x16x32_bf16 v[40:43], a[204:207], a[156:159], v[40:43]
    v_exp_f32 v83, v83
    v_mfma_f32_16x16x32_bf16 v[40:43], a[200:203], a[152:155], v[40:43]
    buffer_load_dwordx4 v217, s[24:27], s34 offen offset:0  lds
    v_mfma_f32_16x16x32_bf16 v[40:43], a[196:199], a[148:151], v[40:43]
    buffer_load_dwordx4 v218, s[24:27], s34 offen offset:1024  lds
    v_mfma_f32_16x16x32_bf16 v[40:43], a[192:195], a[144:147], v[40:43]
    v_add_f32 v220, v220, v83
    v_cvt_pk_bf16_f32 v243, v82, v83
    v_mfma_f32_16x16x32_bf16 v[36:39], a[192:195], a[120:123], v[100:103]
    buffer_load_dwordx4 v219, s[24:27], s34 offen offset:2048  lds
    v_mfma_f32_16x16x32_bf16 v[36:39], a[196:199], a[124:127], v[36:39]
    s_add_u32 s34, s34, 12288
    v_add_u32 v217, 4294918144, v213
    v_mfma_f32_16x16x32_bf16 v[36:39], a[200:203], a[128:131], v[36:39]
    v_bfe_u32 v232, v224, 4, 1
    v_bfe_u32 v233, v224, 5, 1
    v_mfma_f32_16x16x32_bf16 v[36:39], a[204:207], a[132:135], v[36:39]
    v_sub_u32 v232, v232, v233
    v_lshl_add_u32 v225, v232, 4, v225
    v_mfma_f32_16x16x32_bf16 v[36:39], a[208:211], a[136:139], v[36:39]
    v_lshrrev_b32 v228, 4, v224
    v_and_b32 v228, 12, v228
    v_mfma_f32_16x16x32_bf16 v[36:39], a[212:215], a[140:143], v[36:39]
    v_add_u32 v228, 98304, v228
    v_mov_b32 v229, 98304
    v_mfma_f32_16x16x32_bf16 v[32:35], a[212:215], a[116:119], v[96:99]
    ds_read_b128 a[216:219], v208 offset:30720
    ds_read_b128 a[220:223], v209 offset:30720
    v_mfma_f32_16x16x32_bf16 v[32:35], a[208:211], a[112:115], v[32:35]
    ds_read_b128 a[224:227], v208 offset:30848
    ds_read_b128 a[228:231], v209 offset:30848
    v_mfma_f32_16x16x32_bf16 v[32:35], a[204:207], a[108:111], v[32:35]
    ds_read_b128 a[232:235], v208 offset:30976
    ds_read_b128 a[236:239], v209 offset:30976
    v_mfma_f32_16x16x32_bf16 v[32:35], a[200:203], a[104:107], v[32:35]
    ds_read_b128 a[200:203], v208 offset:36992
    ds_read_b128 a[204:207], v209 offset:36992
    v_mfma_f32_16x16x32_bf16 v[32:35], a[196:199], a[100:103], v[32:35]
    ds_read_b128 a[196:199], v209 offset:36864
    ds_read_b128 a[208:211], v208 offset:37120
    v_mfma_f32_16x16x32_bf16 v[32:35], a[192:195], a[96:99], v[32:35]
    ds_read_b128 a[192:195], v208 offset:36864
    ds_read_b128 a[212:215], v209 offset:37120
    v_exp_f32 v36, v36
    v_exp_f32 v37, v37
    v_add_f32 v221, v221, v36
    v_add_f32 v221, v221, v37
    v_cvt_pk_bf16_f32 v36, v36, v37
    v_exp_f32 v38, v38
    s_waitcnt lgkmcnt(11)
    v_mfma_f32_16x16x32_bf16 v[64:67], a[216:219], a[96:99], v[96:99]
    v_exp_f32 v32, v32
    s_waitcnt lgkmcnt(10)
    v_mfma_f32_16x16x32_bf16 v[64:67], a[220:223], a[100:103], v[64:67]
    v_add_f32 v220, v220, v32
    v_add_f32 v221, v221, v38
    s_waitcnt lgkmcnt(9)
    v_mfma_f32_16x16x32_bf16 v[64:67], a[224:227], a[104:107], v[64:67]
    v_exp_f32 v33, v33
    s_waitcnt lgkmcnt(8)
    v_mfma_f32_16x16x32_bf16 v[64:67], a[228:231], a[108:111], v[64:67]
    v_add_f32 v220, v220, v33
    v_cvt_pk_bf16_f32 v32, v32, v33
    s_waitcnt lgkmcnt(7)
    v_mfma_f32_16x16x32_bf16 v[64:67], a[232:235], a[112:115], v[64:67]
    v_exp_f32 v34, v34
    s_waitcnt lgkmcnt(6)
    v_mfma_f32_16x16x32_bf16 v[64:67], a[236:239], a[116:119], v[64:67]
    v_add_f32 v220, v220, v34
    v_mfma_f32_16x16x32_bf16 v[68:71], a[236:239], a[140:143], v[100:103]
    v_exp_f32 v35, v35
    v_mfma_f32_16x16x32_bf16 v[68:71], a[232:235], a[136:139], v[68:71]
    v_add_f32 v220, v220, v35
    v_cvt_pk_bf16_f32 v33, v34, v35
    v_mfma_f32_16x16x32_bf16 v[68:71], a[228:231], a[132:135], v[68:71]
    v_exp_f32 v39, v39
    v_mfma_f32_16x16x32_bf16 v[68:71], a[224:227], a[128:131], v[68:71]
    v_exp_f32 v64, v64
    v_mfma_f32_16x16x32_bf16 v[68:71], a[220:223], a[124:127], v[68:71]
    v_add_f32 v220, v220, v64
    v_add_f32 v221, v221, v39
    v_mfma_f32_16x16x32_bf16 v[68:71], a[216:219], a[120:123], v[68:71]
    v_exp_f32 v65, v65
    v_mfma_f32_16x16x32_bf16 v[72:75], a[216:219], a[144:147], v[104:107]
    v_add_f32 v220, v220, v65
    v_cvt_pk_bf16_f32 v34, v64, v65
    v_mfma_f32_16x16x32_bf16 v[72:75], a[220:223], a[148:151], v[72:75]
    v_exp_f32 v66, v66
    v_mfma_f32_16x16x32_bf16 v[72:75], a[224:227], a[152:155], v[72:75]
    v_add_f32 v220, v220, v66
    v_cvt_pk_bf16_f32 v37, v38, v39
    v_mfma_f32_16x16x32_bf16 v[72:75], a[228:231], a[156:159], v[72:75]
    v_exp_f32 v67, v67
    v_mfma_f32_16x16x32_bf16 v[72:75], a[232:235], a[160:163], v[72:75]
    v_add_f32 v220, v220, v67
    v_cvt_pk_bf16_f32 v35, v66, v67
    v_mfma_f32_16x16x32_bf16 v[72:75], a[236:239], a[164:167], v[72:75]
    v_exp_f32 v68, v68
    v_mfma_f32_16x16x32_bf16 v[76:79], a[236:239], a[188:191], v[108:111]
    ds_read_b128 a[236:239], v209 offset:43264
    v_add_f32 v221, v221, v68
    v_mfma_f32_16x16x32_bf16 v[76:79], a[232:235], a[184:187], v[76:79]
    ds_read_b128 a[232:235], v208 offset:43264
    v_mfma_f32_16x16x32_bf16 v[76:79], a[228:231], a[180:183], v[76:79]
    ds_read_b128 a[228:231], v209 offset:43136
    v_mfma_f32_16x16x32_bf16 v[76:79], a[224:227], a[176:179], v[76:79]
    ds_read_b128 a[224:227], v208 offset:43136
    v_mfma_f32_16x16x32_bf16 v[76:79], a[220:223], a[172:175], v[76:79]
    ds_read_b128 a[220:223], v209 offset:43008
    v_mfma_f32_16x16x32_bf16 v[76:79], a[216:219], a[168:171], v[76:79]
    ds_read_b128 a[216:219], v208 offset:43008
    s_waitcnt lgkmcnt(7)
    v_mfma_f32_16x16x32_bf16 v[60:63], a[192:195], a[168:171], v[108:111]
    v_exp_f32 v69, v69
    v_mfma_f32_16x16x32_bf16 v[60:63], a[196:199], a[172:175], v[60:63]
    v_add_f32 v221, v221, v69
    v_cvt_pk_bf16_f32 v38, v68, v69
    v_mfma_f32_16x16x32_bf16 v[60:63], a[200:203], a[176:179], v[60:63]
    v_exp_f32 v70, v70
    v_mfma_f32_16x16x32_bf16 v[60:63], a[204:207], a[180:183], v[60:63]
    v_add_f32 v221, v221, v70
    v_mfma_f32_16x16x32_bf16 v[60:63], a[208:211], a[184:187], v[60:63]
    v_exp_f32 v71, v71
    s_waitcnt lgkmcnt(6)
    v_mfma_f32_16x16x32_bf16 v[60:63], a[212:215], a[188:191], v[60:63]
    v_add_f32 v221, v221, v71
    v_cvt_pk_bf16_f32 v39, v70, v71
    v_mfma_f32_16x16x32_bf16 v[56:59], a[212:215], a[164:167], v[104:107]
    v_exp_f32 v40, v40
    v_mfma_f32_16x16x32_bf16 v[56:59], a[208:211], a[160:163], v[56:59]
    v_add_f32 v222, v222, v40
    v_mfma_f32_16x16x32_bf16 v[56:59], a[204:207], a[156:159], v[56:59]
    v_exp_f32 v41, v41
    v_mfma_f32_16x16x32_bf16 v[56:59], a[200:203], a[152:155], v[56:59]
    v_add_f32 v222, v222, v41
    v_cvt_pk_bf16_f32 v40, v40, v41
    v_mfma_f32_16x16x32_bf16 v[56:59], a[196:199], a[148:151], v[56:59]
    v_exp_f32 v42, v42
    v_mfma_f32_16x16x32_bf16 v[56:59], a[192:195], a[144:147], v[56:59]
    v_add_f32 v222, v222, v42
    v_mfma_f32_16x16x32_bf16 v[52:55], a[192:195], a[120:123], v[100:103]
    v_exp_f32 v43, v43
    v_mfma_f32_16x16x32_bf16 v[52:55], a[196:199], a[124:127], v[52:55]
    v_add_f32 v222, v222, v43
    v_cvt_pk_bf16_f32 v41, v42, v43
    v_mfma_f32_16x16x32_bf16 v[52:55], a[200:203], a[128:131], v[52:55]
    v_exp_f32 v72, v72
    v_mfma_f32_16x16x32_bf16 v[52:55], a[204:207], a[132:135], v[52:55]
    v_add_f32 v222, v222, v72
    v_mfma_f32_16x16x32_bf16 v[52:55], a[208:211], a[136:139], v[52:55]
    v_exp_f32 v73, v73
    v_mfma_f32_16x16x32_bf16 v[52:55], a[212:215], a[140:143], v[52:55]
    v_add_f32 v222, v222, v73
    s_waitcnt vmcnt(0)
    s_barrier
    v_mfma_f32_16x16x32_bf16 v[48:51], a[212:215], a[116:119], v[96:99]
    ds_read_b64_tr_b16 v[24:25], v214 offset:0
    ds_read_b64_tr_b16 v[26:27], v214 offset:6144
    v_mfma_f32_16x16x32_bf16 v[48:51], a[208:211], a[112:115], v[48:51]
    ds_read_b64_tr_b16 v[28:29], v214 offset:12288
    ds_read_b64_tr_b16 v[30:31], v214 offset:18432
    v_mfma_f32_16x16x32_bf16 v[48:51], a[204:207], a[108:111], v[48:51]
    ds_read_b64_tr_b16 v[232:233], v210 offset:24576
    ds_read_b64_tr_b16 v[234:235], v210 offset:30720
    v_mfma_f32_16x16x32_bf16 v[48:51], a[200:203], a[104:107], v[48:51]
    ds_read_b64_tr_b16 v[236:237], v210 offset:36864
    ds_read_b64_tr_b16 v[238:239], v210 offset:43008
    v_mfma_f32_16x16x32_bf16 v[48:51], a[196:199], a[100:103], v[48:51]
    ds_read_b64_tr_b16 a[196:197], v215 offset:12288
    ds_read_b64_tr_b16 a[198:199], v215 offset:18432
    v_mfma_f32_16x16x32_bf16 v[48:51], a[192:195], a[96:99], v[48:51]
    ds_read_b64_tr_b16 a[192:193], v215 offset:0
    ds_read_b64_tr_b16 a[194:195], v215 offset:6144
    s_waitcnt lgkmcnt(12)
    v_mfma_f32_16x16x32_bf16 v[80:83], a[216:219], a[96:99], v[96:99]
    ds_read_b64_tr_b16 a[200:201], v211 offset:24576
    ds_read_b64_tr_b16 a[202:203], v211 offset:30720
    v_mfma_f32_16x16x32_bf16 v[80:83], a[220:223], a[100:103], v[80:83]
    ds_read_b64_tr_b16 a[204:205], v211 offset:36864
    ds_read_b64_tr_b16 a[206:207], v211 offset:43008
    v_mfma_f32_16x16x32_bf16 v[80:83], a[224:227], a[104:107], v[80:83]
    v_exp_f32 v48, v48
    v_mfma_f32_16x16x32_bf16 v[80:83], a[228:231], a[108:111], v[80:83]
    v_add_f32 v220, v220, v48
    ds_read_b64_tr_b16 a[208:209], v216 offset:0
    v_mfma_f32_16x16x32_bf16 v[80:83], a[232:235], a[112:115], v[80:83]
    v_exp_f32 v49, v49
    v_mfma_f32_16x16x32_bf16 v[80:83], a[236:239], a[116:119], v[80:83]
    v_add_f32 v220, v220, v49
    v_cvt_pk_bf16_f32 v48, v48, v49
    v_mfma_f32_16x16x32_bf16 v[84:87], a[236:239], a[140:143], v[100:103]
    v_exp_f32 v50, v50
    v_mfma_f32_16x16x32_bf16 v[84:87], a[232:235], a[136:139], v[84:87]
    v_add_f32 v220, v220, v50
    ds_read_b64_tr_b16 a[210:211], v216 offset:6144
    v_mfma_f32_16x16x32_bf16 v[84:87], a[228:231], a[132:135], v[84:87]
    v_exp_f32 v51, v51
    v_mfma_f32_16x16x32_bf16 v[84:87], a[224:227], a[128:131], v[84:87]
    v_add_f32 v220, v220, v51
    v_cvt_pk_bf16_f32 v49, v50, v51
    v_mfma_f32_16x16x32_bf16 v[84:87], a[220:223], a[124:127], v[84:87]
    v_exp_f32 v80, v80
    v_mfma_f32_16x16x32_bf16 v[84:87], a[216:219], a[120:123], v[84:87]
    v_add_f32 v220, v220, v80
    ds_read_b64_tr_b16 a[212:213], v216 offset:12288
    v_mfma_f32_16x16x32_bf16 v[88:91], a[216:219], a[144:147], v[104:107]
    v_exp_f32 v81, v81
    v_mfma_f32_16x16x32_bf16 v[88:91], a[220:223], a[148:151], v[88:91]
    v_add_f32 v220, v220, v81
    v_cvt_pk_bf16_f32 v50, v80, v81
    v_mfma_f32_16x16x32_bf16 v[88:91], a[224:227], a[152:155], v[88:91]
    v_exp_f32 v82, v82
    v_mfma_f32_16x16x32_bf16 v[88:91], a[228:231], a[156:159], v[88:91]
    v_add_f32 v220, v220, v82
    ds_read_b64_tr_b16 a[214:215], v216 offset:18432
    v_mfma_f32_16x16x32_bf16 v[88:91], a[232:235], a[160:163], v[88:91]
    v_exp_f32 v83, v83
    v_mfma_f32_16x16x32_bf16 v[88:91], a[236:239], a[164:167], v[88:91]
    v_add_f32 v220, v220, v83
    v_cvt_pk_bf16_f32 v51, v82, v83
    v_mfma_f32_16x16x32_bf16 v[92:95], a[236:239], a[188:191], v[108:111]
    v_mov_b32 v226, v220
    ds_read_b64_tr_b16 a[96:97], v212 offset:24576
    v_mfma_f32_16x16x32_bf16 v[92:95], a[232:235], a[184:187], v[92:95]
    v_permlane32_swap_b32 v220, v226
    s_nop 0
    v_add_f32 v220, v220, v226
    v_mfma_f32_16x16x32_bf16 v[92:95], a[228:231], a[180:183], v[92:95]
    v_mov_b32 v226, v220
    ds_read_b64_tr_b16 a[98:99], v212 offset:30720
    v_mfma_f32_16x16x32_bf16 v[92:95], a[224:227], a[176:179], v[92:95]
    v_permlane16_swap_b32 v220, v226
    s_nop 0
    v_add_f32 v220, v220, v226
    v_mfma_f32_16x16x32_bf16 v[92:95], a[220:223], a[172:175], v[92:95]
    v_max_f32 v227, v220, v220
    v_rcp_f32 v220, v220
    v_mfma_f32_16x16x32_bf16 v[92:95], a[216:219], a[168:171], v[92:95]
    ds_read_b64_tr_b16 a[100:101], v212 offset:36864
    ds_read_b64_tr_b16 a[102:103], v212 offset:43008
    s_waitcnt lgkmcnt(14)
    v_mfma_f32_16x16x32_bf16 v[112:115], v[24:27], v[192:195], v[112:115]
    ds_read_b64_tr_b16 a[104:105], v217 offset:0
    ds_read_b64_tr_b16 a[106:107], v217 offset:6144
    v_mfma_f32_16x16x32_bf16 v[112:115], v[28:31], v[240:243], v[112:115]
    ds_read_b64_tr_b16 a[108:109], v217 offset:12288
    ds_read_b64_tr_b16 a[110:111], v217 offset:18432
    v_mfma_f32_16x16x32_bf16 v[112:115], v[232:235], v[32:35], v[112:115]
    ds_read_b64_tr_b16 a[112:113], v213 offset:24576
    ds_read_b64_tr_b16 a[114:115], v213 offset:30720
    v_mfma_f32_16x16x32_bf16 v[112:115], v[236:239], v[48:51], v[112:115]
    ds_read_b64_tr_b16 a[116:117], v213 offset:36864
    ds_read_b64_tr_b16 a[118:119], v213 offset:43008
    s_waitcnt lgkmcnt(14)
    v_mfma_f32_16x16x32_bf16 v[116:119], a[204:207], v[48:51], v[116:119]
    ds_read_b64_tr_b16 a[120:121], v214 offset:128
    ds_read_b64_tr_b16 a[122:123], v214 offset:6272
    v_mfma_f32_16x16x32_bf16 v[116:119], a[200:203], v[32:35], v[116:119]
    ds_read_b64_tr_b16 a[124:125], v214 offset:12416
    ds_read_b64_tr_b16 a[126:127], v214 offset:18560
    v_mfma_f32_16x16x32_bf16 v[116:119], a[196:199], v[240:243], v[116:119]
    v_mul_f32 v0, v220, v112
    v_mul_f32 v1, v220, v113
    v_mfma_f32_16x16x32_bf16 v[116:119], a[192:195], v[192:195], v[116:119]
    v_mul_f32 v2, v220, v114
    v_mul_f32 v3, v220, v115
    v_mfma_f32_16x16x32_bf16 v[120:123], a[208:211], v[192:195], v[120:123]
    v_cvt_pk_bf16_f32 v0, v0, v1
    v_cvt_pk_bf16_f32 v1, v2, v3
    s_waitcnt lgkmcnt(14)
    v_mfma_f32_16x16x32_bf16 v[120:123], a[212:215], v[240:243], v[120:123]
    ds_read_b64_tr_b16 a[128:129], v210 offset:24704
    ds_read_b64_tr_b16 a[130:131], v210 offset:30848
    v_mfma_f32_16x16x32_bf16 v[120:123], a[96:99], v[32:35], v[120:123]
    v_mul_f32 v4, v220, v116
    v_mul_f32 v5, v220, v117
    s_waitcnt lgkmcnt(14)
    v_mfma_f32_16x16x32_bf16 v[120:123], a[100:103], v[48:51], v[120:123]
    v_mul_f32 v6, v220, v118
    v_mul_f32 v7, v220, v119
    s_waitcnt lgkmcnt(6)
    v_mfma_f32_16x16x32_bf16 v[124:127], a[116:119], v[48:51], v[124:127]
    v_cvt_pk_bf16_f32 v2, v4, v5
    v_cvt_pk_bf16_f32 v3, v6, v7
    v_mfma_f32_16x16x32_bf16 v[124:127], a[112:115], v[32:35], v[124:127]
    v_permlane16_swap_b32 v0, v2
    v_permlane16_swap_b32 v1, v3
    v_mfma_f32_16x16x32_bf16 v[124:127], a[108:111], v[240:243], v[124:127]
    ds_read_b64_tr_b16 a[132:133], v210 offset:36992
    ds_read_b64_tr_b16 a[134:135], v210 offset:43136
    v_mfma_f32_16x16x32_bf16 v[124:127], a[104:107], v[192:195], v[124:127]
    ds_read_b64_tr_b16 a[136:137], v215 offset:128
    ds_read_b64_tr_b16 a[138:139], v215 offset:6272
    s_waitcnt lgkmcnt(8)
    v_mfma_f32_16x16x32_bf16 v[128:131], a[120:123], v[192:195], v[128:131]
    buffer_store_dwordx4 v[0:3], v225, s[28:31], 0 offen offset:0 sc0 sc1
    s_waitcnt lgkmcnt(6)
    v_mfma_f32_16x16x32_bf16 v[128:131], a[124:127], v[240:243], v[128:131]
    v_mul_f32 v8, v220, v120
    v_mul_f32 v9, v220, v121
    s_waitcnt lgkmcnt(4)
    v_mfma_f32_16x16x32_bf16 v[128:131], a[128:131], v[32:35], v[128:131]
    v_mul_f32 v10, v220, v122
    v_mul_f32 v11, v220, v123
    v_mul_f32 v12, v220, v124
    v_mul_f32 v13, v220, v125
    v_mul_f32 v14, v220, v126
    v_mul_f32 v15, v220, v127
    v_cvt_pk_bf16_f32 v8, v8, v9
    v_cvt_pk_bf16_f32 v9, v10, v11
    v_cvt_pk_bf16_f32 v10, v12, v13
    v_cvt_pk_bf16_f32 v11, v14, v15
    s_waitcnt lgkmcnt(2)
    v_mfma_f32_16x16x32_bf16 v[128:131], a[132:135], v[48:51], v[128:131]
    v_permlane16_swap_b32 v8, v10
    v_permlane16_swap_b32 v9, v11
    ds_read_b64_tr_b16 a[140:141], v215 offset:12416
    ds_read_b64_tr_b16 a[142:143], v215 offset:18560
    ds_read_b64_tr_b16 a[144:145], v211 offset:24704
    ds_read_b64_tr_b16 a[146:147], v211 offset:30848
    ds_read_b64_tr_b16 a[148:149], v211 offset:36992
    ds_read_b64_tr_b16 a[150:151], v211 offset:43136
    ds_read_b64_tr_b16 a[152:153], v216 offset:128
    ds_read_b64_tr_b16 a[154:155], v216 offset:6272
    ds_read_b64_tr_b16 a[156:157], v216 offset:12416
    ds_read_b64_tr_b16 a[158:159], v216 offset:18560
    buffer_store_dwordx4 v[8:11], v225, s[28:31], 0 offen offset:64 sc0 sc1
    ds_read_b64_tr_b16 a[160:161], v212 offset:24704
    ds_read_b64_tr_b16 a[162:163], v212 offset:30848
    ds_read_b64_tr_b16 a[164:165], v212 offset:36992
    ds_read_b64_tr_b16 a[166:167], v212 offset:43136
    ds_read_b64_tr_b16 v[96:97], v217 offset:128
    ds_read_b64_tr_b16 v[98:99], v217 offset:6272
    ds_read_b64_tr_b16 v[100:101], v217 offset:12416
    ds_read_b64_tr_b16 v[102:103], v217 offset:18560
    ds_read_b64_tr_b16 v[104:105], v213 offset:24704
    v_mul_f32 v16, v220, v128
    v_mul_f32 v17, v220, v129
    v_mul_f32 v18, v220, v130
    v_mul_f32 v19, v220, v131
    v_cvt_pk_bf16_f32 v16, v16, v17
    v_cvt_pk_bf16_f32 v17, v18, v19
    ds_read_b64_tr_b16 v[106:107], v213 offset:30848
    ds_read_b64_tr_b16 v[108:109], v213 offset:36992
    ds_read_b64_tr_b16 v[110:111], v213 offset:43136
    ds_read_b64_tr_b16 a[168:169], v214 offset:256
    ds_read_b64_tr_b16 a[170:171], v214 offset:6400
    ds_read_b64_tr_b16 a[172:173], v214 offset:12544
    ds_read_b64_tr_b16 a[174:175], v214 offset:18688
    s_waitcnt lgkmcnt(14)
    v_mfma_f32_16x16x32_bf16 v[132:135], a[148:151], v[48:51], v[132:135]
    ds_read_b64_tr_b16 a[176:177], v210 offset:24832
    ds_read_b64_tr_b16 a[178:179], v210 offset:30976
    v_mfma_f32_16x16x32_bf16 v[132:135], a[144:147], v[32:35], v[132:135]
    ds_read_b64_tr_b16 a[180:181], v210 offset:37120
    ds_read_b64_tr_b16 a[182:183], v210 offset:43264
    v_mfma_f32_16x16x32_bf16 v[132:135], a[140:143], v[240:243], v[132:135]
    ds_read_b64_tr_b16 a[184:185], v215 offset:256
    ds_read_b64_tr_b16 a[186:187], v215 offset:6400
    v_mfma_f32_16x16x32_bf16 v[132:135], a[136:139], v[192:195], v[132:135]
    ds_read_b64_tr_b16 a[188:189], v215 offset:12544
    ds_read_b64_tr_b16 a[190:191], v215 offset:18688
    v_mfma_f32_16x16x32_bf16 v[136:139], a[152:155], v[192:195], v[136:139]
    ds_read_b64_tr_b16 a[216:217], v211 offset:24832
    ds_read_b64_tr_b16 a[218:219], v211 offset:30976
    v_mfma_f32_16x16x32_bf16 v[136:139], a[156:159], v[240:243], v[136:139]
    ds_read_b64_tr_b16 a[220:221], v211 offset:37120
    ds_read_b64_tr_b16 a[222:223], v211 offset:43264
    v_mfma_f32_16x16x32_bf16 v[136:139], a[160:163], v[32:35], v[136:139]
    v_mul_f32 v20, v220, v132
    v_mul_f32 v21, v220, v133
    s_waitcnt lgkmcnt(14)
    v_mfma_f32_16x16x32_bf16 v[136:139], a[164:167], v[48:51], v[136:139]
    v_mul_f32 v22, v220, v134
    v_mul_f32 v23, v220, v135
    v_mfma_f32_16x16x32_bf16 v[140:143], v[108:111], v[48:51], v[140:143]
    v_cvt_pk_bf16_f32 v18, v20, v21
    v_cvt_pk_bf16_f32 v19, v22, v23
    v_mfma_f32_16x16x32_bf16 v[140:143], v[104:107], v[32:35], v[140:143]
    v_permlane16_swap_b32 v16, v18
    v_permlane16_swap_b32 v17, v19
    v_mfma_f32_16x16x32_bf16 v[140:143], v[100:103], v[240:243], v[140:143]
    v_mul_f32 v0, v220, v136
    v_mul_f32 v1, v220, v137
    v_mfma_f32_16x16x32_bf16 v[140:143], v[96:99], v[192:195], v[140:143]
    v_mul_f32 v2, v220, v138
    v_mul_f32 v3, v220, v139
    v_mfma_f32_16x16x32_bf16 v[144:147], a[168:171], v[192:195], v[144:147]
    buffer_store_dwordx4 v[16:19], v225, s[28:31], 0 offen offset:128 sc0 sc1
    s_waitcnt lgkmcnt(12)
    v_mfma_f32_16x16x32_bf16 v[144:147], a[172:175], v[240:243], v[144:147]
    v_cvt_pk_bf16_f32 v0, v0, v1
    v_cvt_pk_bf16_f32 v1, v2, v3
    s_waitcnt lgkmcnt(10)
    v_mfma_f32_16x16x32_bf16 v[144:147], a[176:179], v[32:35], v[144:147]
    v_mul_f32 v4, v220, v140
    v_mul_f32 v5, v220, v141
    s_waitcnt lgkmcnt(8)
    v_mfma_f32_16x16x32_bf16 v[144:147], a[180:183], v[48:51], v[144:147]
    v_mul_f32 v6, v220, v142
    v_mul_f32 v7, v220, v143
    s_waitcnt lgkmcnt(0)
    v_mfma_f32_16x16x32_bf16 v[148:151], a[220:223], v[48:51], v[148:151]
    v_cvt_pk_bf16_f32 v2, v4, v5
    v_cvt_pk_bf16_f32 v3, v6, v7
    v_mfma_f32_16x16x32_bf16 v[148:151], a[216:219], v[32:35], v[148:151]
    v_permlane16_swap_b32 v0, v2
    v_permlane16_swap_b32 v1, v3
    v_mfma_f32_16x16x32_bf16 v[148:151], a[188:191], v[240:243], v[148:151]
    ds_read_b64_tr_b16 a[224:225], v216 offset:256
    ds_read_b64_tr_b16 a[226:227], v216 offset:6400
    v_mfma_f32_16x16x32_bf16 v[148:151], a[184:187], v[192:195], v[148:151]
    ds_read_b64_tr_b16 a[228:229], v216 offset:12544
    ds_read_b64_tr_b16 a[230:231], v216 offset:18688
    ds_read_b64_tr_b16 a[232:233], v212 offset:24832
    ds_read_b64_tr_b16 a[234:235], v212 offset:30976
    buffer_store_dwordx4 v[0:3], v225, s[28:31], 0 offen offset:192 sc0 sc1
    v_mul_f32 v8, v220, v144
    v_mul_f32 v9, v220, v145
    v_mul_f32 v10, v220, v146
    v_mul_f32 v11, v220, v147
    v_mul_f32 v12, v220, v148
    v_mul_f32 v13, v220, v149
    v_mul_f32 v14, v220, v150
    v_mul_f32 v15, v220, v151
    v_cvt_pk_bf16_f32 v8, v8, v9
    v_cvt_pk_bf16_f32 v9, v10, v11
    v_cvt_pk_bf16_f32 v10, v12, v13
    v_cvt_pk_bf16_f32 v11, v14, v15
    ds_read_b64_tr_b16 a[236:237], v212 offset:37120
    v_permlane16_swap_b32 v8, v10
    v_permlane16_swap_b32 v9, v11
    s_waitcnt lgkmcnt(5)
    v_mfma_f32_16x16x32_bf16 v[152:155], a[224:227], v[192:195], v[152:155]
    ds_read_b64_tr_b16 a[238:239], v212 offset:43264
    ds_read_b64_tr_b16 v[64:65], v217 offset:256
    s_waitcnt lgkmcnt(5)
    v_mfma_f32_16x16x32_bf16 v[152:155], a[228:231], v[240:243], v[152:155]
    ds_read_b64_tr_b16 v[66:67], v217 offset:6400
    ds_read_b64_tr_b16 v[80:81], v217 offset:12544
    s_waitcnt lgkmcnt(5)
    v_mfma_f32_16x16x32_bf16 v[152:155], a[232:235], v[32:35], v[152:155]
    buffer_store_dwordx4 v[8:11], v225, s[28:31], 0 offen offset:256 sc0 sc1
    ds_read_b64_tr_b16 v[82:83], v217 offset:18688
    ds_read_b64_tr_b16 v[68:69], v213 offset:24832
    ds_read_b64_tr_b16 v[70:71], v213 offset:30976
    v_exp_f32 v52, v52
    v_exp_f32 v53, v53
    v_add_f32 v221, v221, v52
    v_add_f32 v221, v221, v53
    v_cvt_pk_bf16_f32 v52, v52, v53
    v_exp_f32 v54, v54
    v_exp_f32 v55, v55
    s_waitcnt lgkmcnt(6)
    v_mfma_f32_16x16x32_bf16 v[152:155], a[236:239], v[48:51], v[152:155]
    v_add_f32 v221, v221, v54
    v_add_f32 v221, v221, v55
    v_cvt_pk_bf16_f32 v53, v54, v55
    v_exp_f32 v84, v84
    v_exp_f32 v85, v85
    v_add_f32 v221, v221, v84
    v_add_f32 v221, v221, v85
    v_cvt_pk_bf16_f32 v54, v84, v85
    v_mul_f32 v16, v220, v152
    v_mul_f32 v17, v220, v153
    v_mul_f32 v18, v220, v154
    v_mul_f32 v19, v220, v155
    v_cvt_pk_bf16_f32 v16, v16, v17
    v_cvt_pk_bf16_f32 v17, v18, v19
    ds_read_b64_tr_b16 v[84:85], v213 offset:37120
    v_exp_f32 v86, v86
    v_exp_f32 v87, v87
    v_add_f32 v221, v221, v86
    v_add_f32 v221, v221, v87
    v_cvt_pk_bf16_f32 v55, v86, v87
    ds_read_b64_tr_b16 v[86:87], v213 offset:43264
    v_mov_b32 v226, v221
    v_cvt_pk_bf16_f32 v42, v72, v73
    v_exp_f32 v74, v74
    v_permlane32_swap_b32 v221, v226
    s_nop 0
    v_add_f32 v221, v221, v226
    v_mov_b32 v226, v221
    v_add_f32 v222, v222, v74
    v_exp_f32 v75, v75
    v_permlane16_swap_b32 v221, v226
    s_nop 0
    v_add_f32 v221, v221, v226
    v_max_f32 v227, v221, v227
    v_rcp_f32 v221, v221
    v_add_f32 v222, v222, v75
    v_cvt_pk_bf16_f32 v43, v74, v75
    v_exp_f32 v56, v56
    v_exp_f32 v57, v57
    v_add_f32 v222, v222, v56
    v_add_f32 v222, v222, v57
    v_cvt_pk_bf16_f32 v56, v56, v57
    v_exp_f32 v58, v58
    v_exp_f32 v59, v59
    s_waitcnt lgkmcnt(0)
    v_mfma_f32_16x16x32_bf16 v[156:159], v[84:87], v[48:51], v[156:159]
    v_add_f32 v222, v222, v58
    v_add_f32 v222, v222, v59
    v_mfma_f32_16x16x32_bf16 v[156:159], v[68:71], v[32:35], v[156:159]
    v_cvt_pk_bf16_f32 v57, v58, v59
    v_mfma_f32_16x16x32_bf16 v[156:159], v[80:83], v[240:243], v[156:159]
    v_exp_f32 v88, v88
    v_mfma_f32_16x16x32_bf16 v[156:159], v[64:67], v[192:195], v[156:159]
    v_add_f32 v222, v222, v88
    v_mfma_f32_16x16x32_bf16 v[160:163], v[24:27], v[196:199], v[160:163]
    v_exp_f32 v89, v89
    v_mfma_f32_16x16x32_bf16 v[160:163], v[28:31], v[244:247], v[160:163]
    v_add_f32 v222, v222, v89
    v_cvt_pk_bf16_f32 v58, v88, v89
    v_mfma_f32_16x16x32_bf16 v[160:163], v[232:235], v[36:39], v[160:163]
    v_exp_f32 v90, v90
    v_mfma_f32_16x16x32_bf16 v[160:163], v[236:239], v[52:55], v[160:163]
    v_mul_f32 v20, v220, v156
    v_mul_f32 v21, v220, v157
    v_mfma_f32_16x16x32_bf16 v[164:167], a[204:207], v[52:55], v[164:167]
    v_mul_f32 v22, v220, v158
    v_mul_f32 v23, v220, v159
    v_mfma_f32_16x16x32_bf16 v[164:167], a[200:203], v[36:39], v[164:167]
    v_cvt_pk_bf16_f32 v18, v20, v21
    v_cvt_pk_bf16_f32 v19, v22, v23
    v_mfma_f32_16x16x32_bf16 v[164:167], a[196:199], v[244:247], v[164:167]
    v_permlane16_swap_b32 v16, v18
    v_permlane16_swap_b32 v17, v19
    v_mfma_f32_16x16x32_bf16 v[164:167], a[192:195], v[196:199], v[164:167]
    v_mul_f32 v0, v221, v160
    v_mul_f32 v1, v221, v161
    v_mfma_f32_16x16x32_bf16 v[168:171], a[208:211], v[196:199], v[168:171]
    v_mul_f32 v2, v221, v162
    v_mul_f32 v3, v221, v163
    v_mfma_f32_16x16x32_bf16 v[168:171], a[212:215], v[244:247], v[168:171]
    buffer_store_dwordx4 v[16:19], v225, s[28:31], 0 offen offset:320 sc0 sc1
    v_mfma_f32_16x16x32_bf16 v[168:171], a[96:99], v[36:39], v[168:171]
    v_mul_f32 v4, v221, v164
    v_mul_f32 v5, v221, v165
    v_mfma_f32_16x16x32_bf16 v[168:171], a[100:103], v[52:55], v[168:171]
    v_mul_f32 v6, v221, v166
    v_mul_f32 v7, v221, v167
    v_mfma_f32_16x16x32_bf16 v[172:175], a[116:119], v[52:55], v[172:175]
    v_cvt_pk_bf16_f32 v0, v0, v1
    v_cvt_pk_bf16_f32 v1, v2, v3
    v_mfma_f32_16x16x32_bf16 v[172:175], a[112:115], v[36:39], v[172:175]
    v_cvt_pk_bf16_f32 v2, v4, v5
    v_cvt_pk_bf16_f32 v3, v6, v7
    v_mfma_f32_16x16x32_bf16 v[172:175], a[108:111], v[244:247], v[172:175]
    v_permlane16_swap_b32 v0, v2
    v_permlane16_swap_b32 v1, v3
    v_mfma_f32_16x16x32_bf16 v[172:175], a[104:107], v[196:199], v[172:175]
    v_mul_f32 v8, v221, v168
    v_mul_f32 v9, v221, v169
    v_mfma_f32_16x16x32_bf16 v[176:179], a[120:123], v[196:199], v[176:179]
    v_mul_f32 v10, v221, v170
    v_mul_f32 v11, v221, v171
    v_mfma_f32_16x16x32_bf16 v[176:179], a[124:127], v[244:247], v[176:179]
    buffer_store_dwordx4 v[0:3], v225, s[28:31], s73 offen offset:0 sc0 sc1
    v_mfma_f32_16x16x32_bf16 v[176:179], a[128:131], v[36:39], v[176:179]
    v_mul_f32 v12, v221, v172
    v_mul_f32 v13, v221, v173
    v_mfma_f32_16x16x32_bf16 v[176:179], a[132:135], v[52:55], v[176:179]
    v_mul_f32 v14, v221, v174
    v_mul_f32 v15, v221, v175
    v_mfma_f32_16x16x32_bf16 v[180:183], a[148:151], v[52:55], v[180:183]
    v_cvt_pk_bf16_f32 v8, v8, v9
    v_cvt_pk_bf16_f32 v9, v10, v11
    v_mfma_f32_16x16x32_bf16 v[180:183], a[144:147], v[36:39], v[180:183]
    v_cvt_pk_bf16_f32 v10, v12, v13
    v_cvt_pk_bf16_f32 v11, v14, v15
    v_mfma_f32_16x16x32_bf16 v[180:183], a[140:143], v[244:247], v[180:183]
    v_permlane16_swap_b32 v8, v10
    v_permlane16_swap_b32 v9, v11
    v_mfma_f32_16x16x32_bf16 v[180:183], a[136:139], v[196:199], v[180:183]
    v_mul_f32 v16, v221, v176
    v_mul_f32 v17, v221, v177
    v_mfma_f32_16x16x32_bf16 v[184:187], a[152:155], v[196:199], v[184:187]
    v_mul_f32 v18, v221, v178
    v_mul_f32 v19, v221, v179
    v_mfma_f32_16x16x32_bf16 v[184:187], a[156:159], v[244:247], v[184:187]
    buffer_store_dwordx4 v[8:11], v225, s[28:31], s73 offen offset:64 sc0 sc1
    v_mfma_f32_16x16x32_bf16 v[184:187], a[160:163], v[36:39], v[184:187]
    v_mul_f32 v20, v221, v180
    v_mul_f32 v21, v221, v181
    v_mfma_f32_16x16x32_bf16 v[184:187], a[164:167], v[52:55], v[184:187]
    v_mul_f32 v22, v221, v182
    v_mul_f32 v23, v221, v183
    v_mfma_f32_16x16x32_bf16 v[188:191], v[108:111], v[52:55], v[188:191]
    v_cvt_pk_bf16_f32 v16, v16, v17
    v_cvt_pk_bf16_f32 v17, v18, v19
    v_mfma_f32_16x16x32_bf16 v[188:191], v[104:107], v[36:39], v[188:191]
    v_cvt_pk_bf16_f32 v18, v20, v21
    v_cvt_pk_bf16_f32 v19, v22, v23
    v_mfma_f32_16x16x32_bf16 v[188:191], v[100:103], v[244:247], v[188:191]
    v_permlane16_swap_b32 v16, v18
    v_permlane16_swap_b32 v17, v19
    v_mfma_f32_16x16x32_bf16 v[188:191], v[96:99], v[196:199], v[188:191]
    v_mul_f32 v0, v221, v184
    v_mul_f32 v1, v221, v185
    v_mfma_f32_16x16x32_bf16 a[240:243], a[168:171], v[196:199], a[240:243]
    v_mul_f32 v2, v221, v186
    v_mul_f32 v3, v221, v187
    v_mfma_f32_16x16x32_bf16 a[240:243], a[172:175], v[244:247], a[240:243]
    buffer_store_dwordx4 v[16:19], v225, s[28:31], s73 offen offset:128 sc0 sc1
    v_mfma_f32_16x16x32_bf16 a[240:243], a[176:179], v[36:39], a[240:243]
    v_mul_f32 v4, v221, v188
    v_mul_f32 v5, v221, v189
    v_mfma_f32_16x16x32_bf16 a[240:243], a[180:183], v[52:55], a[240:243]
    v_mul_f32 v6, v221, v190
    v_mul_f32 v7, v221, v191
    v_mfma_f32_16x16x32_bf16 a[244:247], a[220:223], v[52:55], a[244:247]
    v_cvt_pk_bf16_f32 v0, v0, v1
    v_cvt_pk_bf16_f32 v1, v2, v3
    v_mfma_f32_16x16x32_bf16 a[244:247], a[216:219], v[36:39], a[244:247]
    v_cvt_pk_bf16_f32 v2, v4, v5
    v_cvt_pk_bf16_f32 v3, v6, v7
    v_mfma_f32_16x16x32_bf16 a[244:247], a[188:191], v[244:247], a[244:247]
    v_permlane16_swap_b32 v0, v2
    v_permlane16_swap_b32 v1, v3
    v_mfma_f32_16x16x32_bf16 a[244:247], a[184:187], v[196:199], a[244:247]
    v_add_f32 v222, v222, v90
    v_mfma_f32_16x16x32_bf16 a[248:251], a[224:227], v[196:199], a[248:251]
    v_exp_f32 v91, v91
    v_mfma_f32_16x16x32_bf16 a[248:251], a[228:231], v[244:247], a[248:251]
    buffer_store_dwordx4 v[0:3], v225, s[28:31], s73 offen offset:192 sc0 sc1
    v_mfma_f32_16x16x32_bf16 a[248:251], a[232:235], v[36:39], a[248:251]
    v_accvgpr_read_b32 v8, a240
    v_accvgpr_read_b32 v9, a241
    v_mfma_f32_16x16x32_bf16 a[248:251], a[236:239], v[52:55], a[248:251]
    v_accvgpr_read_b32 v10, a242
    v_accvgpr_read_b32 v11, a243
    v_mfma_f32_16x16x32_bf16 a[252:255], v[84:87], v[52:55], a[252:255]
    v_accvgpr_read_b32 v12, a244
    v_accvgpr_read_b32 v13, a245
    v_mfma_f32_16x16x32_bf16 a[252:255], v[68:71], v[36:39], a[252:255]
    v_accvgpr_read_b32 v14, a246
    v_accvgpr_read_b32 v15, a247
    v_mfma_f32_16x16x32_bf16 a[252:255], v[80:83], v[244:247], a[252:255]
    v_mul_f32 v8, v221, v8
    v_mul_f32 v9, v221, v9
    v_mfma_f32_16x16x32_bf16 a[252:255], v[64:67], v[196:199], a[252:255]
    v_mul_f32 v10, v221, v10
    v_mul_f32 v11, v221, v11
    v_mfma_f32_16x16x32_bf16 a[0:3], v[24:27], v[200:203], a[0:3]
    v_mul_f32 v12, v221, v12
    v_mul_f32 v13, v221, v13
    v_mfma_f32_16x16x32_bf16 a[0:3], v[28:31], v[248:251], a[0:3]
    v_mul_f32 v14, v221, v14
    v_mul_f32 v15, v221, v15
    v_mfma_f32_16x16x32_bf16 a[0:3], v[232:235], v[40:43], a[0:3]
    v_cvt_pk_bf16_f32 v8, v8, v9
    v_cvt_pk_bf16_f32 v9, v10, v11
    v_cvt_pk_bf16_f32 v10, v12, v13
    v_cvt_pk_bf16_f32 v11, v14, v15
    v_add_f32 v222, v222, v91
    v_permlane16_swap_b32 v8, v10
    v_permlane16_swap_b32 v9, v11
    v_cvt_pk_bf16_f32 v59, v90, v91
    v_mov_b32 v226, v222
    s_nop 0
    v_mfma_f32_16x16x32_bf16 a[0:3], v[236:239], v[56:59], a[0:3]
    v_permlane32_swap_b32 v222, v226
    s_nop 0
    v_add_f32 v222, v222, v226
    v_mfma_f32_16x16x32_bf16 a[4:7], a[204:207], v[56:59], a[4:7]
    v_accvgpr_read_b32 v16, a248
    v_accvgpr_read_b32 v17, a249
    v_mfma_f32_16x16x32_bf16 a[4:7], a[200:203], v[40:43], a[4:7]
    buffer_store_dwordx4 v[8:11], v225, s[28:31], s73 offen offset:256 sc0 sc1
    v_mfma_f32_16x16x32_bf16 a[4:7], a[196:199], v[248:251], a[4:7]
    v_accvgpr_read_b32 v18, a250
    v_accvgpr_read_b32 v19, a251
    v_mfma_f32_16x16x32_bf16 a[4:7], a[192:195], v[200:203], a[4:7]
    v_accvgpr_read_b32 v20, a252
    v_accvgpr_read_b32 v21, a253
    v_mfma_f32_16x16x32_bf16 a[8:11], a[208:211], v[200:203], a[8:11]
    v_accvgpr_read_b32 v22, a254
    v_accvgpr_read_b32 v23, a255
    v_mfma_f32_16x16x32_bf16 a[8:11], a[212:215], v[248:251], a[8:11]
    v_mul_f32 v16, v221, v16
    v_mul_f32 v17, v221, v17
    v_mfma_f32_16x16x32_bf16 a[8:11], a[96:99], v[40:43], a[8:11]
    v_mul_f32 v18, v221, v18
    v_mul_f32 v19, v221, v19
    v_mfma_f32_16x16x32_bf16 a[8:11], a[100:103], v[56:59], a[8:11]
    v_mul_f32 v20, v221, v20
    v_mul_f32 v21, v221, v21
    v_mfma_f32_16x16x32_bf16 a[12:15], a[116:119], v[56:59], a[12:15]
    v_mul_f32 v22, v221, v22
    v_mul_f32 v23, v221, v23
    v_mfma_f32_16x16x32_bf16 a[12:15], a[112:115], v[40:43], a[12:15]
    v_cvt_pk_bf16_f32 v16, v16, v17
    v_cvt_pk_bf16_f32 v17, v18, v19
    v_mfma_f32_16x16x32_bf16 a[12:15], a[108:111], v[248:251], a[12:15]
    v_cvt_pk_bf16_f32 v18, v20, v21
    v_cvt_pk_bf16_f32 v19, v22, v23
    v_mfma_f32_16x16x32_bf16 a[12:15], a[104:107], v[200:203], a[12:15]
    v_permlane16_swap_b32 v16, v18
    v_permlane16_swap_b32 v17, v19
    v_mfma_f32_16x16x32_bf16 a[16:19], a[120:123], v[200:203], a[16:19]
    v_accvgpr_read_b32 v0, a0
    v_accvgpr_read_b32 v1, a1
    v_mfma_f32_16x16x32_bf16 a[16:19], a[124:127], v[248:251], a[16:19]
    v_accvgpr_read_b32 v2, a2
    v_accvgpr_read_b32 v3, a3
    v_mfma_f32_16x16x32_bf16 a[16:19], a[128:131], v[40:43], a[16:19]
    buffer_store_dwordx4 v[16:19], v225, s[28:31], s73 offen offset:320 sc0 sc1
    v_mfma_f32_16x16x32_bf16 a[16:19], a[132:135], v[56:59], a[16:19]
    v_accvgpr_read_b32 v4, a4
    v_accvgpr_read_b32 v5, a5
    v_mfma_f32_16x16x32_bf16 a[20:23], a[148:151], v[56:59], a[20:23]
    v_accvgpr_read_b32 v6, a6
    v_accvgpr_read_b32 v7, a7
    v_mfma_f32_16x16x32_bf16 a[20:23], a[144:147], v[40:43], a[20:23]
    v_mov_b32 v226, v222
    v_mfma_f32_16x16x32_bf16 a[20:23], a[140:143], v[248:251], a[20:23]
    s_nop 0
    v_permlane16_swap_b32 v222, v226
    s_nop 0
    v_add_f32 v222, v222, v226
    v_mfma_f32_16x16x32_bf16 a[20:23], a[136:139], v[200:203], a[20:23]
    v_max_f32 v227, v222, v227
    v_rcp_f32 v222, v222
    v_mfma_f32_16x16x32_bf16 a[24:27], a[152:155], v[200:203], a[24:27]
    v_mul_f32 v0, v222, v0
    v_mul_f32 v1, v222, v1
    v_mfma_f32_16x16x32_bf16 a[24:27], a[156:159], v[248:251], a[24:27]
    v_mul_f32 v2, v222, v2
    v_mul_f32 v3, v222, v3
    v_mfma_f32_16x16x32_bf16 a[24:27], a[160:163], v[40:43], a[24:27]
    v_mul_f32 v4, v222, v4
    v_mul_f32 v5, v222, v5
    v_mfma_f32_16x16x32_bf16 a[24:27], a[164:167], v[56:59], a[24:27]
    v_mul_f32 v6, v222, v6
    v_mul_f32 v7, v222, v7
    v_mfma_f32_16x16x32_bf16 a[28:31], v[108:111], v[56:59], a[28:31]
    v_cvt_pk_bf16_f32 v0, v0, v1
    v_cvt_pk_bf16_f32 v1, v2, v3
    v_mfma_f32_16x16x32_bf16 a[28:31], v[104:107], v[40:43], a[28:31]
    v_cvt_pk_bf16_f32 v2, v4, v5
    v_cvt_pk_bf16_f32 v3, v6, v7
    v_mfma_f32_16x16x32_bf16 a[28:31], v[100:103], v[248:251], a[28:31]
    v_permlane16_swap_b32 v0, v2
    v_permlane16_swap_b32 v1, v3
    v_mfma_f32_16x16x32_bf16 a[28:31], v[96:99], v[200:203], a[28:31]
    v_accvgpr_read_b32 v8, a8
    v_accvgpr_read_b32 v9, a9
    v_mfma_f32_16x16x32_bf16 a[32:35], a[168:171], v[200:203], a[32:35]
    v_accvgpr_read_b32 v10, a10
    v_accvgpr_read_b32 v11, a11
    v_mfma_f32_16x16x32_bf16 a[32:35], a[172:175], v[248:251], a[32:35]
    buffer_store_dwordx4 v[0:3], v225, s[28:31], s74 offen offset:0 sc0 sc1
    v_mfma_f32_16x16x32_bf16 a[32:35], a[176:179], v[40:43], a[32:35]
    v_accvgpr_read_b32 v12, a12
    v_accvgpr_read_b32 v13, a13
    v_mfma_f32_16x16x32_bf16 a[32:35], a[180:183], v[56:59], a[32:35]
    v_accvgpr_read_b32 v14, a14
    v_accvgpr_read_b32 v15, a15
    v_mfma_f32_16x16x32_bf16 a[36:39], a[220:223], v[56:59], a[36:39]
    v_mul_f32 v8, v222, v8
    v_mul_f32 v9, v222, v9
    v_mfma_f32_16x16x32_bf16 a[36:39], a[216:219], v[40:43], a[36:39]
    v_mul_f32 v10, v222, v10
    v_mul_f32 v11, v222, v11
    v_mfma_f32_16x16x32_bf16 a[36:39], a[188:191], v[248:251], a[36:39]
    v_mul_f32 v12, v222, v12
    v_mul_f32 v13, v222, v13
    v_mfma_f32_16x16x32_bf16 a[36:39], a[184:187], v[200:203], a[36:39]
    v_mul_f32 v14, v222, v14
    v_mul_f32 v15, v222, v15
    v_mfma_f32_16x16x32_bf16 a[40:43], a[224:227], v[200:203], a[40:43]
    v_cvt_pk_bf16_f32 v8, v8, v9
    v_cvt_pk_bf16_f32 v9, v10, v11
    v_mfma_f32_16x16x32_bf16 a[40:43], a[228:231], v[248:251], a[40:43]
    v_cvt_pk_bf16_f32 v10, v12, v13
    v_cvt_pk_bf16_f32 v11, v14, v15
    v_mfma_f32_16x16x32_bf16 a[40:43], a[232:235], v[40:43], a[40:43]
    v_permlane16_swap_b32 v8, v10
    v_permlane16_swap_b32 v9, v11
    v_mfma_f32_16x16x32_bf16 a[40:43], a[236:239], v[56:59], a[40:43]
    v_accvgpr_read_b32 v16, a16
    v_accvgpr_read_b32 v17, a17
    v_mfma_f32_16x16x32_bf16 a[44:47], v[84:87], v[56:59], a[44:47]
    v_accvgpr_read_b32 v18, a18
    v_accvgpr_read_b32 v19, a19
    v_mfma_f32_16x16x32_bf16 a[44:47], v[68:71], v[40:43], a[44:47]
    buffer_store_dwordx4 v[8:11], v225, s[28:31], s74 offen offset:64 sc0 sc1
    v_mfma_f32_16x16x32_bf16 a[44:47], v[80:83], v[248:251], a[44:47]
    v_accvgpr_read_b32 v20, a20
    v_accvgpr_read_b32 v21, a21
    v_mfma_f32_16x16x32_bf16 a[44:47], v[64:67], v[200:203], a[44:47]
    v_accvgpr_read_b32 v22, a22
    v_accvgpr_read_b32 v23, a23
    v_mfma_f32_16x16x32_bf16 a[48:51], v[24:27], v[204:207], a[48:51]
    v_mul_f32 v16, v222, v16
    v_mul_f32 v17, v222, v17
    v_mfma_f32_16x16x32_bf16 a[48:51], v[28:31], v[252:255], a[48:51]
    v_mul_f32 v18, v222, v18
    v_mul_f32 v19, v222, v19
    v_mul_f32 v20, v222, v20
    v_mul_f32 v21, v222, v21
    v_mul_f32 v22, v222, v22
    v_mul_f32 v23, v222, v23
    v_cvt_pk_bf16_f32 v16, v16, v17
    v_cvt_pk_bf16_f32 v17, v18, v19
    v_cvt_pk_bf16_f32 v18, v20, v21
    v_cvt_pk_bf16_f32 v19, v22, v23
    v_accvgpr_read_b32 v0, a24
    v_permlane16_swap_b32 v16, v18
    v_permlane16_swap_b32 v17, v19
    v_accvgpr_read_b32 v1, a25
    v_accvgpr_read_b32 v2, a26
    v_accvgpr_read_b32 v3, a27
    v_accvgpr_read_b32 v4, a28
    v_accvgpr_read_b32 v5, a29
    v_accvgpr_read_b32 v6, a30
    v_accvgpr_read_b32 v7, a31
    v_mul_f32 v0, v222, v0
    v_mul_f32 v1, v222, v1
    buffer_store_dwordx4 v[16:19], v225, s[28:31], s74 offen offset:128 sc0 sc1
    v_mul_f32 v2, v222, v2
    v_mul_f32 v3, v222, v3
    v_mul_f32 v4, v222, v4
    v_mul_f32 v5, v222, v5
    v_mul_f32 v6, v222, v6
    v_mul_f32 v7, v222, v7
    v_cvt_pk_bf16_f32 v0, v0, v1
    v_cvt_pk_bf16_f32 v1, v2, v3
    v_cvt_pk_bf16_f32 v2, v4, v5
    v_cvt_pk_bf16_f32 v3, v6, v7
    v_exp_f32 v44, v44
    v_permlane16_swap_b32 v0, v2
    v_permlane16_swap_b32 v1, v3
    v_add_f32 v223, v223, v44
    v_exp_f32 v45, v45
    v_exp_f32 v46, v46
    v_add_f32 v223, v223, v45
    v_cvt_pk_bf16_f32 v44, v44, v45
    v_accvgpr_read_b32 v8, a32
    v_accvgpr_read_b32 v9, a33
    v_accvgpr_read_b32 v10, a34
    buffer_store_dwordx4 v[0:3], v225, s[28:31], s74 offen offset:192 sc0 sc1
    v_accvgpr_read_b32 v11, a35
    v_accvgpr_read_b32 v12, a36
    v_accvgpr_read_b32 v13, a37
    v_accvgpr_read_b32 v14, a38
    v_accvgpr_read_b32 v15, a39
    v_mul_f32 v8, v222, v8
    v_mul_f32 v9, v222, v9
    v_mul_f32 v10, v222, v10
    v_mul_f32 v11, v222, v11
    v_mul_f32 v12, v222, v12
    v_mul_f32 v13, v222, v13
    v_mul_f32 v14, v222, v14
    v_mul_f32 v15, v222, v15
    v_cvt_pk_bf16_f32 v8, v8, v9
    v_cvt_pk_bf16_f32 v9, v10, v11
    v_cvt_pk_bf16_f32 v10, v12, v13
    v_cvt_pk_bf16_f32 v11, v14, v15
    v_add_f32 v223, v223, v46
    v_permlane16_swap_b32 v8, v10
    v_permlane16_swap_b32 v9, v11
    v_exp_f32 v47, v47
    v_exp_f32 v76, v76
    v_add_f32 v223, v223, v47
    v_cvt_pk_bf16_f32 v45, v46, v47
    v_add_f32 v223, v223, v76
    v_exp_f32 v77, v77
    v_exp_f32 v78, v78
    buffer_store_dwordx4 v[8:11], v225, s[28:31], s74 offen offset:256 sc0 sc1
    v_add_f32 v223, v223, v77
    v_accvgpr_read_b32 v16, a40
    v_accvgpr_read_b32 v17, a41
    v_accvgpr_read_b32 v18, a42
    v_accvgpr_read_b32 v19, a43
    v_accvgpr_read_b32 v20, a44
    v_accvgpr_read_b32 v21, a45
    v_accvgpr_read_b32 v22, a46
    v_accvgpr_read_b32 v23, a47
    v_mul_f32 v16, v222, v16
    v_mul_f32 v17, v222, v17
    v_mul_f32 v18, v222, v18
    v_mul_f32 v19, v222, v19
    v_mul_f32 v20, v222, v20
    v_mul_f32 v21, v222, v21
    v_mul_f32 v22, v222, v22
    v_mul_f32 v23, v222, v23
    v_cvt_pk_bf16_f32 v16, v16, v17
    v_cvt_pk_bf16_f32 v17, v18, v19
    v_cvt_pk_bf16_f32 v18, v20, v21
    v_cvt_pk_bf16_f32 v19, v22, v23
    v_cvt_pk_bf16_f32 v46, v76, v77
    v_permlane16_swap_b32 v16, v18
    v_permlane16_swap_b32 v17, v19
    v_add_f32 v223, v223, v78
    v_exp_f32 v79, v79
    v_exp_f32 v60, v60
    v_add_f32 v223, v223, v79
    v_cvt_pk_bf16_f32 v47, v78, v79
    v_add_f32 v223, v223, v60
    s_nop 0
    v_mfma_f32_16x16x32_bf16 a[48:51], v[232:235], v[44:47], a[48:51]
    buffer_store_dwordx4 v[16:19], v225, s[28:31], s74 offen offset:320 sc0 sc1
    v_exp_f32 v61, v61
    v_exp_f32 v62, v62
    v_add_f32 v223, v223, v61
    v_cvt_pk_bf16_f32 v60, v60, v61
    v_add_f32 v223, v223, v62
    v_exp_f32 v63, v63
    v_exp_f32 v92, v92
    v_add_f32 v223, v223, v63
    v_cvt_pk_bf16_f32 v61, v62, v63
    v_add_f32 v223, v223, v92
    v_exp_f32 v93, v93
    v_exp_f32 v94, v94
    v_add_f32 v223, v223, v93
    v_cvt_pk_bf16_f32 v62, v92, v93
    v_add_f32 v223, v223, v94
    v_exp_f32 v95, v95
    s_nop 0
    v_add_f32 v223, v223, v95
    v_cvt_pk_bf16_f32 v63, v94, v95
    v_mov_b32 v226, v223
    s_nop 0
    v_mfma_f32_16x16x32_bf16 a[48:51], v[236:239], v[60:63], a[48:51]
    v_permlane32_swap_b32 v223, v226
    s_nop 0
    v_add_f32 v223, v223, v226
    v_mfma_f32_16x16x32_bf16 a[52:55], a[204:207], v[60:63], a[52:55]
    v_mov_b32 v226, v223
    v_mfma_f32_16x16x32_bf16 a[52:55], a[200:203], v[44:47], a[52:55]
    s_nop 0
    v_permlane16_swap_b32 v223, v226
    s_nop 0
    v_add_f32 v223, v223, v226
    v_mfma_f32_16x16x32_bf16 a[52:55], a[196:199], v[252:255], a[52:55]
    v_accvgpr_read_b32 v0, a48
    v_accvgpr_read_b32 v1, a49
    v_mfma_f32_16x16x32_bf16 a[52:55], a[192:195], v[204:207], a[52:55]
    v_accvgpr_read_b32 v2, a50
    v_accvgpr_read_b32 v3, a51
    v_mfma_f32_16x16x32_bf16 a[56:59], a[208:211], v[204:207], a[56:59]
    v_max_f32 v227, v223, v227
    v_rcp_f32 v223, v223
    v_mfma_f32_16x16x32_bf16 a[56:59], a[212:215], v[252:255], a[56:59]
    v_cmp_nge_f32 vcc, s36, v227
    s_nop 1
    s_cmp_lg_u64 vcc, 0
    v_mfma_f32_16x16x32_bf16 a[56:59], a[96:99], v[44:47], a[56:59]
    s_cselect_b32 s3, 1, 0
    v_mov_b32 v230, s3
    v_mfma_f32_16x16x32_bf16 a[56:59], a[100:103], v[60:63], a[56:59]
    ds_write_b32 v228, v230
    v_accvgpr_read_b32 v4, a52
    v_mfma_f32_16x16x32_bf16 a[60:63], a[116:119], v[60:63], a[60:63]
    v_accvgpr_read_b32 v5, a53
    v_accvgpr_read_b32 v6, a54
    v_mfma_f32_16x16x32_bf16 a[60:63], a[112:115], v[44:47], a[60:63]
    v_accvgpr_read_b32 v7, a55
    v_mul_f32 v0, v223, v0
    v_mfma_f32_16x16x32_bf16 a[60:63], a[108:111], v[252:255], a[60:63]
    v_mul_f32 v1, v223, v1
    v_mul_f32 v2, v223, v2
    v_mfma_f32_16x16x32_bf16 a[60:63], a[104:107], v[204:207], a[60:63]
    v_mul_f32 v3, v223, v3
    v_mul_f32 v4, v223, v4
    v_mfma_f32_16x16x32_bf16 a[64:67], a[120:123], v[204:207], a[64:67]
    v_mul_f32 v5, v223, v5
    v_mul_f32 v6, v223, v6
    v_mfma_f32_16x16x32_bf16 a[64:67], a[124:127], v[252:255], a[64:67]
    v_mul_f32 v7, v223, v7
    v_cvt_pk_bf16_f32 v0, v0, v1
    v_mfma_f32_16x16x32_bf16 a[64:67], a[128:131], v[44:47], a[64:67]
    v_cvt_pk_bf16_f32 v1, v2, v3
    s_waitcnt lgkmcnt(0)
    s_barrier
    v_mfma_f32_16x16x32_bf16 a[64:67], a[132:135], v[60:63], a[64:67]
    ds_read_b128 v[208:211], v229
    v_cvt_pk_bf16_f32 v2, v4, v5
    v_mfma_f32_16x16x32_bf16 a[68:71], a[148:151], v[60:63], a[68:71]
    v_cvt_pk_bf16_f32 v3, v6, v7
    v_permlane16_swap_b32 v0, v2
    v_mfma_f32_16x16x32_bf16 a[68:71], a[144:147], v[44:47], a[68:71]
    v_permlane16_swap_b32 v1, v3
    v_accvgpr_read_b32 v8, a56
    v_mfma_f32_16x16x32_bf16 a[68:71], a[140:143], v[252:255], a[68:71]
    v_accvgpr_read_b32 v9, a57
    v_accvgpr_read_b32 v10, a58
    v_mfma_f32_16x16x32_bf16 a[68:71], a[136:139], v[204:207], a[68:71]
    v_accvgpr_read_b32 v11, a59
    v_accvgpr_read_b32 v12, a60
    v_mfma_f32_16x16x32_bf16 a[72:75], a[152:155], v[204:207], a[72:75]
    buffer_store_dwordx4 v[0:3], v225, s[28:31], s75 offen offset:0 sc0 sc1
    v_mfma_f32_16x16x32_bf16 a[72:75], a[156:159], v[252:255], a[72:75]
    v_accvgpr_read_b32 v13, a61
    s_waitcnt lgkmcnt(0)
    v_or3_b32 v208, v208, v209, v210
    v_mfma_f32_16x16x32_bf16 a[72:75], a[160:163], v[44:47], a[72:75]
    v_or_b32 v208, v208, v211
    v_cmp_ne_u32 vcc, 0, v208
    v_mfma_f32_16x16x32_bf16 a[72:75], a[164:167], v[60:63], a[72:75]
    v_accvgpr_read_b32 v14, a62
    v_accvgpr_read_b32 v15, a63
    v_mfma_f32_16x16x32_bf16 a[76:79], v[108:111], v[60:63], a[76:79]
    v_mul_f32 v8, v223, v8
    v_mul_f32 v9, v223, v9
    v_mfma_f32_16x16x32_bf16 a[76:79], v[104:107], v[44:47], a[76:79]
    v_mul_f32 v10, v223, v10
    v_mul_f32 v11, v223, v11
    v_mfma_f32_16x16x32_bf16 a[76:79], v[100:103], v[252:255], a[76:79]
    v_mul_f32 v12, v223, v12
    v_mul_f32 v13, v223, v13
    v_mfma_f32_16x16x32_bf16 a[76:79], v[96:99], v[204:207], a[76:79]
    v_mul_f32 v14, v223, v14
    v_mul_f32 v15, v223, v15
    v_mfma_f32_16x16x32_bf16 a[80:83], a[168:171], v[204:207], a[80:83]
    v_cvt_pk_bf16_f32 v8, v8, v9
    v_cvt_pk_bf16_f32 v9, v10, v11
    v_mfma_f32_16x16x32_bf16 a[80:83], a[172:175], v[252:255], a[80:83]
    v_cvt_pk_bf16_f32 v10, v12, v13
    v_cvt_pk_bf16_f32 v11, v14, v15
    v_mfma_f32_16x16x32_bf16 a[80:83], a[176:179], v[44:47], a[80:83]
    v_permlane16_swap_b32 v8, v10
    v_permlane16_swap_b32 v9, v11
    v_mfma_f32_16x16x32_bf16 a[80:83], a[180:183], v[60:63], a[80:83]
    v_accvgpr_read_b32 v16, a64
    v_accvgpr_read_b32 v17, a65
    v_mfma_f32_16x16x32_bf16 a[84:87], a[220:223], v[60:63], a[84:87]
    v_accvgpr_read_b32 v18, a66
    v_accvgpr_read_b32 v19, a67
    v_mfma_f32_16x16x32_bf16 a[84:87], a[216:219], v[44:47], a[84:87]
    buffer_store_dwordx4 v[8:11], v225, s[28:31], s75 offen offset:64 sc0 sc1
    v_mfma_f32_16x16x32_bf16 a[84:87], a[188:191], v[252:255], a[84:87]
    v_accvgpr_read_b32 v20, a68
    v_accvgpr_read_b32 v21, a69
    v_mfma_f32_16x16x32_bf16 a[84:87], a[184:187], v[204:207], a[84:87]
    v_accvgpr_read_b32 v22, a70
    v_accvgpr_read_b32 v23, a71
    v_mfma_f32_16x16x32_bf16 a[88:91], a[224:227], v[204:207], a[88:91]
    v_mul_f32 v16, v223, v16
    v_mul_f32 v17, v223, v17
    v_mfma_f32_16x16x32_bf16 a[88:91], a[228:231], v[252:255], a[88:91]
    v_mul_f32 v18, v223, v18
    v_mul_f32 v19, v223, v19
    v_mfma_f32_16x16x32_bf16 a[88:91], a[232:235], v[44:47], a[88:91]
    v_mul_f32 v20, v223, v20
    v_mul_f32 v21, v223, v21
    v_mfma_f32_16x16x32_bf16 a[88:91], a[236:239], v[60:63], a[88:91]
    v_mul_f32 v22, v223, v22
    v_mul_f32 v23, v223, v23
    v_mfma_f32_16x16x32_bf16 a[92:95], v[84:87], v[60:63], a[92:95]
    v_cvt_pk_bf16_f32 v16, v16, v17
    v_cvt_pk_bf16_f32 v17, v18, v19
    v_mfma_f32_16x16x32_bf16 a[92:95], v[68:71], v[44:47], a[92:95]
    v_cvt_pk_bf16_f32 v18, v20, v21
    v_cvt_pk_bf16_f32 v19, v22, v23
    v_mfma_f32_16x16x32_bf16 a[92:95], v[80:83], v[252:255], a[92:95]
    v_permlane16_swap_b32 v16, v18
    v_permlane16_swap_b32 v17, v19
    v_mfma_f32_16x16x32_bf16 a[92:95], v[64:67], v[204:207], a[92:95]
    v_accvgpr_read_b32 v0, a72
    v_accvgpr_read_b32 v1, a73
    v_accvgpr_read_b32 v2, a74
    v_accvgpr_read_b32 v3, a75
    v_accvgpr_read_b32 v4, a76
    v_accvgpr_read_b32 v5, a77
    v_accvgpr_read_b32 v6, a78
    buffer_store_dwordx4 v[16:19], v225, s[28:31], s75 offen offset:128 sc0 sc1
    v_accvgpr_read_b32 v7, a79
    v_mul_f32 v0, v223, v0
    v_mul_f32 v1, v223, v1
    v_mul_f32 v2, v223, v2
    v_mul_f32 v3, v223, v3
    v_mul_f32 v4, v223, v4
    v_mul_f32 v5, v223, v5
    v_mul_f32 v6, v223, v6
    v_mul_f32 v7, v223, v7
    v_cvt_pk_bf16_f32 v0, v0, v1
    v_cvt_pk_bf16_f32 v1, v2, v3
    v_cvt_pk_bf16_f32 v2, v4, v5
    v_cvt_pk_bf16_f32 v3, v6, v7
    v_accvgpr_read_b32 v8, a80
    v_permlane16_swap_b32 v0, v2
    v_permlane16_swap_b32 v1, v3
    v_accvgpr_read_b32 v9, a81
    v_accvgpr_read_b32 v10, a82
    v_accvgpr_read_b32 v11, a83
    v_accvgpr_read_b32 v12, a84
    v_accvgpr_read_b32 v13, a85
    v_accvgpr_read_b32 v14, a86
    v_accvgpr_read_b32 v15, a87
    v_mul_f32 v8, v223, v8
    v_mul_f32 v9, v223, v9
    buffer_store_dwordx4 v[0:3], v225, s[28:31], s75 offen offset:192 sc0 sc1
    v_mul_f32 v10, v223, v10
    v_mul_f32 v11, v223, v11
    v_mul_f32 v12, v223, v12
    v_mul_f32 v13, v223, v13
    v_mul_f32 v14, v223, v14
    v_mul_f32 v15, v223, v15
    v_cvt_pk_bf16_f32 v8, v8, v9
    v_cvt_pk_bf16_f32 v9, v10, v11
    v_cvt_pk_bf16_f32 v10, v12, v13
    v_cvt_pk_bf16_f32 v11, v14, v15
    v_accvgpr_read_b32 v16, a88
    v_permlane16_swap_b32 v8, v10
    v_permlane16_swap_b32 v9, v11
    v_accvgpr_read_b32 v17, a89
    v_accvgpr_read_b32 v18, a90
    v_accvgpr_read_b32 v19, a91
    v_accvgpr_read_b32 v20, a92
    v_accvgpr_read_b32 v21, a93
    v_accvgpr_read_b32 v22, a94
    v_accvgpr_read_b32 v23, a95
    v_mul_f32 v16, v223, v16
    v_mul_f32 v17, v223, v17
    buffer_store_dwordx4 v[8:11], v225, s[28:31], s75 offen offset:256 sc0 sc1
    v_mul_f32 v18, v223, v18
    v_mul_f32 v19, v223, v19
    v_mul_f32 v20, v223, v20
    v_mul_f32 v21, v223, v21
    v_mul_f32 v22, v223, v22
    v_mul_f32 v23, v223, v23
    v_cvt_pk_bf16_f32 v16, v16, v17
    v_cvt_pk_bf16_f32 v17, v18, v19
    v_cvt_pk_bf16_f32 v18, v20, v21
    v_cvt_pk_bf16_f32 v19, v22, v23
    s_nop 0
    v_permlane16_swap_b32 v16, v18
    v_permlane16_swap_b32 v17, v19
    s_nop 0
    buffer_store_dwordx4 v[16:19], v225, s[28:31], s75 offen offset:320 sc0 sc1
    s_nop 1
    s_cbranch_vccnz L_fallback
L_end:
    s_endpgm
L_fallback:
    s_waitcnt vmcnt(0) lgkmcnt(0)
    s_barrier
    v_mov_b32 v0, v224
    s_nop 7
    s_cmp_ge_u32 s2, 256
    s_cbranch_scc1 F_end
    s_load_dwordx8 s[4:11], s[0:1], 0
    v_mov_b32 v240, v0
    v_lshrrev_b32 v1, 6, v0
    v_and_b32 v2, 63, v0
    s_and_b32 s3, s2, 7
    v_readfirstlane_b32 s14, v1
    s_lshr_b32 s15, s2, 6
    s_lshl_b32 s3, s3, 2
    s_add_u32 s3, s3, s15
    s_lshr_b32 s15, s2, 3
    s_and_b32 s15, s15, 7
    s_mul_i32 s3, s3, 786432
    s_mul_i32 s15, s15, 98304
    s_add_u32 s15, s15, s3
    s_mul_i32 s32, s14, 3072
    s_mov_b32 s36, 0x53800000
    s_mov_b32 s38, 0x3dd53b95
    s_mov_b32 s39, 0x3dd53b95
    v_add_u32 v3, 0, v2
    v_mul_u32_u24 v3, 2731, v3
    v_lshrrev_b32 v3, 17, v3
    v_and_b32 v4, 1, v1
    v_lshl_add_u32 v4, v4, 2, v3
    v_xor_b32 v4, v4, v2
    v_lshlrev_b32 v4, 4, v4
    v_add_u32 v206, s32, v4
    v_and_b32 v4, 1, v3
    v_lshlrev_b32 v4, 2, v4
    v_xor_b32 v4, v4, v2
    v_lshlrev_b32 v4, 4, v4
    v_add_u32 v209, s32, v4
    v_add_u32 v3, 64, v2
    v_mul_u32_u24 v3, 2731, v3
    v_lshrrev_b32 v3, 17, v3
    v_and_b32 v4, 1, v1
    v_lshl_add_u32 v4, v4, 2, v3
    v_xor_b32 v4, v4, v2
    v_lshlrev_b32 v4, 4, v4
    v_add_u32 v207, s32, v4
    v_and_b32 v4, 1, v3
    v_lshlrev_b32 v4, 2, v4
    v_xor_b32 v4, v4, v2
    v_lshlrev_b32 v4, 4, v4
    v_add_u32 v210, s32, v4
    v_add_u32 v3, 128, v2
    v_mul_u32_u24 v3, 2731, v3
    v_lshrrev_b32 v3, 17, v3
    v_and_b32 v4, 1, v1
    v_lshl_add_u32 v4, v4, 2, v3
    v_xor_b32 v4, v4, v2
    v_lshlrev_b32 v4, 4, v4
    v_add_u32 v208, s32, v4
    v_and_b32 v4, 1, v3
    v_lshlrev_b32 v4, 2, v4
    v_xor_b32 v4, v4, v2
    v_lshlrev_b32 v4, 4, v4
    v_add_u32 v211, s32, v4
    v_and_b32 v5, 31, v2
    v_lshrrev_b32 v6, 5, v2
    v_lshl_add_u32 v3, v1, 6, v5
    v_mul_u32_u24 v3, 384, v3
    v_lshl_add_u32 v241, v6, 4, v3
    s_waitcnt lgkmcnt(0)
    s_add_u32 s20, s6, s3
    s_addc_u32 s21, s7, 0
    s_mov_b32 s22, 786432
    s_mov_b32 s23, 0x20000
    s_add_u32 s16, s4, s15
    s_addc_u32 s17, s5, 0
    s_mov_b32 s18, 98304
    s_mov_b32 s19, 0x20000
    s_add_u32 s24, s8, s3
    s_addc_u32 s25, s9, 0
    s_mov_b32 s26, 786432
    s_mov_b32 s27, 0x20000
    s_add_u32 s28, s10, s15
    s_addc_u32 s29, s11, 0
    s_mov_b32 s30, 98304
    s_mov_b32 s31, 0x20000
    s_mov_b32 s33, 0
    s_mov_b32 s34, 0
    s_add_u32 m0, s32, 0
    s_nop 0
    buffer_load_dwordx4 v206, s[20:23], s33 offen offset:0 lds
    buffer_load_dwordx4 v207, s[20:23], s33 offen offset:1024 lds
    buffer_load_dwordx4 v208, s[20:23], s33 offen offset:2048 lds
    s_add_u32 s33, s33, 12288
    v_mul_u32_u24 v3, 384, v5
    v_bfe_u32 v4, v5, 1, 3
    v_add_u32 v7, 0, v6
    v_xor_b32 v7, v7, v4
    v_lshl_add_u32 v200, v7, 4, v3
    v_add_u32 v7, 2, v6
    v_xor_b32 v7, v7, v4
    v_lshl_add_u32 v201, v7, 4, v3
    v_add_u32 v7, 4, v6
    v_xor_b32 v7, v7, v4
    v_lshl_add_u32 v202, v7, 4, v3
    v_add_u32 v7, 6, v6
    v_xor_b32 v7, v7, v4
    v_lshl_add_u32 v203, v7, 4, v3
    v_bfe_u32 v3, v2, 2, 2
    v_lshl_add_u32 v4, v6, 2, v3
    v_mul_u32_u24 v4, 384, v4
    v_bfe_u32 v7, v2, 4, 1
    v_lshl_add_u32 v4, v7, 5, v4
    v_and_b32 v7, 3, v2
    v_lshl_add_u32 v4, v7, 3, v4
    v_add_u32 v4, 49152, v4
    v_lshrrev_b32 v3, 1, v3
    v_lshl_add_u32 v204, v3, 6, v4
    v_xor_b32 v3, 1, v3
    v_lshl_add_u32 v205, v3, 6, v4
    v_add_u32 v242, 12288, v241
    buffer_load_dwordx4 v[0:3], v241, s[16:19], 0 offen offset:0
    buffer_load_dwordx4 v[48:51], v242, s[16:19], 0 offen offset:0
    buffer_load_dwordx4 v[4:7], v241, s[16:19], 0 offen offset:32
    buffer_load_dwordx4 v[52:55], v242, s[16:19], 0 offen offset:32
    buffer_load_dwordx4 v[8:11], v241, s[16:19], 0 offen offset:64
    buffer_load_dwordx4 v[56:59], v242, s[16:19], 0 offen offset:64
    buffer_load_dwordx4 v[12:15], v241, s[16:19], 0 offen offset:96
    buffer_load_dwordx4 v[60:63], v242, s[16:19], 0 offen offset:96
    buffer_load_dwordx4 v[16:19], v241, s[16:19], 0 offen offset:128
    buffer_load_dwordx4 v[160:163], v242, s[16:19], 0 offen offset:128
    buffer_load_dwordx4 v[20:23], v241, s[16:19], 0 offen offset:160
    buffer_load_dwordx4 v[164:167], v242, s[16:19], 0 offen offset:160
    buffer_load_dwordx4 v[24:27], v241, s[16:19], 0 offen offset:192
    buffer_load_dwordx4 v[168:171], v242, s[16:19], 0 offen offset:192
    buffer_load_dwordx4 v[28:31], v241, s[16:19], 0 offen offset:224
    buffer_load_dwordx4 v[172:175], v242, s[16:19], 0 offen offset:224
    buffer_load_dwordx4 v[32:35], v241, s[16:19], 0 offen offset:256
    buffer_load_dwordx4 v[176:179], v242, s[16:19], 0 offen offset:256
    buffer_load_dwordx4 v[36:39], v241, s[16:19], 0 offen offset:288
    buffer_load_dwordx4 v[180:183], v242, s[16:19], 0 offen offset:288
    buffer_load_dwordx4 v[40:43], v241, s[16:19], 0 offen offset:320
    buffer_load_dwordx4 v[184:187], v242, s[16:19], 0 offen offset:320
    buffer_load_dwordx4 v[44:47], v241, s[16:19], 0 offen offset:352
    buffer_load_dwordx4 v[188:191], v242, s[16:19], 0 offen offset:352
    s_add_u32 m0, s32, 12288
    s_nop 0
    buffer_load_dwordx4 v206, s[20:23], s33 offen offset:0 lds
    buffer_load_dwordx4 v207, s[20:23], s33 offen offset:1024 lds
    buffer_load_dwordx4 v208, s[20:23], s33 offen offset:2048 lds
    s_add_u32 s33, s33, 12288
    s_add_u32 m0, s32, 49152
    s_nop 0
    buffer_load_dwordx4 v209, s[24:27], s34 offen offset:0 lds
    buffer_load_dwordx4 v210, s[24:27], s34 offen offset:1024 lds
    buffer_load_dwordx4 v211, s[24:27], s34 offen offset:2048 lds
    s_add_u32 s34, s34, 12288
    s_add_u32 m0, s32, 24576
    s_nop 0
    buffer_load_dwordx4 v206, s[20:23], s33 offen offset:0 lds
    buffer_load_dwordx4 v207, s[20:23], s33 offen offset:1024 lds
    buffer_load_dwordx4 v208, s[20:23], s33 offen offset:2048 lds
    s_add_u32 s33, s33, 12288
    s_add_u32 m0, s32, 61440
    s_nop 0
    buffer_load_dwordx4 v209, s[24:27], s34 offen offset:0 lds
    buffer_load_dwordx4 v210, s[24:27], s34 offen offset:1024 lds
    buffer_load_dwordx4 v211, s[24:27], s34 offen offset:2048 lds
    s_add_u32 s34, s34, 12288
    s_add_u32 m0, s32, 36864
    s_nop 0
    buffer_load_dwordx4 v206, s[20:23], s33 offen offset:0 lds
    buffer_load_dwordx4 v207, s[20:23], s33 offen offset:1024 lds
    buffer_load_dwordx4 v208, s[20:23], s33 offen offset:2048 lds
    s_add_u32 s33, s33, 12288
    v_mov_b32 v212, 0
    v_mov_b32 v213, 0
    v_accvgpr_write_b32 a0, 0
    v_accvgpr_write_b32 a1, 0
    v_accvgpr_write_b32 a2, 0
    v_accvgpr_write_b32 a3, 0
    v_accvgpr_write_b32 a4, 0
    v_accvgpr_write_b32 a5, 0
    v_accvgpr_write_b32 a6, 0
    v_accvgpr_write_b32 a7, 0
    v_accvgpr_write_b32 a8, 0
    v_accvgpr_write_b32 a9, 0
    v_accvgpr_write_b32 a10, 0
    v_accvgpr_write_b32 a11, 0
    v_accvgpr_write_b32 a12, 0
    v_accvgpr_write_b32 a13, 0
    v_accvgpr_write_b32 a14, 0
    v_accvgpr_write_b32 a15, 0
    v_accvgpr_write_b32 a16, 0
    v_accvgpr_write_b32 a17, 0
    v_accvgpr_write_b32 a18, 0
    v_accvgpr_write_b32 a19, 0
    v_accvgpr_write_b32 a20, 0
    v_accvgpr_write_b32 a21, 0
    v_accvgpr_write_b32 a22, 0
    v_accvgpr_write_b32 a23, 0
    v_accvgpr_write_b32 a24, 0
    v_accvgpr_write_b32 a25, 0
    v_accvgpr_write_b32 a26, 0
    v_accvgpr_write_b32 a27, 0
    v_accvgpr_write_b32 a28, 0
    v_accvgpr_write_b32 a29, 0
    v_accvgpr_write_b32 a30, 0
    v_accvgpr_write_b32 a31, 0
    v_accvgpr_write_b32 a32, 0
    v_accvgpr_write_b32 a33, 0
    v_accvgpr_write_b32 a34, 0
    v_accvgpr_write_b32 a35, 0
    v_accvgpr_write_b32 a36, 0
    v_accvgpr_write_b32 a37, 0
    v_accvgpr_write_b32 a38, 0
    v_accvgpr_write_b32 a39, 0
    v_accvgpr_write_b32 a40, 0
    v_accvgpr_write_b32 a41, 0
    v_accvgpr_write_b32 a42, 0
    v_accvgpr_write_b32 a43, 0
    v_accvgpr_write_b32 a44, 0
    v_accvgpr_write_b32 a45, 0
    v_accvgpr_write_b32 a46, 0
    v_accvgpr_write_b32 a47, 0
    v_accvgpr_write_b32 a48, 0
    v_accvgpr_write_b32 a49, 0
    v_accvgpr_write_b32 a50, 0
    v_accvgpr_write_b32 a51, 0
    v_accvgpr_write_b32 a52, 0
    v_accvgpr_write_b32 a53, 0
    v_accvgpr_write_b32 a54, 0
    v_accvgpr_write_b32 a55, 0
    v_accvgpr_write_b32 a56, 0
    v_accvgpr_write_b32 a57, 0
    v_accvgpr_write_b32 a58, 0
    v_accvgpr_write_b32 a59, 0
    v_accvgpr_write_b32 a60, 0
    v_accvgpr_write_b32 a61, 0
    v_accvgpr_write_b32 a62, 0
    v_accvgpr_write_b32 a63, 0
    v_accvgpr_write_b32 a64, 0
    v_accvgpr_write_b32 a65, 0
    v_accvgpr_write_b32 a66, 0
    v_accvgpr_write_b32 a67, 0
    v_accvgpr_write_b32 a68, 0
    v_accvgpr_write_b32 a69, 0
    v_accvgpr_write_b32 a70, 0
    v_accvgpr_write_b32 a71, 0
    v_accvgpr_write_b32 a72, 0
    v_accvgpr_write_b32 a73, 0
    v_accvgpr_write_b32 a74, 0
    v_accvgpr_write_b32 a75, 0
    v_accvgpr_write_b32 a76, 0
    v_accvgpr_write_b32 a77, 0
    v_accvgpr_write_b32 a78, 0
    v_accvgpr_write_b32 a79, 0
    v_accvgpr_write_b32 a80, 0
    v_accvgpr_write_b32 a81, 0
    v_accvgpr_write_b32 a82, 0
    v_accvgpr_write_b32 a83, 0
    v_accvgpr_write_b32 a84, 0
    v_accvgpr_write_b32 a85, 0
    v_accvgpr_write_b32 a86, 0
    v_accvgpr_write_b32 a87, 0
    v_accvgpr_write_b32 a88, 0
    v_accvgpr_write_b32 a89, 0
    v_accvgpr_write_b32 a90, 0
    v_accvgpr_write_b32 a91, 0
    v_accvgpr_write_b32 a92, 0
    v_accvgpr_write_b32 a93, 0
    v_accvgpr_write_b32 a94, 0
    v_accvgpr_write_b32 a95, 0
    v_accvgpr_write_b32 a96, 0
    v_accvgpr_write_b32 a97, 0
    v_accvgpr_write_b32 a98, 0
    v_accvgpr_write_b32 a99, 0
    v_accvgpr_write_b32 a100, 0
    v_accvgpr_write_b32 a101, 0
    v_accvgpr_write_b32 a102, 0
    v_accvgpr_write_b32 a103, 0
    v_accvgpr_write_b32 a104, 0
    v_accvgpr_write_b32 a105, 0
    v_accvgpr_write_b32 a106, 0
    v_accvgpr_write_b32 a107, 0
    v_accvgpr_write_b32 a108, 0
    v_accvgpr_write_b32 a109, 0
    v_accvgpr_write_b32 a110, 0
    v_accvgpr_write_b32 a111, 0
    v_accvgpr_write_b32 a112, 0
    v_accvgpr_write_b32 a113, 0
    v_accvgpr_write_b32 a114, 0
    v_accvgpr_write_b32 a115, 0
    v_accvgpr_write_b32 a116, 0
    v_accvgpr_write_b32 a117, 0
    v_accvgpr_write_b32 a118, 0
    v_accvgpr_write_b32 a119, 0
    v_accvgpr_write_b32 a120, 0
    v_accvgpr_write_b32 a121, 0
    v_accvgpr_write_b32 a122, 0
    v_accvgpr_write_b32 a123, 0
    v_accvgpr_write_b32 a124, 0
    v_accvgpr_write_b32 a125, 0
    v_accvgpr_write_b32 a126, 0
    v_accvgpr_write_b32 a127, 0
    v_accvgpr_write_b32 a128, 0
    v_accvgpr_write_b32 a129, 0
    v_accvgpr_write_b32 a130, 0
    v_accvgpr_write_b32 a131, 0
    v_accvgpr_write_b32 a132, 0
    v_accvgpr_write_b32 a133, 0
    v_accvgpr_write_b32 a134, 0
    v_accvgpr_write_b32 a135, 0
    v_accvgpr_write_b32 a136, 0
    v_accvgpr_write_b32 a137, 0
    v_accvgpr_write_b32 a138, 0
    v_accvgpr_write_b32 a139, 0
    v_accvgpr_write_b32 a140, 0
    v_accvgpr_write_b32 a141, 0
    v_accvgpr_write_b32 a142, 0
    v_accvgpr_write_b32 a143, 0
    v_accvgpr_write_b32 a144, 0
    v_accvgpr_write_b32 a145, 0
    v_accvgpr_write_b32 a146, 0
    v_accvgpr_write_b32 a147, 0
    v_accvgpr_write_b32 a148, 0
    v_accvgpr_write_b32 a149, 0
    v_accvgpr_write_b32 a150, 0
    v_accvgpr_write_b32 a151, 0
    v_accvgpr_write_b32 a152, 0
    v_accvgpr_write_b32 a153, 0
    v_accvgpr_write_b32 a154, 0
    v_accvgpr_write_b32 a155, 0
    v_accvgpr_write_b32 a156, 0
    v_accvgpr_write_b32 a157, 0
    v_accvgpr_write_b32 a158, 0
    v_accvgpr_write_b32 a159, 0
    v_accvgpr_write_b32 a160, 0
    v_accvgpr_write_b32 a161, 0
    v_accvgpr_write_b32 a162, 0
    v_accvgpr_write_b32 a163, 0
    v_accvgpr_write_b32 a164, 0
    v_accvgpr_write_b32 a165, 0
    v_accvgpr_write_b32 a166, 0
    v_accvgpr_write_b32 a167, 0
    v_accvgpr_write_b32 a168, 0
    v_accvgpr_write_b32 a169, 0
    v_accvgpr_write_b32 a170, 0
    v_accvgpr_write_b32 a171, 0
    v_accvgpr_write_b32 a172, 0
    v_accvgpr_write_b32 a173, 0
    v_accvgpr_write_b32 a174, 0
    v_accvgpr_write_b32 a175, 0
    v_accvgpr_write_b32 a176, 0
    v_accvgpr_write_b32 a177, 0
    v_accvgpr_write_b32 a178, 0
    v_accvgpr_write_b32 a179, 0
    v_accvgpr_write_b32 a180, 0
    v_accvgpr_write_b32 a181, 0
    v_accvgpr_write_b32 a182, 0
    v_accvgpr_write_b32 a183, 0
    v_accvgpr_write_b32 a184, 0
    v_accvgpr_write_b32 a185, 0
    v_accvgpr_write_b32 a186, 0
    v_accvgpr_write_b32 a187, 0
    v_accvgpr_write_b32 a188, 0
    v_accvgpr_write_b32 a189, 0
    v_accvgpr_write_b32 a190, 0
    v_accvgpr_write_b32 a191, 0
    s_waitcnt vmcnt(38)
    v_lshlrev_b32 v216, 16, v0
    v_and_b32 v217, 0xffff0000, v0
    v_lshlrev_b32 v218, 16, v1
    v_and_b32 v219, 0xffff0000, v1
    v_lshlrev_b32 v220, 16, v2
    v_and_b32 v221, 0xffff0000, v2
    v_lshlrev_b32 v222, 16, v3
    v_and_b32 v223, 0xffff0000, v3
    v_mul_f32 v216, s38, v216
    v_mul_f32 v217, s38, v217
    v_mul_f32 v218, s38, v218
    v_mul_f32 v219, s38, v219
    v_mul_f32 v220, s38, v220
    v_mul_f32 v221, s38, v221
    v_mul_f32 v222, s38, v222
    v_mul_f32 v223, s38, v223
    v_cvt_pk_bf16_f32 v0, v216, v217
    v_cvt_pk_bf16_f32 v1, v218, v219
    v_cvt_pk_bf16_f32 v2, v220, v221
    v_cvt_pk_bf16_f32 v3, v222, v223
    v_accvgpr_write_b32 a192, v0
    v_accvgpr_write_b32 a193, v1
    v_accvgpr_write_b32 a194, v2
    v_accvgpr_write_b32 a195, v3
    s_waitcnt vmcnt(37)
    v_lshlrev_b32 v216, 16, v48
    v_and_b32 v217, 0xffff0000, v48
    v_lshlrev_b32 v218, 16, v49
    v_and_b32 v219, 0xffff0000, v49
    v_lshlrev_b32 v220, 16, v50
    v_and_b32 v221, 0xffff0000, v50
    v_lshlrev_b32 v222, 16, v51
    v_and_b32 v223, 0xffff0000, v51
    v_mul_f32 v216, s38, v216
    v_mul_f32 v217, s38, v217
    v_mul_f32 v218, s38, v218
    v_mul_f32 v219, s38, v219
    v_mul_f32 v220, s38, v220
    v_mul_f32 v221, s38, v221
    v_mul_f32 v222, s38, v222
    v_mul_f32 v223, s38, v223
    v_cvt_pk_bf16_f32 v48, v216, v217
    v_cvt_pk_bf16_f32 v49, v218, v219
    v_cvt_pk_bf16_f32 v50, v220, v221
    v_cvt_pk_bf16_f32 v51, v222, v223
    v_accvgpr_write_b32 a240, v48
    v_accvgpr_write_b32 a241, v49
    v_accvgpr_write_b32 a242, v50
    v_accvgpr_write_b32 a243, v51
    s_waitcnt vmcnt(36)
    v_lshlrev_b32 v216, 16, v4
    v_and_b32 v217, 0xffff0000, v4
    v_lshlrev_b32 v218, 16, v5
    v_and_b32 v219, 0xffff0000, v5
    v_lshlrev_b32 v220, 16, v6
    v_and_b32 v221, 0xffff0000, v6
    v_lshlrev_b32 v222, 16, v7
    v_and_b32 v223, 0xffff0000, v7
    v_mul_f32 v216, s38, v216
    v_mul_f32 v217, s38, v217
    v_mul_f32 v218, s38, v218
    v_mul_f32 v219, s38, v219
    v_mul_f32 v220, s38, v220
    v_mul_f32 v221, s38, v221
    v_mul_f32 v222, s38, v222
    v_mul_f32 v223, s38, v223
    v_cvt_pk_bf16_f32 v4, v216, v217
    v_cvt_pk_bf16_f32 v5, v218, v219
    v_cvt_pk_bf16_f32 v6, v220, v221
    v_cvt_pk_bf16_f32 v7, v222, v223
    v_accvgpr_write_b32 a196, v4
    v_accvgpr_write_b32 a197, v5
    v_accvgpr_write_b32 a198, v6
    v_accvgpr_write_b32 a199, v7
    s_waitcnt vmcnt(35)
    v_lshlrev_b32 v216, 16, v52
    v_and_b32 v217, 0xffff0000, v52
    v_lshlrev_b32 v218, 16, v53
    v_and_b32 v219, 0xffff0000, v53
    v_lshlrev_b32 v220, 16, v54
    v_and_b32 v221, 0xffff0000, v54
    v_lshlrev_b32 v222, 16, v55
    v_and_b32 v223, 0xffff0000, v55
    v_mul_f32 v216, s38, v216
    v_mul_f32 v217, s38, v217
    v_mul_f32 v218, s38, v218
    v_mul_f32 v219, s38, v219
    v_mul_f32 v220, s38, v220
    v_mul_f32 v221, s38, v221
    v_mul_f32 v222, s38, v222
    v_mul_f32 v223, s38, v223
    v_cvt_pk_bf16_f32 v52, v216, v217
    v_cvt_pk_bf16_f32 v53, v218, v219
    v_cvt_pk_bf16_f32 v54, v220, v221
    v_cvt_pk_bf16_f32 v55, v222, v223
    v_accvgpr_write_b32 a244, v52
    v_accvgpr_write_b32 a245, v53
    v_accvgpr_write_b32 a246, v54
    v_accvgpr_write_b32 a247, v55
    s_waitcnt vmcnt(34)
    v_lshlrev_b32 v216, 16, v8
    v_and_b32 v217, 0xffff0000, v8
    v_lshlrev_b32 v218, 16, v9
    v_and_b32 v219, 0xffff0000, v9
    v_lshlrev_b32 v220, 16, v10
    v_and_b32 v221, 0xffff0000, v10
    v_lshlrev_b32 v222, 16, v11
    v_and_b32 v223, 0xffff0000, v11
    v_mul_f32 v216, s38, v216
    v_mul_f32 v217, s38, v217
    v_mul_f32 v218, s38, v218
    v_mul_f32 v219, s38, v219
    v_mul_f32 v220, s38, v220
    v_mul_f32 v221, s38, v221
    v_mul_f32 v222, s38, v222
    v_mul_f32 v223, s38, v223
    v_cvt_pk_bf16_f32 v8, v216, v217
    v_cvt_pk_bf16_f32 v9, v218, v219
    v_cvt_pk_bf16_f32 v10, v220, v221
    v_cvt_pk_bf16_f32 v11, v222, v223
    v_accvgpr_write_b32 a200, v8
    v_accvgpr_write_b32 a201, v9
    v_accvgpr_write_b32 a202, v10
    v_accvgpr_write_b32 a203, v11
    s_waitcnt vmcnt(33)
    v_lshlrev_b32 v216, 16, v56
    v_and_b32 v217, 0xffff0000, v56
    v_lshlrev_b32 v218, 16, v57
    v_and_b32 v219, 0xffff0000, v57
    v_lshlrev_b32 v220, 16, v58
    v_and_b32 v221, 0xffff0000, v58
    v_lshlrev_b32 v222, 16, v59
    v_and_b32 v223, 0xffff0000, v59
    v_mul_f32 v216, s38, v216
    v_mul_f32 v217, s38, v217
    v_mul_f32 v218, s38, v218
    v_mul_f32 v219, s38, v219
    v_mul_f32 v220, s38, v220
    v_mul_f32 v221, s38, v221
    v_mul_f32 v222, s38, v222
    v_mul_f32 v223, s38, v223
    v_cvt_pk_bf16_f32 v56, v216, v217
    v_cvt_pk_bf16_f32 v57, v218, v219
    v_cvt_pk_bf16_f32 v58, v220, v221
    v_cvt_pk_bf16_f32 v59, v222, v223
    v_accvgpr_write_b32 a248, v56
    v_accvgpr_write_b32 a249, v57
    v_accvgpr_write_b32 a250, v58
    v_accvgpr_write_b32 a251, v59
    s_waitcnt vmcnt(32)
    v_lshlrev_b32 v216, 16, v12
    v_and_b32 v217, 0xffff0000, v12
    v_lshlrev_b32 v218, 16, v13
    v_and_b32 v219, 0xffff0000, v13
    v_lshlrev_b32 v220, 16, v14
    v_and_b32 v221, 0xffff0000, v14
    v_lshlrev_b32 v222, 16, v15
    v_and_b32 v223, 0xffff0000, v15
    v_mul_f32 v216, s38, v216
    v_mul_f32 v217, s38, v217
    v_mul_f32 v218, s38, v218
    v_mul_f32 v219, s38, v219
    v_mul_f32 v220, s38, v220
    v_mul_f32 v221, s38, v221
    v_mul_f32 v222, s38, v222
    v_mul_f32 v223, s38, v223
    v_cvt_pk_bf16_f32 v12, v216, v217
    v_cvt_pk_bf16_f32 v13, v218, v219
    v_cvt_pk_bf16_f32 v14, v220, v221
    v_cvt_pk_bf16_f32 v15, v222, v223
    v_accvgpr_write_b32 a204, v12
    v_accvgpr_write_b32 a205, v13
    v_accvgpr_write_b32 a206, v14
    v_accvgpr_write_b32 a207, v15
    s_waitcnt vmcnt(31)
    v_lshlrev_b32 v216, 16, v60
    v_and_b32 v217, 0xffff0000, v60
    v_lshlrev_b32 v218, 16, v61
    v_and_b32 v219, 0xffff0000, v61
    v_lshlrev_b32 v220, 16, v62
    v_and_b32 v221, 0xffff0000, v62
    v_lshlrev_b32 v222, 16, v63
    v_and_b32 v223, 0xffff0000, v63
    v_mul_f32 v216, s38, v216
    v_mul_f32 v217, s38, v217
    v_mul_f32 v218, s38, v218
    v_mul_f32 v219, s38, v219
    v_mul_f32 v220, s38, v220
    v_mul_f32 v221, s38, v221
    v_mul_f32 v222, s38, v222
    v_mul_f32 v223, s38, v223
    v_cvt_pk_bf16_f32 v60, v216, v217
    v_cvt_pk_bf16_f32 v61, v218, v219
    v_cvt_pk_bf16_f32 v62, v220, v221
    v_cvt_pk_bf16_f32 v63, v222, v223
    v_accvgpr_write_b32 a252, v60
    v_accvgpr_write_b32 a253, v61
    v_accvgpr_write_b32 a254, v62
    v_accvgpr_write_b32 a255, v63
    s_waitcnt vmcnt(30)
    v_lshlrev_b32 v216, 16, v16
    v_and_b32 v217, 0xffff0000, v16
    v_lshlrev_b32 v218, 16, v17
    v_and_b32 v219, 0xffff0000, v17
    v_lshlrev_b32 v220, 16, v18
    v_and_b32 v221, 0xffff0000, v18
    v_lshlrev_b32 v222, 16, v19
    v_and_b32 v223, 0xffff0000, v19
    v_mul_f32 v216, s38, v216
    v_mul_f32 v217, s38, v217
    v_mul_f32 v218, s38, v218
    v_mul_f32 v219, s38, v219
    v_mul_f32 v220, s38, v220
    v_mul_f32 v221, s38, v221
    v_mul_f32 v222, s38, v222
    v_mul_f32 v223, s38, v223
    v_cvt_pk_bf16_f32 v16, v216, v217
    v_cvt_pk_bf16_f32 v17, v218, v219
    v_cvt_pk_bf16_f32 v18, v220, v221
    v_cvt_pk_bf16_f32 v19, v222, v223
    v_accvgpr_write_b32 a208, v16
    v_accvgpr_write_b32 a209, v17
    v_accvgpr_write_b32 a210, v18
    v_accvgpr_write_b32 a211, v19
    s_waitcnt vmcnt(29)
    v_lshlrev_b32 v216, 16, v160
    v_and_b32 v217, 0xffff0000, v160
    v_lshlrev_b32 v218, 16, v161
    v_and_b32 v219, 0xffff0000, v161
    v_lshlrev_b32 v220, 16, v162
    v_and_b32 v221, 0xffff0000, v162
    v_lshlrev_b32 v222, 16, v163
    v_and_b32 v223, 0xffff0000, v163
    v_mul_f32 v216, s38, v216
    v_mul_f32 v217, s38, v217
    v_mul_f32 v218, s38, v218
    v_mul_f32 v219, s38, v219
    v_mul_f32 v220, s38, v220
    v_mul_f32 v221, s38, v221
    v_mul_f32 v222, s38, v222
    v_mul_f32 v223, s38, v223
    v_cvt_pk_bf16_f32 v160, v216, v217
    v_cvt_pk_bf16_f32 v161, v218, v219
    v_cvt_pk_bf16_f32 v162, v220, v221
    v_cvt_pk_bf16_f32 v163, v222, v223
    s_waitcnt vmcnt(28)
    v_lshlrev_b32 v216, 16, v20
    v_and_b32 v217, 0xffff0000, v20
    v_lshlrev_b32 v218, 16, v21
    v_and_b32 v219, 0xffff0000, v21
    v_lshlrev_b32 v220, 16, v22
    v_and_b32 v221, 0xffff0000, v22
    v_lshlrev_b32 v222, 16, v23
    v_and_b32 v223, 0xffff0000, v23
    v_mul_f32 v216, s38, v216
    v_mul_f32 v217, s38, v217
    v_mul_f32 v218, s38, v218
    v_mul_f32 v219, s38, v219
    v_mul_f32 v220, s38, v220
    v_mul_f32 v221, s38, v221
    v_mul_f32 v222, s38, v222
    v_mul_f32 v223, s38, v223
    v_cvt_pk_bf16_f32 v20, v216, v217
    v_cvt_pk_bf16_f32 v21, v218, v219
    v_cvt_pk_bf16_f32 v22, v220, v221
    v_cvt_pk_bf16_f32 v23, v222, v223
    v_accvgpr_write_b32 a212, v20
    v_accvgpr_write_b32 a213, v21
    v_accvgpr_write_b32 a214, v22
    v_accvgpr_write_b32 a215, v23
    s_waitcnt vmcnt(27)
    v_lshlrev_b32 v216, 16, v164
    v_and_b32 v217, 0xffff0000, v164
    v_lshlrev_b32 v218, 16, v165
    v_and_b32 v219, 0xffff0000, v165
    v_lshlrev_b32 v220, 16, v166
    v_and_b32 v221, 0xffff0000, v166
    v_lshlrev_b32 v222, 16, v167
    v_and_b32 v223, 0xffff0000, v167
    v_mul_f32 v216, s38, v216
    v_mul_f32 v217, s38, v217
    v_mul_f32 v218, s38, v218
    v_mul_f32 v219, s38, v219
    v_mul_f32 v220, s38, v220
    v_mul_f32 v221, s38, v221
    v_mul_f32 v222, s38, v222
    v_mul_f32 v223, s38, v223
    v_cvt_pk_bf16_f32 v164, v216, v217
    v_cvt_pk_bf16_f32 v165, v218, v219
    v_cvt_pk_bf16_f32 v166, v220, v221
    v_cvt_pk_bf16_f32 v167, v222, v223
    s_waitcnt vmcnt(26)
    v_lshlrev_b32 v216, 16, v24
    v_and_b32 v217, 0xffff0000, v24
    v_lshlrev_b32 v218, 16, v25
    v_and_b32 v219, 0xffff0000, v25
    v_lshlrev_b32 v220, 16, v26
    v_and_b32 v221, 0xffff0000, v26
    v_lshlrev_b32 v222, 16, v27
    v_and_b32 v223, 0xffff0000, v27
    v_mul_f32 v216, s38, v216
    v_mul_f32 v217, s38, v217
    v_mul_f32 v218, s38, v218
    v_mul_f32 v219, s38, v219
    v_mul_f32 v220, s38, v220
    v_mul_f32 v221, s38, v221
    v_mul_f32 v222, s38, v222
    v_mul_f32 v223, s38, v223
    v_cvt_pk_bf16_f32 v24, v216, v217
    v_cvt_pk_bf16_f32 v25, v218, v219
    v_cvt_pk_bf16_f32 v26, v220, v221
    v_cvt_pk_bf16_f32 v27, v222, v223
    v_accvgpr_write_b32 a216, v24
    v_accvgpr_write_b32 a217, v25
    v_accvgpr_write_b32 a218, v26
    v_accvgpr_write_b32 a219, v27
    s_waitcnt vmcnt(25)
    v_lshlrev_b32 v216, 16, v168
    v_and_b32 v217, 0xffff0000, v168
    v_lshlrev_b32 v218, 16, v169
    v_and_b32 v219, 0xffff0000, v169
    v_lshlrev_b32 v220, 16, v170
    v_and_b32 v221, 0xffff0000, v170
    v_lshlrev_b32 v222, 16, v171
    v_and_b32 v223, 0xffff0000, v171
    v_mul_f32 v216, s38, v216
    v_mul_f32 v217, s38, v217
    v_mul_f32 v218, s38, v218
    v_mul_f32 v219, s38, v219
    v_mul_f32 v220, s38, v220
    v_mul_f32 v221, s38, v221
    v_mul_f32 v222, s38, v222
    v_mul_f32 v223, s38, v223
    v_cvt_pk_bf16_f32 v168, v216, v217
    v_cvt_pk_bf16_f32 v169, v218, v219
    v_cvt_pk_bf16_f32 v170, v220, v221
    v_cvt_pk_bf16_f32 v171, v222, v223
    s_waitcnt vmcnt(24)
    v_lshlrev_b32 v216, 16, v28
    v_and_b32 v217, 0xffff0000, v28
    v_lshlrev_b32 v218, 16, v29
    v_and_b32 v219, 0xffff0000, v29
    v_lshlrev_b32 v220, 16, v30
    v_and_b32 v221, 0xffff0000, v30
    v_lshlrev_b32 v222, 16, v31
    v_and_b32 v223, 0xffff0000, v31
    v_mul_f32 v216, s38, v216
    v_mul_f32 v217, s38, v217
    v_mul_f32 v218, s38, v218
    v_mul_f32 v219, s38, v219
    v_mul_f32 v220, s38, v220
    v_mul_f32 v221, s38, v221
    v_mul_f32 v222, s38, v222
    v_mul_f32 v223, s38, v223
    v_cvt_pk_bf16_f32 v28, v216, v217
    v_cvt_pk_bf16_f32 v29, v218, v219
    v_cvt_pk_bf16_f32 v30, v220, v221
    v_cvt_pk_bf16_f32 v31, v222, v223
    v_accvgpr_write_b32 a220, v28
    v_accvgpr_write_b32 a221, v29
    v_accvgpr_write_b32 a222, v30
    v_accvgpr_write_b32 a223, v31
    s_waitcnt vmcnt(23)
    v_lshlrev_b32 v216, 16, v172
    v_and_b32 v217, 0xffff0000, v172
    v_lshlrev_b32 v218, 16, v173
    v_and_b32 v219, 0xffff0000, v173
    v_lshlrev_b32 v220, 16, v174
    v_and_b32 v221, 0xffff0000, v174
    v_lshlrev_b32 v222, 16, v175
    v_and_b32 v223, 0xffff0000, v175
    v_mul_f32 v216, s38, v216
    v_mul_f32 v217, s38, v217
    v_mul_f32 v218, s38, v218
    v_mul_f32 v219, s38, v219
    v_mul_f32 v220, s38, v220
    v_mul_f32 v221, s38, v221
    v_mul_f32 v222, s38, v222
    v_mul_f32 v223, s38, v223
    v_cvt_pk_bf16_f32 v172, v216, v217
    v_cvt_pk_bf16_f32 v173, v218, v219
    v_cvt_pk_bf16_f32 v174, v220, v221
    v_cvt_pk_bf16_f32 v175, v222, v223
    s_waitcnt vmcnt(22)
    v_lshlrev_b32 v216, 16, v32
    v_and_b32 v217, 0xffff0000, v32
    v_lshlrev_b32 v218, 16, v33
    v_and_b32 v219, 0xffff0000, v33
    v_lshlrev_b32 v220, 16, v34
    v_and_b32 v221, 0xffff0000, v34
    v_lshlrev_b32 v222, 16, v35
    v_and_b32 v223, 0xffff0000, v35
    v_mul_f32 v216, s38, v216
    v_mul_f32 v217, s38, v217
    v_mul_f32 v218, s38, v218
    v_mul_f32 v219, s38, v219
    v_mul_f32 v220, s38, v220
    v_mul_f32 v221, s38, v221
    v_mul_f32 v222, s38, v222
    v_mul_f32 v223, s38, v223
    v_cvt_pk_bf16_f32 v32, v216, v217
    v_cvt_pk_bf16_f32 v33, v218, v219
    v_cvt_pk_bf16_f32 v34, v220, v221
    v_cvt_pk_bf16_f32 v35, v222, v223
    v_accvgpr_write_b32 a224, v32
    v_accvgpr_write_b32 a225, v33
    v_accvgpr_write_b32 a226, v34
    v_accvgpr_write_b32 a227, v35
    s_waitcnt vmcnt(21)
    v_lshlrev_b32 v216, 16, v176
    v_and_b32 v217, 0xffff0000, v176
    v_lshlrev_b32 v218, 16, v177
    v_and_b32 v219, 0xffff0000, v177
    v_lshlrev_b32 v220, 16, v178
    v_and_b32 v221, 0xffff0000, v178
    v_lshlrev_b32 v222, 16, v179
    v_and_b32 v223, 0xffff0000, v179
    v_mul_f32 v216, s38, v216
    v_mul_f32 v217, s38, v217
    v_mul_f32 v218, s38, v218
    v_mul_f32 v219, s38, v219
    v_mul_f32 v220, s38, v220
    v_mul_f32 v221, s38, v221
    v_mul_f32 v222, s38, v222
    v_mul_f32 v223, s38, v223
    v_cvt_pk_bf16_f32 v176, v216, v217
    v_cvt_pk_bf16_f32 v177, v218, v219
    v_cvt_pk_bf16_f32 v178, v220, v221
    v_cvt_pk_bf16_f32 v179, v222, v223
    s_waitcnt vmcnt(20)
    v_lshlrev_b32 v216, 16, v36
    v_and_b32 v217, 0xffff0000, v36
    v_lshlrev_b32 v218, 16, v37
    v_and_b32 v219, 0xffff0000, v37
    v_lshlrev_b32 v220, 16, v38
    v_and_b32 v221, 0xffff0000, v38
    v_lshlrev_b32 v222, 16, v39
    v_and_b32 v223, 0xffff0000, v39
    v_mul_f32 v216, s38, v216
    v_mul_f32 v217, s38, v217
    v_mul_f32 v218, s38, v218
    v_mul_f32 v219, s38, v219
    v_mul_f32 v220, s38, v220
    v_mul_f32 v221, s38, v221
    v_mul_f32 v222, s38, v222
    v_mul_f32 v223, s38, v223
    v_cvt_pk_bf16_f32 v36, v216, v217
    v_cvt_pk_bf16_f32 v37, v218, v219
    v_cvt_pk_bf16_f32 v38, v220, v221
    v_cvt_pk_bf16_f32 v39, v222, v223
    v_accvgpr_write_b32 a228, v36
    v_accvgpr_write_b32 a229, v37
    v_accvgpr_write_b32 a230, v38
    v_accvgpr_write_b32 a231, v39
    s_waitcnt vmcnt(19)
    v_lshlrev_b32 v216, 16, v180
    v_and_b32 v217, 0xffff0000, v180
    v_lshlrev_b32 v218, 16, v181
    v_and_b32 v219, 0xffff0000, v181
    v_lshlrev_b32 v220, 16, v182
    v_and_b32 v221, 0xffff0000, v182
    v_lshlrev_b32 v222, 16, v183
    v_and_b32 v223, 0xffff0000, v183
    v_mul_f32 v216, s38, v216
    v_mul_f32 v217, s38, v217
    v_mul_f32 v218, s38, v218
    v_mul_f32 v219, s38, v219
    v_mul_f32 v220, s38, v220
    v_mul_f32 v221, s38, v221
    v_mul_f32 v222, s38, v222
    v_mul_f32 v223, s38, v223
    v_cvt_pk_bf16_f32 v180, v216, v217
    v_cvt_pk_bf16_f32 v181, v218, v219
    v_cvt_pk_bf16_f32 v182, v220, v221
    v_cvt_pk_bf16_f32 v183, v222, v223
    s_waitcnt vmcnt(18)
    v_lshlrev_b32 v216, 16, v40
    v_and_b32 v217, 0xffff0000, v40
    v_lshlrev_b32 v218, 16, v41
    v_and_b32 v219, 0xffff0000, v41
    v_lshlrev_b32 v220, 16, v42
    v_and_b32 v221, 0xffff0000, v42
    v_lshlrev_b32 v222, 16, v43
    v_and_b32 v223, 0xffff0000, v43
    v_mul_f32 v216, s38, v216
    v_mul_f32 v217, s38, v217
    v_mul_f32 v218, s38, v218
    v_mul_f32 v219, s38, v219
    v_mul_f32 v220, s38, v220
    v_mul_f32 v221, s38, v221
    v_mul_f32 v222, s38, v222
    v_mul_f32 v223, s38, v223
    v_cvt_pk_bf16_f32 v40, v216, v217
    v_cvt_pk_bf16_f32 v41, v218, v219
    v_cvt_pk_bf16_f32 v42, v220, v221
    v_cvt_pk_bf16_f32 v43, v222, v223
    v_accvgpr_write_b32 a232, v40
    v_accvgpr_write_b32 a233, v41
    v_accvgpr_write_b32 a234, v42
    v_accvgpr_write_b32 a235, v43
    s_waitcnt vmcnt(17)
    v_lshlrev_b32 v216, 16, v184
    v_and_b32 v217, 0xffff0000, v184
    v_lshlrev_b32 v218, 16, v185
    v_and_b32 v219, 0xffff0000, v185
    v_lshlrev_b32 v220, 16, v186
    v_and_b32 v221, 0xffff0000, v186
    v_lshlrev_b32 v222, 16, v187
    v_and_b32 v223, 0xffff0000, v187
    v_mul_f32 v216, s38, v216
    v_mul_f32 v217, s38, v217
    v_mul_f32 v218, s38, v218
    v_mul_f32 v219, s38, v219
    v_mul_f32 v220, s38, v220
    v_mul_f32 v221, s38, v221
    v_mul_f32 v222, s38, v222
    v_mul_f32 v223, s38, v223
    v_cvt_pk_bf16_f32 v184, v216, v217
    v_cvt_pk_bf16_f32 v185, v218, v219
    v_cvt_pk_bf16_f32 v186, v220, v221
    v_cvt_pk_bf16_f32 v187, v222, v223
    s_waitcnt vmcnt(16)
    v_lshlrev_b32 v216, 16, v44
    v_and_b32 v217, 0xffff0000, v44
    v_lshlrev_b32 v218, 16, v45
    v_and_b32 v219, 0xffff0000, v45
    v_lshlrev_b32 v220, 16, v46
    v_and_b32 v221, 0xffff0000, v46
    v_lshlrev_b32 v222, 16, v47
    v_and_b32 v223, 0xffff0000, v47
    v_mul_f32 v216, s38, v216
    v_mul_f32 v217, s38, v217
    v_mul_f32 v218, s38, v218
    v_mul_f32 v219, s38, v219
    v_mul_f32 v220, s38, v220
    v_mul_f32 v221, s38, v221
    v_mul_f32 v222, s38, v222
    v_mul_f32 v223, s38, v223
    v_cvt_pk_bf16_f32 v44, v216, v217
    v_cvt_pk_bf16_f32 v45, v218, v219
    v_cvt_pk_bf16_f32 v46, v220, v221
    v_cvt_pk_bf16_f32 v47, v222, v223
    v_accvgpr_write_b32 a236, v44
    v_accvgpr_write_b32 a237, v45
    v_accvgpr_write_b32 a238, v46
    v_accvgpr_write_b32 a239, v47
    s_waitcnt vmcnt(15)
    v_lshlrev_b32 v216, 16, v188
    v_and_b32 v217, 0xffff0000, v188
    v_lshlrev_b32 v218, 16, v189
    v_and_b32 v219, 0xffff0000, v189
    v_lshlrev_b32 v220, 16, v190
    v_and_b32 v221, 0xffff0000, v190
    v_lshlrev_b32 v222, 16, v191
    v_and_b32 v223, 0xffff0000, v191
    v_mul_f32 v216, s38, v216
    v_mul_f32 v217, s38, v217
    v_mul_f32 v218, s38, v218
    v_mul_f32 v219, s38, v219
    v_mul_f32 v220, s38, v220
    v_mul_f32 v221, s38, v221
    v_mul_f32 v222, s38, v222
    v_mul_f32 v223, s38, v223
    v_cvt_pk_bf16_f32 v188, v216, v217
    v_cvt_pk_bf16_f32 v189, v218, v219
    v_cvt_pk_bf16_f32 v190, v220, v221
    v_cvt_pk_bf16_f32 v191, v222, v223
    s_barrier
    ds_read_b128 v[128:131], v200 offset:0
    ds_read_b128 v[132:135], v201 offset:0
    ds_read_b128 v[136:139], v202 offset:0
    ds_read_b128 v[140:143], v203 offset:0
    s_waitcnt lgkmcnt(2)
    v_mfma_f32_32x32x16_bf16 v[0:15], v[128:131], a[192:195], 0
    ds_read_b128 v[144:147], v200 offset:128
    v_mfma_f32_32x32x16_bf16 v[16:31], v[128:131], a[240:243], 0
    v_mfma_f32_32x32x16_bf16 v[0:15], v[132:135], a[196:199], v[0:15]
    ds_read_b128 v[148:151], v201 offset:128
    v_mfma_f32_32x32x16_bf16 v[16:31], v[132:135], a[244:247], v[16:31]
    s_waitcnt lgkmcnt(2)
    v_mfma_f32_32x32x16_bf16 v[0:15], v[136:139], a[200:203], v[0:15]
    ds_read_b128 v[128:131], v202 offset:128
    v_mfma_f32_32x32x16_bf16 v[16:31], v[136:139], a[248:251], v[16:31]
    v_mfma_f32_32x32x16_bf16 v[0:15], v[140:143], a[204:207], v[0:15]
    ds_read_b128 v[132:135], v203 offset:128
    v_mfma_f32_32x32x16_bf16 v[16:31], v[140:143], a[252:255], v[16:31]
    s_waitcnt lgkmcnt(2)
    v_mfma_f32_32x32x16_bf16 v[0:15], v[144:147], a[208:211], v[0:15]
    ds_read_b128 v[136:139], v200 offset:256
    v_mfma_f32_32x32x16_bf16 v[16:31], v[144:147], v[160:163], v[16:31]
    v_mfma_f32_32x32x16_bf16 v[0:15], v[148:151], a[212:215], v[0:15]
    ds_read_b128 v[140:143], v201 offset:256
    v_mfma_f32_32x32x16_bf16 v[16:31], v[148:151], v[164:167], v[16:31]
    s_waitcnt lgkmcnt(2)
    v_mfma_f32_32x32x16_bf16 v[0:15], v[128:131], a[216:219], v[0:15]
    ds_read_b128 v[144:147], v202 offset:256
    v_mfma_f32_32x32x16_bf16 v[16:31], v[128:131], v[168:171], v[16:31]
    v_mfma_f32_32x32x16_bf16 v[0:15], v[132:135], a[220:223], v[0:15]
    ds_read_b128 v[148:151], v203 offset:256
    v_mfma_f32_32x32x16_bf16 v[16:31], v[132:135], v[172:175], v[16:31]
    s_waitcnt lgkmcnt(2)
    v_mfma_f32_32x32x16_bf16 v[0:15], v[136:139], a[224:227], v[0:15]
    v_mfma_f32_32x32x16_bf16 v[16:31], v[136:139], v[176:179], v[16:31]
    v_mfma_f32_32x32x16_bf16 v[0:15], v[140:143], a[228:231], v[0:15]
    v_mfma_f32_32x32x16_bf16 v[16:31], v[140:143], v[180:183], v[16:31]
    s_waitcnt lgkmcnt(0)
    v_mfma_f32_32x32x16_bf16 v[0:15], v[144:147], a[232:235], v[0:15]
    v_mfma_f32_32x32x16_bf16 v[16:31], v[144:147], v[184:187], v[16:31]
    v_mfma_f32_32x32x16_bf16 v[0:15], v[148:151], a[236:239], v[0:15]
    v_mfma_f32_32x32x16_bf16 v[16:31], v[148:151], v[188:191], v[16:31]
    s_waitcnt vmcnt(9)
    s_barrier
    ds_read_b128 v[128:131], v200 offset:12288
    ds_read_b128 v[132:135], v201 offset:12288
    ds_read_b128 v[136:139], v202 offset:12288
    ds_read_b128 v[140:143], v203 offset:12288
    s_add_u32 m0, s32, 73728
    s_nop 0
    buffer_load_dwordx4 v209, s[24:27], s34 offen offset:0 lds
    buffer_load_dwordx4 v210, s[24:27], s34 offen offset:1024 lds
    buffer_load_dwordx4 v211, s[24:27], s34 offen offset:2048 lds
    s_add_u32 s34, s34, 12288
    s_add_u32 m0, s32, 0
    s_nop 0
    buffer_load_dwordx4 v206, s[20:23], s33 offen offset:0 lds
    buffer_load_dwordx4 v207, s[20:23], s33 offen offset:1024 lds
    buffer_load_dwordx4 v208, s[20:23], s33 offen offset:2048 lds
    s_add_u32 s33, s33, 12288
    s_nop 7
    v_max3_f32 v216, v0, v1, v2
    v_max3_f32 v216, v216, v3, v4
    v_max3_f32 v216, v216, v5, v6
    v_max3_f32 v216, v216, v7, v8
    v_max3_f32 v216, v216, v9, v10
    v_max3_f32 v216, v216, v11, v12
    v_max3_f32 v216, v216, v13, v14
    v_max_f32 v216, v216, v15
    v_mov_b32 v217, v216
    s_nop 1
    v_permlane32_swap_b32 v216, v217
    s_nop 1
    v_max_f32 v216, v216, v217
    v_sub_f32 v96, 0, v216
    v_sub_f32 v97, 0, v216
    v_sub_f32 v98, 0, v216
    v_sub_f32 v99, 0, v216
    v_sub_f32 v100, 0, v216
    v_sub_f32 v101, 0, v216
    v_sub_f32 v102, 0, v216
    v_sub_f32 v103, 0, v216
    v_sub_f32 v104, 0, v216
    v_sub_f32 v105, 0, v216
    v_sub_f32 v106, 0, v216
    v_sub_f32 v107, 0, v216
    v_sub_f32 v108, 0, v216
    v_sub_f32 v109, 0, v216
    v_sub_f32 v110, 0, v216
    v_sub_f32 v111, 0, v216
    v_sub_f32 v0, v0, v216
    v_sub_f32 v1, v1, v216
    v_sub_f32 v2, v2, v216
    v_sub_f32 v3, v3, v216
    v_sub_f32 v4, v4, v216
    v_sub_f32 v5, v5, v216
    v_sub_f32 v6, v6, v216
    v_sub_f32 v7, v7, v216
    v_sub_f32 v8, v8, v216
    v_sub_f32 v9, v9, v216
    v_sub_f32 v10, v10, v216
    v_sub_f32 v11, v11, v216
    v_sub_f32 v12, v12, v216
    v_sub_f32 v13, v13, v216
    v_sub_f32 v14, v14, v216
    v_sub_f32 v15, v15, v216
    v_max3_f32 v216, v16, v17, v18
    v_max3_f32 v216, v216, v19, v20
    v_max3_f32 v216, v216, v21, v22
    v_max3_f32 v216, v216, v23, v24
    v_max3_f32 v216, v216, v25, v26
    v_max3_f32 v216, v216, v27, v28
    v_max3_f32 v216, v216, v29, v30
    v_max_f32 v216, v216, v31
    v_mov_b32 v217, v216
    s_nop 1
    v_permlane32_swap_b32 v216, v217
    s_nop 1
    v_max_f32 v216, v216, v217
    v_sub_f32 v112, 0, v216
    v_sub_f32 v113, 0, v216
    v_sub_f32 v114, 0, v216
    v_sub_f32 v115, 0, v216
    v_sub_f32 v116, 0, v216
    v_sub_f32 v117, 0, v216
    v_sub_f32 v118, 0, v216
    v_sub_f32 v119, 0, v216
    v_sub_f32 v120, 0, v216
    v_sub_f32 v121, 0, v216
    v_sub_f32 v122, 0, v216
    v_sub_f32 v123, 0, v216
    v_sub_f32 v124, 0, v216
    v_sub_f32 v125, 0, v216
    v_sub_f32 v126, 0, v216
    v_sub_f32 v127, 0, v216
    v_sub_f32 v16, v16, v216
    v_sub_f32 v17, v17, v216
    v_sub_f32 v18, v18, v216
    v_sub_f32 v19, v19, v216
    v_sub_f32 v20, v20, v216
    v_sub_f32 v21, v21, v216
    v_sub_f32 v22, v22, v216
    v_sub_f32 v23, v23, v216
    v_sub_f32 v24, v24, v216
    v_sub_f32 v25, v25, v216
    v_sub_f32 v26, v26, v216
    v_sub_f32 v27, v27, v216
    v_sub_f32 v28, v28, v216
    v_sub_f32 v29, v29, v216
    v_sub_f32 v30, v30, v216
    v_sub_f32 v31, v31, v216
    s_nop 1
    s_waitcnt lgkmcnt(2)
    v_mfma_f32_32x32x16_bf16 v[32:47], v[128:131], a[192:195], v[96:111]
    ds_read_b128 v[144:147], v200 offset:12416
    v_exp_f32 v192, v0
    v_exp_f32 v193, v1
    v_mfma_f32_32x32x16_bf16 v[48:63], v[128:131], a[240:243], v[112:127]
    v_exp_f32 v194, v2
    v_exp_f32 v195, v3
    v_add_f32 v214, v192, v193
    v_cvt_pk_bf16_f32 v64, v192, v193
    v_mfma_f32_32x32x16_bf16 v[32:47], v[132:135], a[196:199], v[32:47]
    ds_read_b128 v[148:151], v201 offset:12416
    v_exp_f32 v196, v4
    v_add_f32 v214, v214, v194
    v_exp_f32 v197, v5
    v_mfma_f32_32x32x16_bf16 v[48:63], v[132:135], a[244:247], v[48:63]
    v_add_f32 v214, v214, v195
    v_cvt_pk_bf16_f32 v65, v194, v195
    v_exp_f32 v192, v6
    v_add_f32 v214, v214, v196
    s_waitcnt lgkmcnt(2)
    v_mfma_f32_32x32x16_bf16 v[32:47], v[136:139], a[200:203], v[32:47]
    ds_read_b128 v[128:131], v202 offset:12416
    v_exp_f32 v193, v7
    v_add_f32 v214, v214, v197
    v_cvt_pk_bf16_f32 v66, v196, v197
    v_mfma_f32_32x32x16_bf16 v[48:63], v[136:139], a[248:251], v[48:63]
    v_exp_f32 v194, v8
    v_add_f32 v214, v214, v192
    v_exp_f32 v195, v9
    v_add_f32 v214, v214, v193
    v_mfma_f32_32x32x16_bf16 v[32:47], v[140:143], a[204:207], v[32:47]
    ds_read_b128 v[132:135], v203 offset:12416
    v_cvt_pk_bf16_f32 v67, v192, v193
    v_exp_f32 v196, v10
    v_add_f32 v214, v214, v194
    v_exp_f32 v197, v11
    v_mfma_f32_32x32x16_bf16 v[48:63], v[140:143], a[252:255], v[48:63]
    v_add_f32 v214, v214, v195
    v_cvt_pk_bf16_f32 v68, v194, v195
    v_exp_f32 v192, v12
    s_waitcnt lgkmcnt(2)
    v_mfma_f32_32x32x16_bf16 v[32:47], v[144:147], a[208:211], v[32:47]
    ds_read_b128 v[136:139], v200 offset:12544
    v_add_f32 v214, v214, v196
    v_exp_f32 v193, v13
    v_add_f32 v214, v214, v197
    v_cvt_pk_bf16_f32 v69, v196, v197
    v_mfma_f32_32x32x16_bf16 v[48:63], v[144:147], v[160:163], v[48:63]
    v_exp_f32 v194, v14
    v_add_f32 v214, v214, v192
    v_exp_f32 v195, v15
    v_mfma_f32_32x32x16_bf16 v[32:47], v[148:151], a[212:215], v[32:47]
    ds_read_b128 v[140:143], v201 offset:12544
    v_add_f32 v214, v214, v193
    v_cvt_pk_bf16_f32 v70, v192, v193
    v_exp_f32 v196, v16
    v_add_f32 v214, v214, v194
    v_mfma_f32_32x32x16_bf16 v[48:63], v[148:151], v[164:167], v[48:63]
    v_exp_f32 v197, v17
    v_add_f32 v214, v214, v195
    v_cvt_pk_bf16_f32 v71, v194, v195
    s_waitcnt lgkmcnt(2)
    v_mfma_f32_32x32x16_bf16 v[32:47], v[128:131], a[216:219], v[32:47]
    ds_read_b128 v[144:147], v202 offset:12544
    v_exp_f32 v192, v18
    v_exp_f32 v193, v19
    v_add_f32 v215, v196, v197
    v_cvt_pk_bf16_f32 v72, v196, v197
    v_mfma_f32_32x32x16_bf16 v[48:63], v[128:131], v[168:171], v[48:63]
    v_exp_f32 v194, v20
    v_add_f32 v215, v215, v192
    v_exp_f32 v195, v21
    v_mfma_f32_32x32x16_bf16 v[32:47], v[132:135], a[220:223], v[32:47]
    ds_read_b128 v[148:151], v203 offset:12544
    v_add_f32 v215, v215, v193
    v_cvt_pk_bf16_f32 v73, v192, v193
    v_exp_f32 v196, v22
    v_add_f32 v215, v215, v194
    v_mfma_f32_32x32x16_bf16 v[48:63], v[132:135], v[172:175], v[48:63]
    v_exp_f32 v197, v23
    v_add_f32 v215, v215, v195
    v_cvt_pk_bf16_f32 v74, v194, v195
    s_waitcnt lgkmcnt(2)
    v_mfma_f32_32x32x16_bf16 v[32:47], v[136:139], a[224:227], v[32:47]
    ds_read_b64_tr_b16 v[128:129], v204 offset:0
    v_exp_f32 v192, v24
    v_add_f32 v215, v215, v196
    v_exp_f32 v193, v25
    v_add_f32 v215, v215, v197
    v_mfma_f32_32x32x16_bf16 v[48:63], v[136:139], v[176:179], v[48:63]
    ds_read_b64_tr_b16 v[130:131], v204 offset:3072
    v_cvt_pk_bf16_f32 v75, v196, v197
    v_exp_f32 v194, v26
    v_add_f32 v215, v215, v192
    v_mfma_f32_32x32x16_bf16 v[32:47], v[140:143], a[228:231], v[32:47]
    ds_read_b64_tr_b16 v[132:133], v205 offset:0
    v_exp_f32 v195, v27
    v_add_f32 v215, v215, v193
    v_cvt_pk_bf16_f32 v76, v192, v193
    v_exp_f32 v196, v28
    v_mfma_f32_32x32x16_bf16 v[48:63], v[140:143], v[180:183], v[48:63]
    ds_read_b64_tr_b16 v[134:135], v205 offset:3072
    v_add_f32 v215, v215, v194
    v_exp_f32 v197, v29
    s_waitcnt lgkmcnt(4)
    v_mfma_f32_32x32x16_bf16 v[32:47], v[144:147], a[232:235], v[32:47]
    ds_read_b64_tr_b16 v[136:137], v204 offset:128
    v_add_f32 v215, v215, v195
    v_cvt_pk_bf16_f32 v77, v194, v195
    v_exp_f32 v192, v30
    v_add_f32 v215, v215, v196
    v_mfma_f32_32x32x16_bf16 v[48:63], v[144:147], v[184:187], v[48:63]
    ds_read_b64_tr_b16 v[138:139], v204 offset:3200
    v_exp_f32 v193, v31
    v_add_f32 v215, v215, v197
    v_cvt_pk_bf16_f32 v78, v196, v197
    v_mfma_f32_32x32x16_bf16 v[32:47], v[148:151], a[236:239], v[32:47]
    ds_read_b64_tr_b16 v[140:141], v205 offset:128
    v_add_f32 v215, v215, v192
    v_add_f32 v215, v215, v193
    v_cvt_pk_bf16_f32 v79, v192, v193
    v_max_f32 v216, v214, v215
    v_cmp_nge_f32 vcc, s36, v216
    v_mfma_f32_32x32x16_bf16 v[48:63], v[148:151], v[188:191], v[48:63]
    ds_read_b64_tr_b16 v[142:143], v205 offset:3200
    s_cbranch_vccnz F_slowP
F_retP:
    s_waitcnt lgkmcnt(4)
    s_mov_b32 s35, 0
.p2align 6
F_loop:
    v_mfma_f32_32x32x16_bf16 a[0:15], v[128:131], v[64:67], a[0:15]
    v_add_f32 v212, v212, v214
    v_add_f32 v213, v213, v215
    ds_read_b64_tr_b16 v[144:145], v204 offset:256
    v_mfma_f32_32x32x16_bf16 a[96:111], v[128:131], v[72:75], a[96:111]
    ds_read_b64_tr_b16 v[146:147], v204 offset:3328
    v_mfma_f32_32x32x16_bf16 a[16:31], v[132:135], v[64:67], a[16:31]
    ds_read_b64_tr_b16 v[148:149], v205 offset:256
    v_mfma_f32_32x32x16_bf16 a[112:127], v[132:135], v[72:75], a[112:127]
    ds_read_b64_tr_b16 v[150:151], v205 offset:3328
    v_exp_f32 v192, v32
    s_waitcnt lgkmcnt(4)
    v_mfma_f32_32x32x16_bf16 a[32:47], v[136:139], v[64:67], a[32:47]
    ds_read_b64_tr_b16 v[128:129], v204 offset:6144
    v_exp_f32 v193, v33
    v_mfma_f32_32x32x16_bf16 a[128:143], v[136:139], v[72:75], a[128:143]
    ds_read_b64_tr_b16 v[130:131], v204 offset:9216
    v_exp_f32 v194, v34
    v_exp_f32 v195, v35
    v_mfma_f32_32x32x16_bf16 a[48:63], v[140:143], v[64:67], a[48:63]
    ds_read_b64_tr_b16 v[132:133], v205 offset:6144
    v_add_f32 v214, v192, v193
    v_cvt_pk_bf16_f32 v80, v192, v193
    v_mfma_f32_32x32x16_bf16 a[144:159], v[140:143], v[72:75], a[144:159]
    ds_read_b64_tr_b16 v[134:135], v205 offset:9216
    v_exp_f32 v196, v36
    v_add_f32 v214, v214, v194
    s_waitcnt lgkmcnt(4)
    v_mfma_f32_32x32x16_bf16 a[64:79], v[144:147], v[64:67], a[64:79]
    ds_read_b64_tr_b16 v[136:137], v204 offset:6272
    v_exp_f32 v197, v37
    v_add_f32 v214, v214, v195
    v_mfma_f32_32x32x16_bf16 a[160:175], v[144:147], v[72:75], a[160:175]
    ds_read_b64_tr_b16 v[138:139], v204 offset:9344
    v_cvt_pk_bf16_f32 v81, v194, v195
    v_exp_f32 v192, v38
    v_mfma_f32_32x32x16_bf16 a[80:95], v[148:151], v[64:67], a[80:95]
    ds_read_b64_tr_b16 v[140:141], v205 offset:6272
    v_add_f32 v214, v214, v196
    v_exp_f32 v193, v39
    v_mfma_f32_32x32x16_bf16 a[176:191], v[148:151], v[72:75], a[176:191]
    ds_read_b64_tr_b16 v[142:143], v205 offset:9344
    v_add_f32 v214, v214, v197
    s_waitcnt lgkmcnt(4)
    v_mfma_f32_32x32x16_bf16 a[0:15], v[128:131], v[68:71], a[0:15]
    ds_read_b64_tr_b16 v[144:145], v204 offset:6400
    v_cvt_pk_bf16_f32 v82, v196, v197
    v_exp_f32 v194, v40
    v_mfma_f32_32x32x16_bf16 a[96:111], v[128:131], v[76:79], a[96:111]
    ds_read_b64_tr_b16 v[146:147], v204 offset:9472
    v_add_f32 v214, v214, v192
    v_exp_f32 v195, v41
    v_mfma_f32_32x32x16_bf16 a[16:31], v[132:135], v[68:71], a[16:31]
    ds_read_b64_tr_b16 v[148:149], v205 offset:6400
    v_add_f32 v214, v214, v193
    v_cvt_pk_bf16_f32 v83, v192, v193
    v_exp_f32 v196, v42
    v_mfma_f32_32x32x16_bf16 a[112:127], v[132:135], v[76:79], a[112:127]
    ds_read_b64_tr_b16 v[150:151], v205 offset:9472
    s_waitcnt vmcnt(9)
    s_barrier
    s_waitcnt lgkmcnt(4)
    v_mfma_f32_32x32x16_bf16 a[32:47], v[136:139], v[68:71], a[32:47]
    s_add_u32 m0, s32, 86016
    ds_read_b128 v[128:131], v200 offset:24576
    v_add_f32 v214, v214, v194
    v_mfma_f32_32x32x16_bf16 a[128:143], v[136:139], v[76:79], a[128:143]
    buffer_load_dwordx4 v209, s[24:27], s34 offen offset:0 lds
    v_exp_f32 v197, v43
    v_mfma_f32_32x32x16_bf16 a[48:63], v[140:143], v[68:71], a[48:63]
    ds_read_b128 v[132:135], v201 offset:24576
    v_add_f32 v214, v214, v195
    v_cvt_pk_bf16_f32 v84, v194, v195
    v_mfma_f32_32x32x16_bf16 a[144:159], v[140:143], v[76:79], a[144:159]
    buffer_load_dwordx4 v210, s[24:27], s34 offen offset:1024 lds
    v_exp_f32 v192, v44
    s_waitcnt lgkmcnt(2)
    v_mfma_f32_32x32x16_bf16 a[64:79], v[144:147], v[68:71], a[64:79]
    ds_read_b128 v[136:139], v202 offset:24576
    v_add_f32 v214, v214, v196
    v_exp_f32 v193, v45
    v_mfma_f32_32x32x16_bf16 a[160:175], v[144:147], v[76:79], a[160:175]
    buffer_load_dwordx4 v211, s[24:27], s34 offen offset:2048 lds
    v_add_f32 v214, v214, v197
    v_cvt_pk_bf16_f32 v85, v196, v197
    v_mfma_f32_32x32x16_bf16 a[80:95], v[148:151], v[68:71], a[80:95]
    s_add_u32 s34, s34, 12288
    s_add_u32 m0, s32, 12288
    ds_read_b128 v[140:143], v203 offset:24576
    v_mfma_f32_32x32x16_bf16 a[176:191], v[148:151], v[76:79], a[176:191]
    buffer_load_dwordx4 v206, s[20:23], s33 offen offset:0 lds
    v_exp_f32 v194, v46
    s_waitcnt lgkmcnt(2)
    v_mfma_f32_32x32x16_bf16 v[0:15], v[128:131], a[192:195], v[96:111]
    ds_read_b128 v[144:147], v200 offset:24704
    v_add_f32 v214, v214, v192
    v_exp_f32 v195, v47
    v_mfma_f32_32x32x16_bf16 v[16:31], v[128:131], a[240:243], v[112:127]
    buffer_load_dwordx4 v207, s[20:23], s33 offen offset:1024 lds
    v_add_f32 v214, v214, v193
    v_mfma_f32_32x32x16_bf16 v[0:15], v[132:135], a[196:199], v[0:15]
    ds_read_b128 v[148:151], v201 offset:24704
    v_cvt_pk_bf16_f32 v86, v192, v193
    v_exp_f32 v196, v48
    v_mfma_f32_32x32x16_bf16 v[16:31], v[132:135], a[244:247], v[16:31]
    buffer_load_dwordx4 v208, s[20:23], s33 offen offset:2048 lds
    v_add_f32 v214, v214, v194
    s_waitcnt lgkmcnt(2)
    v_mfma_f32_32x32x16_bf16 v[0:15], v[136:139], a[200:203], v[0:15]
    s_add_u32 s33, s33, 12288
    ds_read_b128 v[128:131], v202 offset:24704
    v_exp_f32 v197, v49
    v_mfma_f32_32x32x16_bf16 v[16:31], v[136:139], a[248:251], v[16:31]
    v_add_f32 v214, v214, v195
    v_cvt_pk_bf16_f32 v87, v194, v195
    v_exp_f32 v192, v50
    v_mfma_f32_32x32x16_bf16 v[0:15], v[140:143], a[204:207], v[0:15]
    ds_read_b128 v[132:135], v203 offset:24704
    v_exp_f32 v193, v51
    v_add_f32 v215, v196, v197
    v_mfma_f32_32x32x16_bf16 v[16:31], v[140:143], a[252:255], v[16:31]
    v_cvt_pk_bf16_f32 v88, v196, v197
    v_exp_f32 v194, v52
    s_waitcnt lgkmcnt(2)
    v_mfma_f32_32x32x16_bf16 v[0:15], v[144:147], a[208:211], v[0:15]
    ds_read_b128 v[136:139], v200 offset:24832
    v_add_f32 v215, v215, v192
    v_exp_f32 v195, v53
    v_mfma_f32_32x32x16_bf16 v[16:31], v[144:147], v[160:163], v[16:31]
    v_add_f32 v215, v215, v193
    v_cvt_pk_bf16_f32 v89, v192, v193
    v_exp_f32 v196, v54
    v_mfma_f32_32x32x16_bf16 v[0:15], v[148:151], a[212:215], v[0:15]
    ds_read_b128 v[140:143], v201 offset:24832
    v_add_f32 v215, v215, v194
    v_exp_f32 v197, v55
    v_mfma_f32_32x32x16_bf16 v[16:31], v[148:151], v[164:167], v[16:31]
    v_add_f32 v215, v215, v195
    v_cvt_pk_bf16_f32 v90, v194, v195
    s_waitcnt lgkmcnt(2)
    v_mfma_f32_32x32x16_bf16 v[0:15], v[128:131], a[216:219], v[0:15]
    ds_read_b128 v[144:147], v202 offset:24832
    v_exp_f32 v192, v56
    v_add_f32 v215, v215, v196
    v_mfma_f32_32x32x16_bf16 v[16:31], v[128:131], v[168:171], v[16:31]
    v_exp_f32 v193, v57
    v_add_f32 v215, v215, v197
    v_cvt_pk_bf16_f32 v91, v196, v197
    v_mfma_f32_32x32x16_bf16 v[0:15], v[132:135], a[220:223], v[0:15]
    ds_read_b128 v[148:151], v203 offset:24832
    v_exp_f32 v194, v58
    v_add_f32 v215, v215, v192
    v_mfma_f32_32x32x16_bf16 v[16:31], v[132:135], v[172:175], v[16:31]
    v_exp_f32 v195, v59
    v_add_f32 v215, v215, v193
    s_waitcnt lgkmcnt(2)
    v_mfma_f32_32x32x16_bf16 v[0:15], v[136:139], a[224:227], v[0:15]
    ds_read_b64_tr_b16 v[128:129], v204 offset:12288
    v_cvt_pk_bf16_f32 v92, v192, v193
    v_exp_f32 v196, v60
    v_mfma_f32_32x32x16_bf16 v[16:31], v[136:139], v[176:179], v[16:31]
    ds_read_b64_tr_b16 v[130:131], v204 offset:15360
    v_add_f32 v215, v215, v194
    v_exp_f32 v197, v61
    v_mfma_f32_32x32x16_bf16 v[0:15], v[140:143], a[228:231], v[0:15]
    ds_read_b64_tr_b16 v[132:133], v205 offset:12288
    v_add_f32 v215, v215, v195
    v_cvt_pk_bf16_f32 v93, v194, v195
    v_exp_f32 v192, v62
    v_mfma_f32_32x32x16_bf16 v[16:31], v[140:143], v[180:183], v[16:31]
    ds_read_b64_tr_b16 v[134:135], v205 offset:15360
    v_add_f32 v215, v215, v196
    s_waitcnt lgkmcnt(4)
    v_mfma_f32_32x32x16_bf16 v[0:15], v[144:147], a[232:235], v[0:15]
    ds_read_b64_tr_b16 v[136:137], v204 offset:12416
    v_exp_f32 v193, v63
    v_add_f32 v215, v215, v197
    v_mfma_f32_32x32x16_bf16 v[16:31], v[144:147], v[184:187], v[16:31]
    ds_read_b64_tr_b16 v[138:139], v204 offset:15488
    v_cvt_pk_bf16_f32 v94, v196, v197
    v_add_f32 v215, v215, v192
    v_add_f32 v215, v215, v193
    v_mfma_f32_32x32x16_bf16 v[0:15], v[148:151], a[236:239], v[0:15]
    ds_read_b64_tr_b16 v[140:141], v205 offset:12416
    v_cvt_pk_bf16_f32 v95, v192, v193
    v_max_f32 v216, v214, v215
    v_cmp_nge_f32 vcc, s36, v216
    v_mfma_f32_32x32x16_bf16 v[16:31], v[148:151], v[188:191], v[16:31]
    ds_read_b64_tr_b16 v[142:143], v205 offset:15488
    s_cbranch_vccnz F_slowL1
F_retL1:
    s_waitcnt lgkmcnt(4)
    v_mfma_f32_32x32x16_bf16 a[0:15], v[128:131], v[80:83], a[0:15]
    v_add_f32 v212, v212, v214
    v_add_f32 v213, v213, v215
    ds_read_b64_tr_b16 v[144:145], v204 offset:12544
    v_mfma_f32_32x32x16_bf16 a[96:111], v[128:131], v[88:91], a[96:111]
    ds_read_b64_tr_b16 v[146:147], v204 offset:15616
    v_mfma_f32_32x32x16_bf16 a[16:31], v[132:135], v[80:83], a[16:31]
    ds_read_b64_tr_b16 v[148:149], v205 offset:12544
    v_mfma_f32_32x32x16_bf16 a[112:127], v[132:135], v[88:91], a[112:127]
    ds_read_b64_tr_b16 v[150:151], v205 offset:15616
    v_exp_f32 v192, v0
    s_waitcnt lgkmcnt(4)
    v_mfma_f32_32x32x16_bf16 a[32:47], v[136:139], v[80:83], a[32:47]
    ds_read_b64_tr_b16 v[128:129], v204 offset:18432
    v_exp_f32 v193, v1
    v_mfma_f32_32x32x16_bf16 a[128:143], v[136:139], v[88:91], a[128:143]
    ds_read_b64_tr_b16 v[130:131], v204 offset:21504
    v_exp_f32 v194, v2
    v_exp_f32 v195, v3
    v_mfma_f32_32x32x16_bf16 a[48:63], v[140:143], v[80:83], a[48:63]
    ds_read_b64_tr_b16 v[132:133], v205 offset:18432
    v_add_f32 v214, v192, v193
    v_cvt_pk_bf16_f32 v64, v192, v193
    v_mfma_f32_32x32x16_bf16 a[144:159], v[140:143], v[88:91], a[144:159]
    ds_read_b64_tr_b16 v[134:135], v205 offset:21504
    v_exp_f32 v196, v4
    v_add_f32 v214, v214, v194
    s_waitcnt lgkmcnt(4)
    v_mfma_f32_32x32x16_bf16 a[64:79], v[144:147], v[80:83], a[64:79]
    ds_read_b64_tr_b16 v[136:137], v204 offset:18560
    v_exp_f32 v197, v5
    v_add_f32 v214, v214, v195
    v_mfma_f32_32x32x16_bf16 a[160:175], v[144:147], v[88:91], a[160:175]
    ds_read_b64_tr_b16 v[138:139], v204 offset:21632
    v_cvt_pk_bf16_f32 v65, v194, v195
    v_exp_f32 v192, v6
    v_mfma_f32_32x32x16_bf16 a[80:95], v[148:151], v[80:83], a[80:95]
    ds_read_b64_tr_b16 v[140:141], v205 offset:18560
    v_add_f32 v214, v214, v196
    v_exp_f32 v193, v7
    v_mfma_f32_32x32x16_bf16 a[176:191], v[148:151], v[88:91], a[176:191]
    ds_read_b64_tr_b16 v[142:143], v205 offset:21632
    v_add_f32 v214, v214, v197
    v_cvt_pk_bf16_f32 v66, v196, v197
    s_waitcnt lgkmcnt(4)
    v_mfma_f32_32x32x16_bf16 a[0:15], v[128:131], v[84:87], a[0:15]
    ds_read_b64_tr_b16 v[144:145], v204 offset:18688
    v_exp_f32 v194, v8
    v_add_f32 v214, v214, v192
    v_mfma_f32_32x32x16_bf16 a[96:111], v[128:131], v[92:95], a[96:111]
    ds_read_b64_tr_b16 v[146:147], v204 offset:21760
    v_exp_f32 v195, v9
    v_add_f32 v214, v214, v193
    v_mfma_f32_32x32x16_bf16 a[16:31], v[132:135], v[84:87], a[16:31]
    ds_read_b64_tr_b16 v[148:149], v205 offset:18688
    v_cvt_pk_bf16_f32 v67, v192, v193
    v_exp_f32 v196, v10
    v_mfma_f32_32x32x16_bf16 a[112:127], v[132:135], v[92:95], a[112:127]
    ds_read_b64_tr_b16 v[150:151], v205 offset:21760
    s_waitcnt vmcnt(9)
    s_barrier
    s_waitcnt lgkmcnt(4)
    v_mfma_f32_32x32x16_bf16 a[32:47], v[136:139], v[84:87], a[32:47]
    s_add_u32 m0, s32, 49152
    ds_read_b128 v[128:131], v200 offset:36864
    v_add_f32 v214, v214, v194
    v_mfma_f32_32x32x16_bf16 a[128:143], v[136:139], v[92:95], a[128:143]
    buffer_load_dwordx4 v209, s[24:27], s34 offen offset:0 lds
    v_exp_f32 v197, v11
    v_add_f32 v214, v214, v195
    v_mfma_f32_32x32x16_bf16 a[48:63], v[140:143], v[84:87], a[48:63]
    ds_read_b128 v[132:135], v201 offset:36864
    v_cvt_pk_bf16_f32 v68, v194, v195
    v_exp_f32 v192, v12
    v_mfma_f32_32x32x16_bf16 a[144:159], v[140:143], v[92:95], a[144:159]
    buffer_load_dwordx4 v210, s[24:27], s34 offen offset:1024 lds
    v_add_f32 v214, v214, v196
    s_waitcnt lgkmcnt(2)
    v_mfma_f32_32x32x16_bf16 a[64:79], v[144:147], v[84:87], a[64:79]
    ds_read_b128 v[136:139], v202 offset:36864
    v_exp_f32 v193, v13
    v_add_f32 v214, v214, v197
    v_mfma_f32_32x32x16_bf16 a[160:175], v[144:147], v[92:95], a[160:175]
    buffer_load_dwordx4 v211, s[24:27], s34 offen offset:2048 lds
    v_cvt_pk_bf16_f32 v69, v196, v197
    v_mfma_f32_32x32x16_bf16 a[80:95], v[148:151], v[84:87], a[80:95]
    s_add_u32 s34, s34, 12288
    s_add_u32 m0, s32, 24576
    ds_read_b128 v[140:143], v203 offset:36864
    v_exp_f32 v194, v14
    v_mfma_f32_32x32x16_bf16 a[176:191], v[148:151], v[92:95], a[176:191]
    buffer_load_dwordx4 v206, s[20:23], s33 offen offset:0 lds
    v_add_f32 v214, v214, v192
    s_waitcnt lgkmcnt(2)
    v_mfma_f32_32x32x16_bf16 v[32:47], v[128:131], a[192:195], v[96:111]
    ds_read_b128 v[144:147], v200 offset:36992
    v_exp_f32 v195, v15
    v_add_f32 v214, v214, v193
    v_mfma_f32_32x32x16_bf16 v[48:63], v[128:131], a[240:243], v[112:127]
    buffer_load_dwordx4 v207, s[20:23], s33 offen offset:1024 lds
    v_cvt_pk_bf16_f32 v70, v192, v193
    v_mfma_f32_32x32x16_bf16 v[32:47], v[132:135], a[196:199], v[32:47]
    ds_read_b128 v[148:151], v201 offset:36992
    v_exp_f32 v196, v16
    v_add_f32 v214, v214, v194
    v_mfma_f32_32x32x16_bf16 v[48:63], v[132:135], a[244:247], v[48:63]
    buffer_load_dwordx4 v208, s[20:23], s33 offen offset:2048 lds
    v_exp_f32 v197, v17
    s_waitcnt lgkmcnt(2)
    v_mfma_f32_32x32x16_bf16 v[32:47], v[136:139], a[200:203], v[32:47]
    s_add_u32 s33, s33, 12288
    ds_read_b128 v[128:131], v202 offset:36992
    v_add_f32 v214, v214, v195
    v_mfma_f32_32x32x16_bf16 v[48:63], v[136:139], a[248:251], v[48:63]
    v_cvt_pk_bf16_f32 v71, v194, v195
    v_exp_f32 v192, v18
    v_exp_f32 v193, v19
    v_mfma_f32_32x32x16_bf16 v[32:47], v[140:143], a[204:207], v[32:47]
    ds_read_b128 v[132:135], v203 offset:36992
    v_add_f32 v215, v196, v197
    v_cvt_pk_bf16_f32 v72, v196, v197
    v_mfma_f32_32x32x16_bf16 v[48:63], v[140:143], a[252:255], v[48:63]
    v_exp_f32 v194, v20
    v_add_f32 v215, v215, v192
    s_waitcnt lgkmcnt(2)
    v_mfma_f32_32x32x16_bf16 v[32:47], v[144:147], a[208:211], v[32:47]
    ds_read_b128 v[136:139], v200 offset:37120
    v_exp_f32 v195, v21
    v_add_f32 v215, v215, v193
    v_mfma_f32_32x32x16_bf16 v[48:63], v[144:147], v[160:163], v[48:63]
    v_cvt_pk_bf16_f32 v73, v192, v193
    v_exp_f32 v196, v22
    v_add_f32 v215, v215, v194
    v_mfma_f32_32x32x16_bf16 v[32:47], v[148:151], a[212:215], v[32:47]
    ds_read_b128 v[140:143], v201 offset:37120
    v_exp_f32 v197, v23
    v_add_f32 v215, v215, v195
    v_mfma_f32_32x32x16_bf16 v[48:63], v[148:151], v[164:167], v[48:63]
    v_cvt_pk_bf16_f32 v74, v194, v195
    v_exp_f32 v192, v24
    s_waitcnt lgkmcnt(2)
    v_mfma_f32_32x32x16_bf16 v[32:47], v[128:131], a[216:219], v[32:47]
    ds_read_b128 v[144:147], v202 offset:37120
    v_add_f32 v215, v215, v196
    v_exp_f32 v193, v25
    v_mfma_f32_32x32x16_bf16 v[48:63], v[128:131], v[168:171], v[48:63]
    v_add_f32 v215, v215, v197
    v_cvt_pk_bf16_f32 v75, v196, v197
    v_exp_f32 v194, v26
    v_mfma_f32_32x32x16_bf16 v[32:47], v[132:135], a[220:223], v[32:47]
    ds_read_b128 v[148:151], v203 offset:37120
    v_add_f32 v215, v215, v192
    v_exp_f32 v195, v27
    v_mfma_f32_32x32x16_bf16 v[48:63], v[132:135], v[172:175], v[48:63]
    v_add_f32 v215, v215, v193
    v_cvt_pk_bf16_f32 v76, v192, v193
    v_exp_f32 v196, v28
    s_waitcnt lgkmcnt(2)
    v_mfma_f32_32x32x16_bf16 v[32:47], v[136:139], a[224:227], v[32:47]
    s_add_u32 s35, s35, 1
    ds_read_b64_tr_b16 v[128:129], v204 offset:24576
    v_add_f32 v215, v215, v194
    v_mfma_f32_32x32x16_bf16 v[48:63], v[136:139], v[176:179], v[48:63]
    ds_read_b64_tr_b16 v[130:131], v204 offset:27648
    v_exp_f32 v197, v29
    v_add_f32 v215, v215, v195
    v_mfma_f32_32x32x16_bf16 v[32:47], v[140:143], a[228:231], v[32:47]
    s_cmp_eq_u32 s35, 16
    ds_read_b64_tr_b16 v[132:133], v205 offset:24576
    v_cvt_pk_bf16_f32 v77, v194, v195
    v_exp_f32 v192, v30
    v_mfma_f32_32x32x16_bf16 v[48:63], v[140:143], v[180:183], v[48:63]
    ds_read_b64_tr_b16 v[134:135], v205 offset:27648
    v_add_f32 v215, v215, v196
    s_waitcnt lgkmcnt(4)
    v_mfma_f32_32x32x16_bf16 v[32:47], v[144:147], a[232:235], v[32:47]
    ds_read_b64_tr_b16 v[136:137], v204 offset:24704
    v_exp_f32 v193, v31
    v_add_f32 v215, v215, v197
    v_mfma_f32_32x32x16_bf16 v[48:63], v[144:147], v[184:187], v[48:63]
    ds_read_b64_tr_b16 v[138:139], v204 offset:27776
    v_cvt_pk_bf16_f32 v78, v196, v197
    v_add_f32 v215, v215, v192
    v_add_f32 v215, v215, v193
    v_mfma_f32_32x32x16_bf16 v[32:47], v[148:151], a[236:239], v[32:47]
    ds_read_b64_tr_b16 v[140:141], v205 offset:24704
    v_cvt_pk_bf16_f32 v79, v192, v193
    v_max_f32 v216, v214, v215
    v_cmp_nge_f32 vcc, s36, v216
    v_mfma_f32_32x32x16_bf16 v[48:63], v[148:151], v[188:191], v[48:63]
    ds_read_b64_tr_b16 v[142:143], v205 offset:27776
    s_cbranch_vccnz F_slowL2
F_retL2:
    s_waitcnt lgkmcnt(4)
    s_cbranch_scc1 F_tail
    v_mfma_f32_32x32x16_bf16 a[0:15], v[128:131], v[64:67], a[0:15]
    v_add_f32 v212, v212, v214
    v_add_f32 v213, v213, v215
    ds_read_b64_tr_b16 v[144:145], v204 offset:24832
    v_mfma_f32_32x32x16_bf16 a[96:111], v[128:131], v[72:75], a[96:111]
    ds_read_b64_tr_b16 v[146:147], v204 offset:27904
    v_mfma_f32_32x32x16_bf16 a[16:31], v[132:135], v[64:67], a[16:31]
    ds_read_b64_tr_b16 v[148:149], v205 offset:24832
    v_mfma_f32_32x32x16_bf16 a[112:127], v[132:135], v[72:75], a[112:127]
    ds_read_b64_tr_b16 v[150:151], v205 offset:27904
    v_exp_f32 v192, v32
    s_waitcnt lgkmcnt(4)
    v_mfma_f32_32x32x16_bf16 a[32:47], v[136:139], v[64:67], a[32:47]
    ds_read_b64_tr_b16 v[128:129], v204 offset:30720
    v_exp_f32 v193, v33
    v_mfma_f32_32x32x16_bf16 a[128:143], v[136:139], v[72:75], a[128:143]
    ds_read_b64_tr_b16 v[130:131], v204 offset:33792
    v_exp_f32 v194, v34
    v_exp_f32 v195, v35
    v_mfma_f32_32x32x16_bf16 a[48:63], v[140:143], v[64:67], a[48:63]
    ds_read_b64_tr_b16 v[132:133], v205 offset:30720
    v_add_f32 v214, v192, v193
    v_cvt_pk_bf16_f32 v80, v192, v193
    v_mfma_f32_32x32x16_bf16 a[144:159], v[140:143], v[72:75], a[144:159]
    ds_read_b64_tr_b16 v[134:135], v205 offset:33792
    v_exp_f32 v196, v36
    v_add_f32 v214, v214, v194
    s_waitcnt lgkmcnt(4)
    v_mfma_f32_32x32x16_bf16 a[64:79], v[144:147], v[64:67], a[64:79]
    ds_read_b64_tr_b16 v[136:137], v204 offset:30848
    v_exp_f32 v197, v37
    v_add_f32 v214, v214, v195
    v_mfma_f32_32x32x16_bf16 a[160:175], v[144:147], v[72:75], a[160:175]
    ds_read_b64_tr_b16 v[138:139], v204 offset:33920
    v_cvt_pk_bf16_f32 v81, v194, v195
    v_exp_f32 v192, v38
    v_mfma_f32_32x32x16_bf16 a[80:95], v[148:151], v[64:67], a[80:95]
    ds_read_b64_tr_b16 v[140:141], v205 offset:30848
    v_add_f32 v214, v214, v196
    v_exp_f32 v193, v39
    v_mfma_f32_32x32x16_bf16 a[176:191], v[148:151], v[72:75], a[176:191]
    ds_read_b64_tr_b16 v[142:143], v205 offset:33920
    v_add_f32 v214, v214, v197
    s_waitcnt lgkmcnt(4)
    v_mfma_f32_32x32x16_bf16 a[0:15], v[128:131], v[68:71], a[0:15]
    ds_read_b64_tr_b16 v[144:145], v204 offset:30976
    v_cvt_pk_bf16_f32 v82, v196, v197
    v_exp_f32 v194, v40
    v_mfma_f32_32x32x16_bf16 a[96:111], v[128:131], v[76:79], a[96:111]
    ds_read_b64_tr_b16 v[146:147], v204 offset:34048
    v_add_f32 v214, v214, v192
    v_exp_f32 v195, v41
    v_mfma_f32_32x32x16_bf16 a[16:31], v[132:135], v[68:71], a[16:31]
    ds_read_b64_tr_b16 v[148:149], v205 offset:30976
    v_add_f32 v214, v214, v193
    v_cvt_pk_bf16_f32 v83, v192, v193
    v_exp_f32 v196, v42
    v_mfma_f32_32x32x16_bf16 a[112:127], v[132:135], v[76:79], a[112:127]
    ds_read_b64_tr_b16 v[150:151], v205 offset:34048
    s_waitcnt vmcnt(9)
    s_barrier
    s_waitcnt lgkmcnt(4)
    v_mfma_f32_32x32x16_bf16 a[32:47], v[136:139], v[68:71], a[32:47]
    s_add_u32 m0, s32, 61440
    ds_read_b128 v[128:131], v200 offset:0
    v_add_f32 v214, v214, v194
    v_mfma_f32_32x32x16_bf16 a[128:143], v[136:139], v[76:79], a[128:143]
    buffer_load_dwordx4 v209, s[24:27], s34 offen offset:0 lds
    v_exp_f32 v197, v43
    v_mfma_f32_32x32x16_bf16 a[48:63], v[140:143], v[68:71], a[48:63]
    ds_read_b128 v[132:135], v201 offset:0
    v_add_f32 v214, v214, v195
    v_cvt_pk_bf16_f32 v84, v194, v195
    v_mfma_f32_32x32x16_bf16 a[144:159], v[140:143], v[76:79], a[144:159]
    buffer_load_dwordx4 v210, s[24:27], s34 offen offset:1024 lds
    v_exp_f32 v192, v44
    s_waitcnt lgkmcnt(2)
    v_mfma_f32_32x32x16_bf16 a[64:79], v[144:147], v[68:71], a[64:79]
    ds_read_b128 v[136:139], v202 offset:0
    v_add_f32 v214, v214, v196
    v_exp_f32 v193, v45
    v_mfma_f32_32x32x16_bf16 a[160:175], v[144:147], v[76:79], a[160:175]
    buffer_load_dwordx4 v211, s[24:27], s34 offen offset:2048 lds
    v_add_f32 v214, v214, v197
    v_cvt_pk_bf16_f32 v85, v196, v197
    v_mfma_f32_32x32x16_bf16 a[80:95], v[148:151], v[68:71], a[80:95]
    s_add_u32 s34, s34, 12288
    s_add_u32 m0, s32, 36864
    ds_read_b128 v[140:143], v203 offset:0
    v_mfma_f32_32x32x16_bf16 a[176:191], v[148:151], v[76:79], a[176:191]
    buffer_load_dwordx4 v206, s[20:23], s33 offen offset:0 lds
    v_exp_f32 v194, v46
    s_waitcnt lgkmcnt(2)
    v_mfma_f32_32x32x16_bf16 v[0:15], v[128:131], a[192:195], v[96:111]
    ds_read_b128 v[144:147], v200 offset:128
    v_add_f32 v214, v214, v192
    v_exp_f32 v195, v47
    v_mfma_f32_32x32x16_bf16 v[16:31], v[128:131], a[240:243], v[112:127]
    buffer_load_dwordx4 v207, s[20:23], s33 offen offset:1024 lds
    v_add_f32 v214, v214, v193
    v_mfma_f32_32x32x16_bf16 v[0:15], v[132:135], a[196:199], v[0:15]
    ds_read_b128 v[148:151], v201 offset:128
    v_cvt_pk_bf16_f32 v86, v192, v193
    v_exp_f32 v196, v48
    v_mfma_f32_32x32x16_bf16 v[16:31], v[132:135], a[244:247], v[16:31]
    buffer_load_dwordx4 v208, s[20:23], s33 offen offset:2048 lds
    v_add_f32 v214, v214, v194
    s_waitcnt lgkmcnt(2)
    v_mfma_f32_32x32x16_bf16 v[0:15], v[136:139], a[200:203], v[0:15]
    s_add_u32 s33, s33, 12288
    ds_read_b128 v[128:131], v202 offset:128
    v_exp_f32 v197, v49
    v_mfma_f32_32x32x16_bf16 v[16:31], v[136:139], a[248:251], v[16:31]
    v_add_f32 v214, v214, v195
    v_cvt_pk_bf16_f32 v87, v194, v195
    v_exp_f32 v192, v50
    v_mfma_f32_32x32x16_bf16 v[0:15], v[140:143], a[204:207], v[0:15]
    ds_read_b128 v[132:135], v203 offset:128
    v_exp_f32 v193, v51
    v_add_f32 v215, v196, v197
    v_mfma_f32_32x32x16_bf16 v[16:31], v[140:143], a[252:255], v[16:31]
    v_cvt_pk_bf16_f32 v88, v196, v197
    v_exp_f32 v194, v52
    s_waitcnt lgkmcnt(2)
    v_mfma_f32_32x32x16_bf16 v[0:15], v[144:147], a[208:211], v[0:15]
    ds_read_b128 v[136:139], v200 offset:256
    v_add_f32 v215, v215, v192
    v_exp_f32 v195, v53
    v_mfma_f32_32x32x16_bf16 v[16:31], v[144:147], v[160:163], v[16:31]
    v_add_f32 v215, v215, v193
    v_cvt_pk_bf16_f32 v89, v192, v193
    v_exp_f32 v196, v54
    v_mfma_f32_32x32x16_bf16 v[0:15], v[148:151], a[212:215], v[0:15]
    ds_read_b128 v[140:143], v201 offset:256
    v_add_f32 v215, v215, v194
    v_exp_f32 v197, v55
    v_mfma_f32_32x32x16_bf16 v[16:31], v[148:151], v[164:167], v[16:31]
    v_add_f32 v215, v215, v195
    v_cvt_pk_bf16_f32 v90, v194, v195
    s_waitcnt lgkmcnt(2)
    v_mfma_f32_32x32x16_bf16 v[0:15], v[128:131], a[216:219], v[0:15]
    ds_read_b128 v[144:147], v202 offset:256
    v_exp_f32 v192, v56
    v_add_f32 v215, v215, v196
    v_mfma_f32_32x32x16_bf16 v[16:31], v[128:131], v[168:171], v[16:31]
    v_exp_f32 v193, v57
    v_add_f32 v215, v215, v197
    v_cvt_pk_bf16_f32 v91, v196, v197
    v_mfma_f32_32x32x16_bf16 v[0:15], v[132:135], a[220:223], v[0:15]
    ds_read_b128 v[148:151], v203 offset:256
    v_exp_f32 v194, v58
    v_add_f32 v215, v215, v192
    v_mfma_f32_32x32x16_bf16 v[16:31], v[132:135], v[172:175], v[16:31]
    v_exp_f32 v195, v59
    v_add_f32 v215, v215, v193
    s_waitcnt lgkmcnt(2)
    v_mfma_f32_32x32x16_bf16 v[0:15], v[136:139], a[224:227], v[0:15]
    ds_read_b64_tr_b16 v[128:129], v204 offset:36864
    v_cvt_pk_bf16_f32 v92, v192, v193
    v_exp_f32 v196, v60
    v_mfma_f32_32x32x16_bf16 v[16:31], v[136:139], v[176:179], v[16:31]
    ds_read_b64_tr_b16 v[130:131], v204 offset:39936
    v_add_f32 v215, v215, v194
    v_exp_f32 v197, v61
    v_mfma_f32_32x32x16_bf16 v[0:15], v[140:143], a[228:231], v[0:15]
    ds_read_b64_tr_b16 v[132:133], v205 offset:36864
    v_add_f32 v215, v215, v195
    v_cvt_pk_bf16_f32 v93, v194, v195
    v_exp_f32 v192, v62
    v_mfma_f32_32x32x16_bf16 v[16:31], v[140:143], v[180:183], v[16:31]
    ds_read_b64_tr_b16 v[134:135], v205 offset:39936
    v_add_f32 v215, v215, v196
    s_waitcnt lgkmcnt(4)
    v_mfma_f32_32x32x16_bf16 v[0:15], v[144:147], a[232:235], v[0:15]
    ds_read_b64_tr_b16 v[136:137], v204 offset:36992
    v_exp_f32 v193, v63
    v_add_f32 v215, v215, v197
    v_mfma_f32_32x32x16_bf16 v[16:31], v[144:147], v[184:187], v[16:31]
    ds_read_b64_tr_b16 v[138:139], v204 offset:40064
    v_cvt_pk_bf16_f32 v94, v196, v197
    v_add_f32 v215, v215, v192
    v_add_f32 v215, v215, v193
    v_mfma_f32_32x32x16_bf16 v[0:15], v[148:151], a[236:239], v[0:15]
    ds_read_b64_tr_b16 v[140:141], v205 offset:36992
    v_cvt_pk_bf16_f32 v95, v192, v193
    v_max_f32 v216, v214, v215
    v_cmp_nge_f32 vcc, s36, v216
    v_mfma_f32_32x32x16_bf16 v[16:31], v[148:151], v[188:191], v[16:31]
    ds_read_b64_tr_b16 v[142:143], v205 offset:40064
    s_cbranch_vccnz F_slowL3
F_retL3:
    s_waitcnt lgkmcnt(4)
    v_mfma_f32_32x32x16_bf16 a[0:15], v[128:131], v[80:83], a[0:15]
    v_add_f32 v212, v212, v214
    v_add_f32 v213, v213, v215
    ds_read_b64_tr_b16 v[144:145], v204 offset:37120
    v_mfma_f32_32x32x16_bf16 a[96:111], v[128:131], v[88:91], a[96:111]
    ds_read_b64_tr_b16 v[146:147], v204 offset:40192
    v_mfma_f32_32x32x16_bf16 a[16:31], v[132:135], v[80:83], a[16:31]
    ds_read_b64_tr_b16 v[148:149], v205 offset:37120
    v_mfma_f32_32x32x16_bf16 a[112:127], v[132:135], v[88:91], a[112:127]
    ds_read_b64_tr_b16 v[150:151], v205 offset:40192
    v_exp_f32 v192, v0
    s_waitcnt lgkmcnt(4)
    v_mfma_f32_32x32x16_bf16 a[32:47], v[136:139], v[80:83], a[32:47]
    ds_read_b64_tr_b16 v[128:129], v204 offset:43008
    v_exp_f32 v193, v1
    v_mfma_f32_32x32x16_bf16 a[128:143], v[136:139], v[88:91], a[128:143]
    ds_read_b64_tr_b16 v[130:131], v204 offset:46080
    v_exp_f32 v194, v2
    v_exp_f32 v195, v3
    v_mfma_f32_32x32x16_bf16 a[48:63], v[140:143], v[80:83], a[48:63]
    ds_read_b64_tr_b16 v[132:133], v205 offset:43008
    v_add_f32 v214, v192, v193
    v_cvt_pk_bf16_f32 v64, v192, v193
    v_mfma_f32_32x32x16_bf16 a[144:159], v[140:143], v[88:91], a[144:159]
    ds_read_b64_tr_b16 v[134:135], v205 offset:46080
    v_exp_f32 v196, v4
    v_add_f32 v214, v214, v194
    s_waitcnt lgkmcnt(4)
    v_mfma_f32_32x32x16_bf16 a[64:79], v[144:147], v[80:83], a[64:79]
    ds_read_b64_tr_b16 v[136:137], v204 offset:43136
    v_exp_f32 v197, v5
    v_add_f32 v214, v214, v195
    v_mfma_f32_32x32x16_bf16 a[160:175], v[144:147], v[88:91], a[160:175]
    ds_read_b64_tr_b16 v[138:139], v204 offset:46208
    v_cvt_pk_bf16_f32 v65, v194, v195
    v_exp_f32 v192, v6
    v_mfma_f32_32x32x16_bf16 a[80:95], v[148:151], v[80:83], a[80:95]
    ds_read_b64_tr_b16 v[140:141], v205 offset:43136
    v_add_f32 v214, v214, v196
    v_exp_f32 v193, v7
    v_mfma_f32_32x32x16_bf16 a[176:191], v[148:151], v[88:91], a[176:191]
    ds_read_b64_tr_b16 v[142:143], v205 offset:46208
    v_add_f32 v214, v214, v197
    s_waitcnt lgkmcnt(4)
    v_mfma_f32_32x32x16_bf16 a[0:15], v[128:131], v[84:87], a[0:15]
    ds_read_b64_tr_b16 v[144:145], v204 offset:43264
    v_cvt_pk_bf16_f32 v66, v196, v197
    v_exp_f32 v194, v8
    v_mfma_f32_32x32x16_bf16 a[96:111], v[128:131], v[92:95], a[96:111]
    ds_read_b64_tr_b16 v[146:147], v204 offset:46336
    v_add_f32 v214, v214, v192
    v_exp_f32 v195, v9
    v_mfma_f32_32x32x16_bf16 a[16:31], v[132:135], v[84:87], a[16:31]
    ds_read_b64_tr_b16 v[148:149], v205 offset:43264
    v_add_f32 v214, v214, v193
    v_cvt_pk_bf16_f32 v67, v192, v193
    v_exp_f32 v196, v10
    v_mfma_f32_32x32x16_bf16 a[112:127], v[132:135], v[92:95], a[112:127]
    ds_read_b64_tr_b16 v[150:151], v205 offset:46336
    s_waitcnt vmcnt(9)
    s_barrier
    s_waitcnt lgkmcnt(4)
    v_mfma_f32_32x32x16_bf16 a[32:47], v[136:139], v[84:87], a[32:47]
    s_add_u32 m0, s32, 73728
    ds_read_b128 v[128:131], v200 offset:12288
    v_add_f32 v214, v214, v194
    v_mfma_f32_32x32x16_bf16 a[128:143], v[136:139], v[92:95], a[128:143]
    buffer_load_dwordx4 v209, s[24:27], s34 offen offset:0 lds
    v_exp_f32 v197, v11
    v_mfma_f32_32x32x16_bf16 a[48:63], v[140:143], v[84:87], a[48:63]
    ds_read_b128 v[132:135], v201 offset:12288
    v_add_f32 v214, v214, v195
    v_cvt_pk_bf16_f32 v68, v194, v195
    v_mfma_f32_32x32x16_bf16 a[144:159], v[140:143], v[92:95], a[144:159]
    buffer_load_dwordx4 v210, s[24:27], s34 offen offset:1024 lds
    v_exp_f32 v192, v12
    s_waitcnt lgkmcnt(2)
    v_mfma_f32_32x32x16_bf16 a[64:79], v[144:147], v[84:87], a[64:79]
    ds_read_b128 v[136:139], v202 offset:12288
    v_add_f32 v214, v214, v196
    v_exp_f32 v193, v13
    v_mfma_f32_32x32x16_bf16 a[160:175], v[144:147], v[92:95], a[160:175]
    buffer_load_dwordx4 v211, s[24:27], s34 offen offset:2048 lds
    v_add_f32 v214, v214, v197
    v_cvt_pk_bf16_f32 v69, v196, v197
    v_mfma_f32_32x32x16_bf16 a[80:95], v[148:151], v[84:87], a[80:95]
    s_add_u32 s34, s34, 12288
    s_add_u32 m0, s32, 0
    ds_read_b128 v[140:143], v203 offset:12288
    v_mfma_f32_32x32x16_bf16 a[176:191], v[148:151], v[92:95], a[176:191]
    buffer_load_dwordx4 v206, s[20:23], s33 offen offset:0 lds
    v_exp_f32 v194, v14
    s_waitcnt lgkmcnt(2)
    v_mfma_f32_32x32x16_bf16 v[32:47], v[128:131], a[192:195], v[96:111]
    ds_read_b128 v[144:147], v200 offset:12416
    v_add_f32 v214, v214, v192
    v_exp_f32 v195, v15
    v_mfma_f32_32x32x16_bf16 v[48:63], v[128:131], a[240:243], v[112:127]
    buffer_load_dwordx4 v207, s[20:23], s33 offen offset:1024 lds
    v_add_f32 v214, v214, v193
    v_mfma_f32_32x32x16_bf16 v[32:47], v[132:135], a[196:199], v[32:47]
    ds_read_b128 v[148:151], v201 offset:12416
    v_cvt_pk_bf16_f32 v70, v192, v193
    v_exp_f32 v196, v16
    v_mfma_f32_32x32x16_bf16 v[48:63], v[132:135], a[244:247], v[48:63]
    buffer_load_dwordx4 v208, s[20:23], s33 offen offset:2048 lds
    v_add_f32 v214, v214, v194
    s_waitcnt lgkmcnt(2)
    v_mfma_f32_32x32x16_bf16 v[32:47], v[136:139], a[200:203], v[32:47]
    s_add_u32 s33, s33, 12288
    ds_read_b128 v[128:131], v202 offset:12416
    v_exp_f32 v197, v17
    v_mfma_f32_32x32x16_bf16 v[48:63], v[136:139], a[248:251], v[48:63]
    v_add_f32 v214, v214, v195
    v_cvt_pk_bf16_f32 v71, v194, v195
    v_exp_f32 v192, v18
    v_mfma_f32_32x32x16_bf16 v[32:47], v[140:143], a[204:207], v[32:47]
    ds_read_b128 v[132:135], v203 offset:12416
    v_exp_f32 v193, v19
    v_add_f32 v215, v196, v197
    v_mfma_f32_32x32x16_bf16 v[48:63], v[140:143], a[252:255], v[48:63]
    v_cvt_pk_bf16_f32 v72, v196, v197
    v_exp_f32 v194, v20
    s_waitcnt lgkmcnt(2)
    v_mfma_f32_32x32x16_bf16 v[32:47], v[144:147], a[208:211], v[32:47]
    ds_read_b128 v[136:139], v200 offset:12544
    v_add_f32 v215, v215, v192
    v_exp_f32 v195, v21
    v_mfma_f32_32x32x16_bf16 v[48:63], v[144:147], v[160:163], v[48:63]
    v_add_f32 v215, v215, v193
    v_cvt_pk_bf16_f32 v73, v192, v193
    v_exp_f32 v196, v22
    v_mfma_f32_32x32x16_bf16 v[32:47], v[148:151], a[212:215], v[32:47]
    ds_read_b128 v[140:143], v201 offset:12544
    v_add_f32 v215, v215, v194
    v_exp_f32 v197, v23
    v_mfma_f32_32x32x16_bf16 v[48:63], v[148:151], v[164:167], v[48:63]
    v_add_f32 v215, v215, v195
    v_cvt_pk_bf16_f32 v74, v194, v195
    s_waitcnt lgkmcnt(2)
    v_mfma_f32_32x32x16_bf16 v[32:47], v[128:131], a[216:219], v[32:47]
    ds_read_b128 v[144:147], v202 offset:12544
    v_exp_f32 v192, v24
    v_add_f32 v215, v215, v196
    v_mfma_f32_32x32x16_bf16 v[48:63], v[128:131], v[168:171], v[48:63]
    v_exp_f32 v193, v25
    v_add_f32 v215, v215, v197
    v_cvt_pk_bf16_f32 v75, v196, v197
    v_mfma_f32_32x32x16_bf16 v[32:47], v[132:135], a[220:223], v[32:47]
    ds_read_b128 v[148:151], v203 offset:12544
    v_exp_f32 v194, v26
    v_add_f32 v215, v215, v192
    v_mfma_f32_32x32x16_bf16 v[48:63], v[132:135], v[172:175], v[48:63]
    v_exp_f32 v195, v27
    v_add_f32 v215, v215, v193
    s_waitcnt lgkmcnt(2)
    v_mfma_f32_32x32x16_bf16 v[32:47], v[136:139], a[224:227], v[32:47]
    ds_read_b64_tr_b16 v[128:129], v204 offset:0
    v_cvt_pk_bf16_f32 v76, v192, v193
    v_exp_f32 v196, v28
    v_mfma_f32_32x32x16_bf16 v[48:63], v[136:139], v[176:179], v[48:63]
    ds_read_b64_tr_b16 v[130:131], v204 offset:3072
    v_add_f32 v215, v215, v194
    v_exp_f32 v197, v29
    v_mfma_f32_32x32x16_bf16 v[32:47], v[140:143], a[228:231], v[32:47]
    ds_read_b64_tr_b16 v[132:133], v205 offset:0
    v_add_f32 v215, v215, v195
    v_cvt_pk_bf16_f32 v77, v194, v195
    v_exp_f32 v192, v30
    v_mfma_f32_32x32x16_bf16 v[48:63], v[140:143], v[180:183], v[48:63]
    ds_read_b64_tr_b16 v[134:135], v205 offset:3072
    v_add_f32 v215, v215, v196
    s_waitcnt lgkmcnt(4)
    v_mfma_f32_32x32x16_bf16 v[32:47], v[144:147], a[232:235], v[32:47]
    ds_read_b64_tr_b16 v[136:137], v204 offset:128
    v_exp_f32 v193, v31
    v_add_f32 v215, v215, v197
    v_mfma_f32_32x32x16_bf16 v[48:63], v[144:147], v[184:187], v[48:63]
    ds_read_b64_tr_b16 v[138:139], v204 offset:3200
    v_cvt_pk_bf16_f32 v78, v196, v197
    v_add_f32 v215, v215, v192
    v_add_f32 v215, v215, v193
    v_mfma_f32_32x32x16_bf16 v[32:47], v[148:151], a[236:239], v[32:47]
    ds_read_b64_tr_b16 v[140:141], v205 offset:128
    v_cvt_pk_bf16_f32 v79, v192, v193
    v_max_f32 v216, v214, v215
    v_cmp_nge_f32 vcc, s36, v216
    v_mfma_f32_32x32x16_bf16 v[48:63], v[148:151], v[188:191], v[48:63]
    ds_read_b64_tr_b16 v[142:143], v205 offset:3200
    s_cbranch_vccnz F_slowL4
F_retL4:
    s_waitcnt lgkmcnt(4)
    s_branch F_loop
F_tail:
    v_mfma_f32_32x32x16_bf16 a[0:15], v[128:131], v[64:67], a[0:15]
    v_add_f32 v212, v212, v214
    v_add_f32 v213, v213, v215
    ds_read_b64_tr_b16 v[144:145], v204 offset:24832
    v_mfma_f32_32x32x16_bf16 a[96:111], v[128:131], v[72:75], a[96:111]
    ds_read_b64_tr_b16 v[146:147], v204 offset:27904
    v_mfma_f32_32x32x16_bf16 a[16:31], v[132:135], v[64:67], a[16:31]
    ds_read_b64_tr_b16 v[148:149], v205 offset:24832
    v_mfma_f32_32x32x16_bf16 a[112:127], v[132:135], v[72:75], a[112:127]
    ds_read_b64_tr_b16 v[150:151], v205 offset:27904
    v_exp_f32 v192, v32
    v_exp_f32 v193, v33
    s_waitcnt lgkmcnt(4)
    v_mfma_f32_32x32x16_bf16 a[32:47], v[136:139], v[64:67], a[32:47]
    ds_read_b64_tr_b16 v[128:129], v204 offset:30720
    v_exp_f32 v194, v34
    v_exp_f32 v195, v35
    v_add_f32 v214, v192, v193
    v_cvt_pk_bf16_f32 v80, v192, v193
    v_mfma_f32_32x32x16_bf16 a[128:143], v[136:139], v[72:75], a[128:143]
    ds_read_b64_tr_b16 v[130:131], v204 offset:33792
    v_exp_f32 v196, v36
    v_add_f32 v214, v214, v194
    v_exp_f32 v197, v37
    v_add_f32 v214, v214, v195
    v_cvt_pk_bf16_f32 v81, v194, v195
    v_mfma_f32_32x32x16_bf16 a[48:63], v[140:143], v[64:67], a[48:63]
    ds_read_b64_tr_b16 v[132:133], v205 offset:30720
    v_exp_f32 v192, v38
    v_add_f32 v214, v214, v196
    v_exp_f32 v193, v39
    v_add_f32 v214, v214, v197
    v_mfma_f32_32x32x16_bf16 a[144:159], v[140:143], v[72:75], a[144:159]
    ds_read_b64_tr_b16 v[134:135], v205 offset:33792
    v_cvt_pk_bf16_f32 v82, v196, v197
    v_exp_f32 v194, v40
    v_add_f32 v214, v214, v192
    s_waitcnt lgkmcnt(4)
    v_mfma_f32_32x32x16_bf16 a[64:79], v[144:147], v[64:67], a[64:79]
    ds_read_b64_tr_b16 v[136:137], v204 offset:30848
    v_exp_f32 v195, v41
    v_add_f32 v214, v214, v193
    v_cvt_pk_bf16_f32 v83, v192, v193
    v_exp_f32 v196, v42
    v_add_f32 v214, v214, v194
    v_mfma_f32_32x32x16_bf16 a[160:175], v[144:147], v[72:75], a[160:175]
    ds_read_b64_tr_b16 v[138:139], v204 offset:33920
    v_exp_f32 v197, v43
    v_add_f32 v214, v214, v195
    v_cvt_pk_bf16_f32 v84, v194, v195
    v_exp_f32 v192, v44
    v_mfma_f32_32x32x16_bf16 a[80:95], v[148:151], v[64:67], a[80:95]
    ds_read_b64_tr_b16 v[140:141], v205 offset:30848
    v_add_f32 v214, v214, v196
    v_exp_f32 v193, v45
    v_add_f32 v214, v214, v197
    v_cvt_pk_bf16_f32 v85, v196, v197
    v_mfma_f32_32x32x16_bf16 a[176:191], v[148:151], v[72:75], a[176:191]
    ds_read_b64_tr_b16 v[142:143], v205 offset:33920
    v_exp_f32 v194, v46
    v_add_f32 v214, v214, v192
    v_exp_f32 v195, v47
    v_add_f32 v214, v214, v193
    s_waitcnt lgkmcnt(4)
    v_mfma_f32_32x32x16_bf16 a[0:15], v[128:131], v[68:71], a[0:15]
    ds_read_b64_tr_b16 v[144:145], v204 offset:30976
    v_cvt_pk_bf16_f32 v86, v192, v193
    v_exp_f32 v196, v48
    v_add_f32 v214, v214, v194
    v_exp_f32 v197, v49
    v_mfma_f32_32x32x16_bf16 a[96:111], v[128:131], v[76:79], a[96:111]
    ds_read_b64_tr_b16 v[146:147], v204 offset:34048
    v_add_f32 v214, v214, v195
    v_cvt_pk_bf16_f32 v87, v194, v195
    v_exp_f32 v192, v50
    v_exp_f32 v193, v51
    v_mfma_f32_32x32x16_bf16 a[16:31], v[132:135], v[68:71], a[16:31]
    ds_read_b64_tr_b16 v[148:149], v205 offset:30976
    v_add_f32 v215, v196, v197
    v_cvt_pk_bf16_f32 v88, v196, v197
    v_exp_f32 v194, v52
    v_add_f32 v215, v215, v192
    v_mfma_f32_32x32x16_bf16 a[112:127], v[132:135], v[76:79], a[112:127]
    ds_read_b64_tr_b16 v[150:151], v205 offset:34048
    v_exp_f32 v195, v53
    v_add_f32 v215, v215, v193
    s_waitcnt vmcnt(9)
    s_barrier
    s_waitcnt lgkmcnt(4)
    v_mfma_f32_32x32x16_bf16 a[32:47], v[136:139], v[68:71], a[32:47]
    ds_read_b64_tr_b16 v[128:129], v204 offset:36864
    v_cvt_pk_bf16_f32 v89, v192, v193
    v_exp_f32 v196, v54
    v_add_f32 v215, v215, v194
    v_exp_f32 v197, v55
    v_mfma_f32_32x32x16_bf16 a[128:143], v[136:139], v[76:79], a[128:143]
    ds_read_b64_tr_b16 v[130:131], v204 offset:39936
    v_add_f32 v215, v215, v195
    v_cvt_pk_bf16_f32 v90, v194, v195
    v_exp_f32 v192, v56
    v_add_f32 v215, v215, v196
    v_exp_f32 v193, v57
    v_mfma_f32_32x32x16_bf16 a[48:63], v[140:143], v[68:71], a[48:63]
    ds_read_b64_tr_b16 v[132:133], v205 offset:36864
    v_add_f32 v215, v215, v197
    v_cvt_pk_bf16_f32 v91, v196, v197
    v_exp_f32 v194, v58
    v_add_f32 v215, v215, v192
    v_mfma_f32_32x32x16_bf16 a[144:159], v[140:143], v[76:79], a[144:159]
    ds_read_b64_tr_b16 v[134:135], v205 offset:39936
    v_exp_f32 v195, v59
    v_add_f32 v215, v215, v193
    v_cvt_pk_bf16_f32 v92, v192, v193
    v_exp_f32 v196, v60
    s_waitcnt lgkmcnt(4)
    v_mfma_f32_32x32x16_bf16 a[64:79], v[144:147], v[68:71], a[64:79]
    ds_read_b64_tr_b16 v[136:137], v204 offset:36992
    v_add_f32 v215, v215, v194
    v_exp_f32 v197, v61
    v_add_f32 v215, v215, v195
    v_cvt_pk_bf16_f32 v93, v194, v195
    v_mfma_f32_32x32x16_bf16 a[160:175], v[144:147], v[76:79], a[160:175]
    ds_read_b64_tr_b16 v[138:139], v204 offset:40064
    v_exp_f32 v192, v62
    v_add_f32 v215, v215, v196
    v_exp_f32 v193, v63
    v_add_f32 v215, v215, v197
    v_mfma_f32_32x32x16_bf16 a[80:95], v[148:151], v[68:71], a[80:95]
    ds_read_b64_tr_b16 v[140:141], v205 offset:36992
    v_cvt_pk_bf16_f32 v94, v196, v197
    v_add_f32 v215, v215, v192
    v_add_f32 v215, v215, v193
    v_cvt_pk_bf16_f32 v95, v192, v193
    v_max_f32 v216, v214, v215
    v_cmp_nge_f32 vcc, s36, v216
    v_mfma_f32_32x32x16_bf16 a[176:191], v[148:151], v[76:79], a[176:191]
    ds_read_b64_tr_b16 v[142:143], v205 offset:40064
    s_cbranch_vccnz F_slowT
F_retT:
    s_waitcnt lgkmcnt(4)
    v_mfma_f32_32x32x16_bf16 a[0:15], v[128:131], v[80:83], a[0:15]
    v_add_f32 v212, v212, v214
    v_add_f32 v213, v213, v215
    ds_read_b64_tr_b16 v[144:145], v204 offset:37120
    v_mfma_f32_32x32x16_bf16 a[96:111], v[128:131], v[88:91], a[96:111]
    ds_read_b64_tr_b16 v[146:147], v204 offset:40192
    v_mfma_f32_32x32x16_bf16 a[16:31], v[132:135], v[80:83], a[16:31]
    v_mov_b32 v216, v212
    ds_read_b64_tr_b16 v[148:149], v205 offset:37120
    v_mfma_f32_32x32x16_bf16 a[112:127], v[132:135], v[88:91], a[112:127]
    ds_read_b64_tr_b16 v[150:151], v205 offset:40192
    s_waitcnt lgkmcnt(4)
    v_mfma_f32_32x32x16_bf16 a[32:47], v[136:139], v[80:83], a[32:47]
    v_permlane32_swap_b32 v216, v212
    ds_read_b64_tr_b16 v[128:129], v204 offset:43008
    v_mfma_f32_32x32x16_bf16 a[128:143], v[136:139], v[88:91], a[128:143]
    ds_read_b64_tr_b16 v[130:131], v204 offset:46080
    v_mfma_f32_32x32x16_bf16 a[48:63], v[140:143], v[80:83], a[48:63]
    v_mov_b32 v217, v213
    ds_read_b64_tr_b16 v[132:133], v205 offset:43008
    v_mfma_f32_32x32x16_bf16 a[144:159], v[140:143], v[88:91], a[144:159]
    ds_read_b64_tr_b16 v[134:135], v205 offset:46080
    s_waitcnt lgkmcnt(4)
    v_mfma_f32_32x32x16_bf16 a[64:79], v[144:147], v[80:83], a[64:79]
    v_permlane32_swap_b32 v217, v213
    ds_read_b64_tr_b16 v[136:137], v204 offset:43136
    v_mfma_f32_32x32x16_bf16 a[160:175], v[144:147], v[88:91], a[160:175]
    ds_read_b64_tr_b16 v[138:139], v204 offset:46208
    v_mfma_f32_32x32x16_bf16 a[80:95], v[148:151], v[80:83], a[80:95]
    v_add_f32 v212, v212, v216
    ds_read_b64_tr_b16 v[140:141], v205 offset:43136
    v_mfma_f32_32x32x16_bf16 a[176:191], v[148:151], v[88:91], a[176:191]
    v_rcp_f32 v218, v212
    ds_read_b64_tr_b16 v[142:143], v205 offset:46208
    s_waitcnt lgkmcnt(4)
    v_mfma_f32_32x32x16_bf16 a[0:15], v[128:131], v[84:87], a[0:15]
    v_mov_b32 v219, v218
    ds_read_b64_tr_b16 v[144:145], v204 offset:43264
    v_mfma_f32_32x32x16_bf16 a[96:111], v[128:131], v[92:95], a[96:111]
    ds_read_b64_tr_b16 v[146:147], v204 offset:46336
    v_mfma_f32_32x32x16_bf16 a[16:31], v[132:135], v[84:87], a[16:31]
    v_add_f32 v213, v213, v217
    ds_read_b64_tr_b16 v[148:149], v205 offset:43264
    v_mfma_f32_32x32x16_bf16 a[112:127], v[132:135], v[92:95], a[112:127]
    v_rcp_f32 v220, v213
    ds_read_b64_tr_b16 v[150:151], v205 offset:46336
    s_waitcnt lgkmcnt(4)
    v_mfma_f32_32x32x16_bf16 a[32:47], v[136:139], v[84:87], a[32:47]
    v_mov_b32 v221, v220
    v_mfma_f32_32x32x16_bf16 a[128:143], v[136:139], v[92:95], a[128:143]
    v_mfma_f32_32x32x16_bf16 a[48:63], v[140:143], v[84:87], a[48:63]
    v_mfma_f32_32x32x16_bf16 a[144:159], v[140:143], v[92:95], a[144:159]
    s_waitcnt lgkmcnt(0)
    v_mfma_f32_32x32x16_bf16 a[64:79], v[144:147], v[84:87], a[64:79]
    v_mfma_f32_32x32x16_bf16 a[160:175], v[144:147], v[92:95], a[160:175]
    v_mfma_f32_32x32x16_bf16 a[80:95], v[148:151], v[84:87], a[80:95]
    v_mfma_f32_32x32x16_bf16 a[176:191], v[148:151], v[92:95], a[176:191]
    s_nop 15
    v_accvgpr_read_b32 v0, a0
    v_accvgpr_read_b32 v1, a1
    v_accvgpr_read_b32 v2, a2
    v_accvgpr_read_b32 v3, a3
    v_accvgpr_read_b32 v4, a4
    v_accvgpr_read_b32 v5, a5
    v_accvgpr_read_b32 v6, a6
    v_accvgpr_read_b32 v7, a7
    v_accvgpr_read_b32 v8, a8
    v_accvgpr_read_b32 v9, a9
    v_accvgpr_read_b32 v10, a10
    v_accvgpr_read_b32 v11, a11
    v_accvgpr_read_b32 v12, a12
    v_accvgpr_read_b32 v13, a13
    v_accvgpr_read_b32 v14, a14
    v_accvgpr_read_b32 v15, a15
    v_mul_f32 v0, v218, v0
    v_mul_f32 v1, v218, v1
    v_mul_f32 v2, v218, v2
    v_mul_f32 v3, v218, v3
    v_mul_f32 v4, v218, v4
    v_mul_f32 v5, v218, v5
    v_mul_f32 v6, v218, v6
    v_mul_f32 v7, v218, v7
    v_mul_f32 v8, v218, v8
    v_mul_f32 v9, v218, v9
    v_mul_f32 v10, v218, v10
    v_mul_f32 v11, v218, v11
    v_mul_f32 v12, v218, v12
    v_mul_f32 v13, v218, v13
    v_mul_f32 v14, v218, v14
    v_mul_f32 v15, v218, v15
    v_cvt_pk_bf16_f32 v16, v0, v1
    v_cvt_pk_bf16_f32 v17, v2, v3
    v_cvt_pk_bf16_f32 v18, v4, v5
    v_cvt_pk_bf16_f32 v19, v6, v7
    v_cvt_pk_bf16_f32 v20, v8, v9
    v_cvt_pk_bf16_f32 v21, v10, v11
    v_cvt_pk_bf16_f32 v22, v12, v13
    v_cvt_pk_bf16_f32 v23, v14, v15
    s_nop 1
    v_permlane32_swap_b32 v16, v18
    v_permlane32_swap_b32 v17, v19
    v_permlane32_swap_b32 v20, v22
    v_permlane32_swap_b32 v21, v23
    buffer_store_dwordx4 v[16:19], v241, s[28:31], 0 offen offset:0
    buffer_store_dwordx4 v[20:23], v241, s[28:31], 0 offen offset:32
    v_accvgpr_read_b32 v32, a16
    v_accvgpr_read_b32 v33, a17
    v_accvgpr_read_b32 v34, a18
    v_accvgpr_read_b32 v35, a19
    v_accvgpr_read_b32 v36, a20
    v_accvgpr_read_b32 v37, a21
    v_accvgpr_read_b32 v38, a22
    v_accvgpr_read_b32 v39, a23
    v_accvgpr_read_b32 v40, a24
    v_accvgpr_read_b32 v41, a25
    v_accvgpr_read_b32 v42, a26
    v_accvgpr_read_b32 v43, a27
    v_accvgpr_read_b32 v44, a28
    v_accvgpr_read_b32 v45, a29
    v_accvgpr_read_b32 v46, a30
    v_accvgpr_read_b32 v47, a31
    v_mul_f32 v32, v218, v32
    v_mul_f32 v33, v218, v33
    v_mul_f32 v34, v218, v34
    v_mul_f32 v35, v218, v35
    v_mul_f32 v36, v218, v36
    v_mul_f32 v37, v218, v37
    v_mul_f32 v38, v218, v38
    v_mul_f32 v39, v218, v39
    v_mul_f32 v40, v218, v40
    v_mul_f32 v41, v218, v41
    v_mul_f32 v42, v218, v42
    v_mul_f32 v43, v218, v43
    v_mul_f32 v44, v218, v44
    v_mul_f32 v45, v218, v45
    v_mul_f32 v46, v218, v46
    v_mul_f32 v47, v218, v47
    v_cvt_pk_bf16_f32 v48, v32, v33
    v_cvt_pk_bf16_f32 v49, v34, v35
    v_cvt_pk_bf16_f32 v50, v36, v37
    v_cvt_pk_bf16_f32 v51, v38, v39
    v_cvt_pk_bf16_f32 v52, v40, v41
    v_cvt_pk_bf16_f32 v53, v42, v43
    v_cvt_pk_bf16_f32 v54, v44, v45
    v_cvt_pk_bf16_f32 v55, v46, v47
    s_nop 1
    v_permlane32_swap_b32 v48, v50
    v_permlane32_swap_b32 v49, v51
    v_permlane32_swap_b32 v52, v54
    v_permlane32_swap_b32 v53, v55
    buffer_store_dwordx4 v[48:51], v241, s[28:31], 0 offen offset:64
    buffer_store_dwordx4 v[52:55], v241, s[28:31], 0 offen offset:96
    v_accvgpr_read_b32 v0, a32
    v_accvgpr_read_b32 v1, a33
    v_accvgpr_read_b32 v2, a34
    v_accvgpr_read_b32 v3, a35
    v_accvgpr_read_b32 v4, a36
    v_accvgpr_read_b32 v5, a37
    v_accvgpr_read_b32 v6, a38
    v_accvgpr_read_b32 v7, a39
    v_accvgpr_read_b32 v8, a40
    v_accvgpr_read_b32 v9, a41
    v_accvgpr_read_b32 v10, a42
    v_accvgpr_read_b32 v11, a43
    v_accvgpr_read_b32 v12, a44
    v_accvgpr_read_b32 v13, a45
    v_accvgpr_read_b32 v14, a46
    v_accvgpr_read_b32 v15, a47
    v_mul_f32 v0, v218, v0
    v_mul_f32 v1, v218, v1
    v_mul_f32 v2, v218, v2
    v_mul_f32 v3, v218, v3
    v_mul_f32 v4, v218, v4
    v_mul_f32 v5, v218, v5
    v_mul_f32 v6, v218, v6
    v_mul_f32 v7, v218, v7
    v_mul_f32 v8, v218, v8
    v_mul_f32 v9, v218, v9
    v_mul_f32 v10, v218, v10
    v_mul_f32 v11, v218, v11
    v_mul_f32 v12, v218, v12
    v_mul_f32 v13, v218, v13
    v_mul_f32 v14, v218, v14
    v_mul_f32 v15, v218, v15
    v_cvt_pk_bf16_f32 v16, v0, v1
    v_cvt_pk_bf16_f32 v17, v2, v3
    v_cvt_pk_bf16_f32 v18, v4, v5
    v_cvt_pk_bf16_f32 v19, v6, v7
    v_cvt_pk_bf16_f32 v20, v8, v9
    v_cvt_pk_bf16_f32 v21, v10, v11
    v_cvt_pk_bf16_f32 v22, v12, v13
    v_cvt_pk_bf16_f32 v23, v14, v15
    s_nop 1
    v_permlane32_swap_b32 v16, v18
    v_permlane32_swap_b32 v17, v19
    v_permlane32_swap_b32 v20, v22
    v_permlane32_swap_b32 v21, v23
    buffer_store_dwordx4 v[16:19], v241, s[28:31], 0 offen offset:128
    buffer_store_dwordx4 v[20:23], v241, s[28:31], 0 offen offset:160
    v_accvgpr_read_b32 v32, a48
    v_accvgpr_read_b32 v33, a49
    v_accvgpr_read_b32 v34, a50
    v_accvgpr_read_b32 v35, a51
    v_accvgpr_read_b32 v36, a52
    v_accvgpr_read_b32 v37, a53
    v_accvgpr_read_b32 v38, a54
    v_accvgpr_read_b32 v39, a55
    v_accvgpr_read_b32 v40, a56
    v_accvgpr_read_b32 v41, a57
    v_accvgpr_read_b32 v42, a58
    v_accvgpr_read_b32 v43, a59
    v_accvgpr_read_b32 v44, a60
    v_accvgpr_read_b32 v45, a61
    v_accvgpr_read_b32 v46, a62
    v_accvgpr_read_b32 v47, a63
    v_mul_f32 v32, v218, v32
    v_mul_f32 v33, v218, v33
    v_mul_f32 v34, v218, v34
    v_mul_f32 v35, v218, v35
    v_mul_f32 v36, v218, v36
    v_mul_f32 v37, v218, v37
    v_mul_f32 v38, v218, v38
    v_mul_f32 v39, v218, v39
    v_mul_f32 v40, v218, v40
    v_mul_f32 v41, v218, v41
    v_mul_f32 v42, v218, v42
    v_mul_f32 v43, v218, v43
    v_mul_f32 v44, v218, v44
    v_mul_f32 v45, v218, v45
    v_mul_f32 v46, v218, v46
    v_mul_f32 v47, v218, v47
    v_cvt_pk_bf16_f32 v48, v32, v33
    v_cvt_pk_bf16_f32 v49, v34, v35
    v_cvt_pk_bf16_f32 v50, v36, v37
    v_cvt_pk_bf16_f32 v51, v38, v39
    v_cvt_pk_bf16_f32 v52, v40, v41
    v_cvt_pk_bf16_f32 v53, v42, v43
    v_cvt_pk_bf16_f32 v54, v44, v45
    v_cvt_pk_bf16_f32 v55, v46, v47
    s_nop 1
    v_permlane32_swap_b32 v48, v50
    v_permlane32_swap_b32 v49, v51
    v_permlane32_swap_b32 v52, v54
    v_permlane32_swap_b32 v53, v55
    buffer_store_dwordx4 v[48:51], v241, s[28:31], 0 offen offset:192
    buffer_store_dwordx4 v[52:55], v241, s[28:31], 0 offen offset:224
    v_accvgpr_read_b32 v0, a64
    v_accvgpr_read_b32 v1, a65
    v_accvgpr_read_b32 v2, a66
    v_accvgpr_read_b32 v3, a67
    v_accvgpr_read_b32 v4, a68
    v_accvgpr_read_b32 v5, a69
    v_accvgpr_read_b32 v6, a70
    v_accvgpr_read_b32 v7, a71
    v_accvgpr_read_b32 v8, a72
    v_accvgpr_read_b32 v9, a73
    v_accvgpr_read_b32 v10, a74
    v_accvgpr_read_b32 v11, a75
    v_accvgpr_read_b32 v12, a76
    v_accvgpr_read_b32 v13, a77
    v_accvgpr_read_b32 v14, a78
    v_accvgpr_read_b32 v15, a79
    v_mul_f32 v0, v218, v0
    v_mul_f32 v1, v218, v1
    v_mul_f32 v2, v218, v2
    v_mul_f32 v3, v218, v3
    v_mul_f32 v4, v218, v4
    v_mul_f32 v5, v218, v5
    v_mul_f32 v6, v218, v6
    v_mul_f32 v7, v218, v7
    v_mul_f32 v8, v218, v8
    v_mul_f32 v9, v218, v9
    v_mul_f32 v10, v218, v10
    v_mul_f32 v11, v218, v11
    v_mul_f32 v12, v218, v12
    v_mul_f32 v13, v218, v13
    v_mul_f32 v14, v218, v14
    v_mul_f32 v15, v218, v15
    v_cvt_pk_bf16_f32 v16, v0, v1
    v_cvt_pk_bf16_f32 v17, v2, v3
    v_cvt_pk_bf16_f32 v18, v4, v5
    v_cvt_pk_bf16_f32 v19, v6, v7
    v_cvt_pk_bf16_f32 v20, v8, v9
    v_cvt_pk_bf16_f32 v21, v10, v11
    v_cvt_pk_bf16_f32 v22, v12, v13
    v_cvt_pk_bf16_f32 v23, v14, v15
    s_nop 1
    v_permlane32_swap_b32 v16, v18
    v_permlane32_swap_b32 v17, v19
    v_permlane32_swap_b32 v20, v22
    v_permlane32_swap_b32 v21, v23
    buffer_store_dwordx4 v[16:19], v241, s[28:31], 0 offen offset:256
    buffer_store_dwordx4 v[20:23], v241, s[28:31], 0 offen offset:288
    v_accvgpr_read_b32 v32, a80
    v_accvgpr_read_b32 v33, a81
    v_accvgpr_read_b32 v34, a82
    v_accvgpr_read_b32 v35, a83
    v_accvgpr_read_b32 v36, a84
    v_accvgpr_read_b32 v37, a85
    v_accvgpr_read_b32 v38, a86
    v_accvgpr_read_b32 v39, a87
    v_accvgpr_read_b32 v40, a88
    v_accvgpr_read_b32 v41, a89
    v_accvgpr_read_b32 v42, a90
    v_accvgpr_read_b32 v43, a91
    v_accvgpr_read_b32 v44, a92
    v_accvgpr_read_b32 v45, a93
    v_accvgpr_read_b32 v46, a94
    v_accvgpr_read_b32 v47, a95
    v_mul_f32 v32, v218, v32
    v_mul_f32 v33, v218, v33
    v_mul_f32 v34, v218, v34
    v_mul_f32 v35, v218, v35
    v_mul_f32 v36, v218, v36
    v_mul_f32 v37, v218, v37
    v_mul_f32 v38, v218, v38
    v_mul_f32 v39, v218, v39
    v_mul_f32 v40, v218, v40
    v_mul_f32 v41, v218, v41
    v_mul_f32 v42, v218, v42
    v_mul_f32 v43, v218, v43
    v_mul_f32 v44, v218, v44
    v_mul_f32 v45, v218, v45
    v_mul_f32 v46, v218, v46
    v_mul_f32 v47, v218, v47
    v_cvt_pk_bf16_f32 v48, v32, v33
    v_cvt_pk_bf16_f32 v49, v34, v35
    v_cvt_pk_bf16_f32 v50, v36, v37
    v_cvt_pk_bf16_f32 v51, v38, v39
    v_cvt_pk_bf16_f32 v52, v40, v41
    v_cvt_pk_bf16_f32 v53, v42, v43
    v_cvt_pk_bf16_f32 v54, v44, v45
    v_cvt_pk_bf16_f32 v55, v46, v47
    s_nop 1
    v_permlane32_swap_b32 v48, v50
    v_permlane32_swap_b32 v49, v51
    v_permlane32_swap_b32 v52, v54
    v_permlane32_swap_b32 v53, v55
    buffer_store_dwordx4 v[48:51], v241, s[28:31], 0 offen offset:320
    buffer_store_dwordx4 v[52:55], v241, s[28:31], 0 offen offset:352
    v_accvgpr_read_b32 v0, a96
    v_accvgpr_read_b32 v1, a97
    v_accvgpr_read_b32 v2, a98
    v_accvgpr_read_b32 v3, a99
    v_accvgpr_read_b32 v4, a100
    v_accvgpr_read_b32 v5, a101
    v_accvgpr_read_b32 v6, a102
    v_accvgpr_read_b32 v7, a103
    v_accvgpr_read_b32 v8, a104
    v_accvgpr_read_b32 v9, a105
    v_accvgpr_read_b32 v10, a106
    v_accvgpr_read_b32 v11, a107
    v_accvgpr_read_b32 v12, a108
    v_accvgpr_read_b32 v13, a109
    v_accvgpr_read_b32 v14, a110
    v_accvgpr_read_b32 v15, a111
    v_mul_f32 v0, v220, v0
    v_mul_f32 v1, v220, v1
    v_mul_f32 v2, v220, v2
    v_mul_f32 v3, v220, v3
    v_mul_f32 v4, v220, v4
    v_mul_f32 v5, v220, v5
    v_mul_f32 v6, v220, v6
    v_mul_f32 v7, v220, v7
    v_mul_f32 v8, v220, v8
    v_mul_f32 v9, v220, v9
    v_mul_f32 v10, v220, v10
    v_mul_f32 v11, v220, v11
    v_mul_f32 v12, v220, v12
    v_mul_f32 v13, v220, v13
    v_mul_f32 v14, v220, v14
    v_mul_f32 v15, v220, v15
    v_cvt_pk_bf16_f32 v16, v0, v1
    v_cvt_pk_bf16_f32 v17, v2, v3
    v_cvt_pk_bf16_f32 v18, v4, v5
    v_cvt_pk_bf16_f32 v19, v6, v7
    v_cvt_pk_bf16_f32 v20, v8, v9
    v_cvt_pk_bf16_f32 v21, v10, v11
    v_cvt_pk_bf16_f32 v22, v12, v13
    v_cvt_pk_bf16_f32 v23, v14, v15
    s_nop 1
    v_permlane32_swap_b32 v16, v18
    v_permlane32_swap_b32 v17, v19
    v_permlane32_swap_b32 v20, v22
    v_permlane32_swap_b32 v21, v23
    buffer_store_dwordx4 v[16:19], v242, s[28:31], 0 offen offset:0
    buffer_store_dwordx4 v[20:23], v242, s[28:31], 0 offen offset:32
    v_accvgpr_read_b32 v32, a112
    v_accvgpr_read_b32 v33, a113
    v_accvgpr_read_b32 v34, a114
    v_accvgpr_read_b32 v35, a115
    v_accvgpr_read_b32 v36, a116
    v_accvgpr_read_b32 v37, a117
    v_accvgpr_read_b32 v38, a118
    v_accvgpr_read_b32 v39, a119
    v_accvgpr_read_b32 v40, a120
    v_accvgpr_read_b32 v41, a121
    v_accvgpr_read_b32 v42, a122
    v_accvgpr_read_b32 v43, a123
    v_accvgpr_read_b32 v44, a124
    v_accvgpr_read_b32 v45, a125
    v_accvgpr_read_b32 v46, a126
    v_accvgpr_read_b32 v47, a127
    v_mul_f32 v32, v220, v32
    v_mul_f32 v33, v220, v33
    v_mul_f32 v34, v220, v34
    v_mul_f32 v35, v220, v35
    v_mul_f32 v36, v220, v36
    v_mul_f32 v37, v220, v37
    v_mul_f32 v38, v220, v38
    v_mul_f32 v39, v220, v39
    v_mul_f32 v40, v220, v40
    v_mul_f32 v41, v220, v41
    v_mul_f32 v42, v220, v42
    v_mul_f32 v43, v220, v43
    v_mul_f32 v44, v220, v44
    v_mul_f32 v45, v220, v45
    v_mul_f32 v46, v220, v46
    v_mul_f32 v47, v220, v47
    v_cvt_pk_bf16_f32 v48, v32, v33
    v_cvt_pk_bf16_f32 v49, v34, v35
    v_cvt_pk_bf16_f32 v50, v36, v37
    v_cvt_pk_bf16_f32 v51, v38, v39
    v_cvt_pk_bf16_f32 v52, v40, v41
    v_cvt_pk_bf16_f32 v53, v42, v43
    v_cvt_pk_bf16_f32 v54, v44, v45
    v_cvt_pk_bf16_f32 v55, v46, v47
    s_nop 1
    v_permlane32_swap_b32 v48, v50
    v_permlane32_swap_b32 v49, v51
    v_permlane32_swap_b32 v52, v54
    v_permlane32_swap_b32 v53, v55
    buffer_store_dwordx4 v[48:51], v242, s[28:31], 0 offen offset:64
    buffer_store_dwordx4 v[52:55], v242, s[28:31], 0 offen offset:96
    v_accvgpr_read_b32 v0, a128
    v_accvgpr_read_b32 v1, a129
    v_accvgpr_read_b32 v2, a130
    v_accvgpr_read_b32 v3, a131
    v_accvgpr_read_b32 v4, a132
    v_accvgpr_read_b32 v5, a133
    v_accvgpr_read_b32 v6, a134
    v_accvgpr_read_b32 v7, a135
    v_accvgpr_read_b32 v8, a136
    v_accvgpr_read_b32 v9, a137
    v_accvgpr_read_b32 v10, a138
    v_accvgpr_read_b32 v11, a139
    v_accvgpr_read_b32 v12, a140
    v_accvgpr_read_b32 v13, a141
    v_accvgpr_read_b32 v14, a142
    v_accvgpr_read_b32 v15, a143
    v_mul_f32 v0, v220, v0
    v_mul_f32 v1, v220, v1
    v_mul_f32 v2, v220, v2
    v_mul_f32 v3, v220, v3
    v_mul_f32 v4, v220, v4
    v_mul_f32 v5, v220, v5
    v_mul_f32 v6, v220, v6
    v_mul_f32 v7, v220, v7
    v_mul_f32 v8, v220, v8
    v_mul_f32 v9, v220, v9
    v_mul_f32 v10, v220, v10
    v_mul_f32 v11, v220, v11
    v_mul_f32 v12, v220, v12
    v_mul_f32 v13, v220, v13
    v_mul_f32 v14, v220, v14
    v_mul_f32 v15, v220, v15
    v_cvt_pk_bf16_f32 v16, v0, v1
    v_cvt_pk_bf16_f32 v17, v2, v3
    v_cvt_pk_bf16_f32 v18, v4, v5
    v_cvt_pk_bf16_f32 v19, v6, v7
    v_cvt_pk_bf16_f32 v20, v8, v9
    v_cvt_pk_bf16_f32 v21, v10, v11
    v_cvt_pk_bf16_f32 v22, v12, v13
    v_cvt_pk_bf16_f32 v23, v14, v15
    s_nop 1
    v_permlane32_swap_b32 v16, v18
    v_permlane32_swap_b32 v17, v19
    v_permlane32_swap_b32 v20, v22
    v_permlane32_swap_b32 v21, v23
    buffer_store_dwordx4 v[16:19], v242, s[28:31], 0 offen offset:128
    buffer_store_dwordx4 v[20:23], v242, s[28:31], 0 offen offset:160
    v_accvgpr_read_b32 v32, a144
    v_accvgpr_read_b32 v33, a145
    v_accvgpr_read_b32 v34, a146
    v_accvgpr_read_b32 v35, a147
    v_accvgpr_read_b32 v36, a148
    v_accvgpr_read_b32 v37, a149
    v_accvgpr_read_b32 v38, a150
    v_accvgpr_read_b32 v39, a151
    v_accvgpr_read_b32 v40, a152
    v_accvgpr_read_b32 v41, a153
    v_accvgpr_read_b32 v42, a154
    v_accvgpr_read_b32 v43, a155
    v_accvgpr_read_b32 v44, a156
    v_accvgpr_read_b32 v45, a157
    v_accvgpr_read_b32 v46, a158
    v_accvgpr_read_b32 v47, a159
    v_mul_f32 v32, v220, v32
    v_mul_f32 v33, v220, v33
    v_mul_f32 v34, v220, v34
    v_mul_f32 v35, v220, v35
    v_mul_f32 v36, v220, v36
    v_mul_f32 v37, v220, v37
    v_mul_f32 v38, v220, v38
    v_mul_f32 v39, v220, v39
    v_mul_f32 v40, v220, v40
    v_mul_f32 v41, v220, v41
    v_mul_f32 v42, v220, v42
    v_mul_f32 v43, v220, v43
    v_mul_f32 v44, v220, v44
    v_mul_f32 v45, v220, v45
    v_mul_f32 v46, v220, v46
    v_mul_f32 v47, v220, v47
    v_cvt_pk_bf16_f32 v48, v32, v33
    v_cvt_pk_bf16_f32 v49, v34, v35
    v_cvt_pk_bf16_f32 v50, v36, v37
    v_cvt_pk_bf16_f32 v51, v38, v39
    v_cvt_pk_bf16_f32 v52, v40, v41
    v_cvt_pk_bf16_f32 v53, v42, v43
    v_cvt_pk_bf16_f32 v54, v44, v45
    v_cvt_pk_bf16_f32 v55, v46, v47
    s_nop 1
    v_permlane32_swap_b32 v48, v50
    v_permlane32_swap_b32 v49, v51
    v_permlane32_swap_b32 v52, v54
    v_permlane32_swap_b32 v53, v55
    buffer_store_dwordx4 v[48:51], v242, s[28:31], 0 offen offset:192
    buffer_store_dwordx4 v[52:55], v242, s[28:31], 0 offen offset:224
    v_accvgpr_read_b32 v0, a160
    v_accvgpr_read_b32 v1, a161
    v_accvgpr_read_b32 v2, a162
    v_accvgpr_read_b32 v3, a163
    v_accvgpr_read_b32 v4, a164
    v_accvgpr_read_b32 v5, a165
    v_accvgpr_read_b32 v6, a166
    v_accvgpr_read_b32 v7, a167
    v_accvgpr_read_b32 v8, a168
    v_accvgpr_read_b32 v9, a169
    v_accvgpr_read_b32 v10, a170
    v_accvgpr_read_b32 v11, a171
    v_accvgpr_read_b32 v12, a172
    v_accvgpr_read_b32 v13, a173
    v_accvgpr_read_b32 v14, a174
    v_accvgpr_read_b32 v15, a175
    v_mul_f32 v0, v220, v0
    v_mul_f32 v1, v220, v1
    v_mul_f32 v2, v220, v2
    v_mul_f32 v3, v220, v3
    v_mul_f32 v4, v220, v4
    v_mul_f32 v5, v220, v5
    v_mul_f32 v6, v220, v6
    v_mul_f32 v7, v220, v7
    v_mul_f32 v8, v220, v8
    v_mul_f32 v9, v220, v9
    v_mul_f32 v10, v220, v10
    v_mul_f32 v11, v220, v11
    v_mul_f32 v12, v220, v12
    v_mul_f32 v13, v220, v13
    v_mul_f32 v14, v220, v14
    v_mul_f32 v15, v220, v15
    v_cvt_pk_bf16_f32 v16, v0, v1
    v_cvt_pk_bf16_f32 v17, v2, v3
    v_cvt_pk_bf16_f32 v18, v4, v5
    v_cvt_pk_bf16_f32 v19, v6, v7
    v_cvt_pk_bf16_f32 v20, v8, v9
    v_cvt_pk_bf16_f32 v21, v10, v11
    v_cvt_pk_bf16_f32 v22, v12, v13
    v_cvt_pk_bf16_f32 v23, v14, v15
    s_nop 1
    v_permlane32_swap_b32 v16, v18
    v_permlane32_swap_b32 v17, v19
    v_permlane32_swap_b32 v20, v22
    v_permlane32_swap_b32 v21, v23
    buffer_store_dwordx4 v[16:19], v242, s[28:31], 0 offen offset:256
    buffer_store_dwordx4 v[20:23], v242, s[28:31], 0 offen offset:288
    v_accvgpr_read_b32 v32, a176
    v_accvgpr_read_b32 v33, a177
    v_accvgpr_read_b32 v34, a178
    v_accvgpr_read_b32 v35, a179
    v_accvgpr_read_b32 v36, a180
    v_accvgpr_read_b32 v37, a181
    v_accvgpr_read_b32 v38, a182
    v_accvgpr_read_b32 v39, a183
    v_accvgpr_read_b32 v40, a184
    v_accvgpr_read_b32 v41, a185
    v_accvgpr_read_b32 v42, a186
    v_accvgpr_read_b32 v43, a187
    v_accvgpr_read_b32 v44, a188
    v_accvgpr_read_b32 v45, a189
    v_accvgpr_read_b32 v46, a190
    v_accvgpr_read_b32 v47, a191
    v_mul_f32 v32, v220, v32
    v_mul_f32 v33, v220, v33
    v_mul_f32 v34, v220, v34
    v_mul_f32 v35, v220, v35
    v_mul_f32 v36, v220, v36
    v_mul_f32 v37, v220, v37
    v_mul_f32 v38, v220, v38
    v_mul_f32 v39, v220, v39
    v_mul_f32 v40, v220, v40
    v_mul_f32 v41, v220, v41
    v_mul_f32 v42, v220, v42
    v_mul_f32 v43, v220, v43
    v_mul_f32 v44, v220, v44
    v_mul_f32 v45, v220, v45
    v_mul_f32 v46, v220, v46
    v_mul_f32 v47, v220, v47
    v_cvt_pk_bf16_f32 v48, v32, v33
    v_cvt_pk_bf16_f32 v49, v34, v35
    v_cvt_pk_bf16_f32 v50, v36, v37
    v_cvt_pk_bf16_f32 v51, v38, v39
    v_cvt_pk_bf16_f32 v52, v40, v41
    v_cvt_pk_bf16_f32 v53, v42, v43
    v_cvt_pk_bf16_f32 v54, v44, v45
    v_cvt_pk_bf16_f32 v55, v46, v47
    s_nop 1
    v_permlane32_swap_b32 v48, v50
    v_permlane32_swap_b32 v49, v51
    v_permlane32_swap_b32 v52, v54
    v_permlane32_swap_b32 v53, v55
    buffer_store_dwordx4 v[48:51], v242, s[28:31], 0 offen offset:320
    buffer_store_dwordx4 v[52:55], v242, s[28:31], 0 offen offset:352
F_end:
    s_endpgm
F_slowP:
    s_nop 15
    s_nop 15
    v_max3_f32 v216, v0, v1, v2
    v_max3_f32 v216, v216, v3, v4
    v_max3_f32 v216, v216, v5, v6
    v_max3_f32 v216, v216, v7, v8
    v_max3_f32 v216, v216, v9, v10
    v_max3_f32 v216, v216, v11, v12
    v_max3_f32 v216, v216, v13, v14
    v_max_f32 v216, v216, v15
    v_mov_b32 v217, v216
    s_nop 1
    v_permlane32_swap_b32 v216, v217
    s_nop 1
    v_max_f32 v216, v216, v217
    v_max_f32 v216, 0, v216
    v_sub_f32 v217, 0, v216
    v_exp_f32 v218, v217
    v_sub_f32 v96, v96, v216
    v_sub_f32 v0, v0, v216
    v_sub_f32 v32, v32, v216
    v_sub_f32 v97, v97, v216
    v_sub_f32 v1, v1, v216
    v_sub_f32 v33, v33, v216
    v_sub_f32 v98, v98, v216
    v_sub_f32 v2, v2, v216
    v_sub_f32 v34, v34, v216
    v_sub_f32 v99, v99, v216
    v_sub_f32 v3, v3, v216
    v_sub_f32 v35, v35, v216
    v_sub_f32 v100, v100, v216
    v_sub_f32 v4, v4, v216
    v_sub_f32 v36, v36, v216
    v_sub_f32 v101, v101, v216
    v_sub_f32 v5, v5, v216
    v_sub_f32 v37, v37, v216
    v_sub_f32 v102, v102, v216
    v_sub_f32 v6, v6, v216
    v_sub_f32 v38, v38, v216
    v_sub_f32 v103, v103, v216
    v_sub_f32 v7, v7, v216
    v_sub_f32 v39, v39, v216
    v_sub_f32 v104, v104, v216
    v_sub_f32 v8, v8, v216
    v_sub_f32 v40, v40, v216
    v_sub_f32 v105, v105, v216
    v_sub_f32 v9, v9, v216
    v_sub_f32 v41, v41, v216
    v_sub_f32 v106, v106, v216
    v_sub_f32 v10, v10, v216
    v_sub_f32 v42, v42, v216
    v_sub_f32 v107, v107, v216
    v_sub_f32 v11, v11, v216
    v_sub_f32 v43, v43, v216
    v_sub_f32 v108, v108, v216
    v_sub_f32 v12, v12, v216
    v_sub_f32 v44, v44, v216
    v_sub_f32 v109, v109, v216
    v_sub_f32 v13, v13, v216
    v_sub_f32 v45, v45, v216
    v_sub_f32 v110, v110, v216
    v_sub_f32 v14, v14, v216
    v_sub_f32 v46, v46, v216
    v_sub_f32 v111, v111, v216
    v_sub_f32 v15, v15, v216
    v_sub_f32 v47, v47, v216
    v_mul_f32 v212, v212, v218
    v_max3_f32 v216, v16, v17, v18
    v_max3_f32 v216, v216, v19, v20
    v_max3_f32 v216, v216, v21, v22
    v_max3_f32 v216, v216, v23, v24
    v_max3_f32 v216, v216, v25, v26
    v_max3_f32 v216, v216, v27, v28
    v_max3_f32 v216, v216, v29, v30
    v_max_f32 v216, v216, v31
    v_mov_b32 v217, v216
    s_nop 1
    v_permlane32_swap_b32 v216, v217
    s_nop 1
    v_max_f32 v216, v216, v217
    v_max_f32 v216, 0, v216
    v_sub_f32 v217, 0, v216
    v_exp_f32 v218, v217
    v_sub_f32 v112, v112, v216
    v_sub_f32 v16, v16, v216
    v_sub_f32 v48, v48, v216
    v_sub_f32 v113, v113, v216
    v_sub_f32 v17, v17, v216
    v_sub_f32 v49, v49, v216
    v_sub_f32 v114, v114, v216
    v_sub_f32 v18, v18, v216
    v_sub_f32 v50, v50, v216
    v_sub_f32 v115, v115, v216
    v_sub_f32 v19, v19, v216
    v_sub_f32 v51, v51, v216
    v_sub_f32 v116, v116, v216
    v_sub_f32 v20, v20, v216
    v_sub_f32 v52, v52, v216
    v_sub_f32 v117, v117, v216
    v_sub_f32 v21, v21, v216
    v_sub_f32 v53, v53, v216
    v_sub_f32 v118, v118, v216
    v_sub_f32 v22, v22, v216
    v_sub_f32 v54, v54, v216
    v_sub_f32 v119, v119, v216
    v_sub_f32 v23, v23, v216
    v_sub_f32 v55, v55, v216
    v_sub_f32 v120, v120, v216
    v_sub_f32 v24, v24, v216
    v_sub_f32 v56, v56, v216
    v_sub_f32 v121, v121, v216
    v_sub_f32 v25, v25, v216
    v_sub_f32 v57, v57, v216
    v_sub_f32 v122, v122, v216
    v_sub_f32 v26, v26, v216
    v_sub_f32 v58, v58, v216
    v_sub_f32 v123, v123, v216
    v_sub_f32 v27, v27, v216
    v_sub_f32 v59, v59, v216
    v_sub_f32 v124, v124, v216
    v_sub_f32 v28, v28, v216
    v_sub_f32 v60, v60, v216
    v_sub_f32 v125, v125, v216
    v_sub_f32 v29, v29, v216
    v_sub_f32 v61, v61, v216
    v_sub_f32 v126, v126, v216
    v_sub_f32 v30, v30, v216
    v_sub_f32 v62, v62, v216
    v_sub_f32 v127, v127, v216
    v_sub_f32 v31, v31, v216
    v_sub_f32 v63, v63, v216
    v_mul_f32 v213, v213, v218
    v_exp_f32 v192, v0
    s_nop 0
    v_exp_f32 v193, v1
    s_nop 0
    v_exp_f32 v194, v2
    s_nop 0
    v_exp_f32 v195, v3
    s_nop 0
    v_add_f32 v214, v192, v193
    s_nop 0
    v_cvt_pk_bf16_f32 v64, v192, v193
    s_nop 0
    v_exp_f32 v196, v4
    s_nop 0
    v_add_f32 v214, v214, v194
    s_nop 0
    v_exp_f32 v197, v5
    s_nop 0
    v_add_f32 v214, v214, v195
    s_nop 0
    v_cvt_pk_bf16_f32 v65, v194, v195
    s_nop 0
    v_exp_f32 v192, v6
    s_nop 0
    v_add_f32 v214, v214, v196
    s_nop 0
    v_exp_f32 v193, v7
    s_nop 0
    v_add_f32 v214, v214, v197
    s_nop 0
    v_cvt_pk_bf16_f32 v66, v196, v197
    s_nop 0
    v_exp_f32 v194, v8
    s_nop 0
    v_add_f32 v214, v214, v192
    s_nop 0
    v_exp_f32 v195, v9
    s_nop 0
    v_add_f32 v214, v214, v193
    s_nop 0
    v_cvt_pk_bf16_f32 v67, v192, v193
    s_nop 0
    v_exp_f32 v196, v10
    s_nop 0
    v_add_f32 v214, v214, v194
    s_nop 0
    v_exp_f32 v197, v11
    s_nop 0
    v_add_f32 v214, v214, v195
    s_nop 0
    v_cvt_pk_bf16_f32 v68, v194, v195
    s_nop 0
    v_exp_f32 v192, v12
    s_nop 0
    v_add_f32 v214, v214, v196
    s_nop 0
    v_exp_f32 v193, v13
    s_nop 0
    v_add_f32 v214, v214, v197
    s_nop 0
    v_cvt_pk_bf16_f32 v69, v196, v197
    s_nop 0
    v_exp_f32 v194, v14
    s_nop 0
    v_add_f32 v214, v214, v192
    s_nop 0
    v_exp_f32 v195, v15
    s_nop 0
    v_add_f32 v214, v214, v193
    s_nop 0
    v_cvt_pk_bf16_f32 v70, v192, v193
    s_nop 0
    v_exp_f32 v196, v16
    s_nop 0
    v_add_f32 v214, v214, v194
    s_nop 0
    v_exp_f32 v197, v17
    s_nop 0
    v_add_f32 v214, v214, v195
    s_nop 0
    v_cvt_pk_bf16_f32 v71, v194, v195
    s_nop 0
    v_exp_f32 v192, v18
    s_nop 0
    v_exp_f32 v193, v19
    s_nop 0
    v_add_f32 v215, v196, v197
    s_nop 0
    v_cvt_pk_bf16_f32 v72, v196, v197
    s_nop 0
    v_exp_f32 v194, v20
    s_nop 0
    v_add_f32 v215, v215, v192
    s_nop 0
    v_exp_f32 v195, v21
    s_nop 0
    v_add_f32 v215, v215, v193
    s_nop 0
    v_cvt_pk_bf16_f32 v73, v192, v193
    s_nop 0
    v_exp_f32 v196, v22
    s_nop 0
    v_add_f32 v215, v215, v194
    s_nop 0
    v_exp_f32 v197, v23
    s_nop 0
    v_add_f32 v215, v215, v195
    s_nop 0
    v_cvt_pk_bf16_f32 v74, v194, v195
    s_nop 0
    v_exp_f32 v192, v24
    s_nop 0
    v_add_f32 v215, v215, v196
    s_nop 0
    v_exp_f32 v193, v25
    s_nop 0
    v_add_f32 v215, v215, v197
    s_nop 0
    v_cvt_pk_bf16_f32 v75, v196, v197
    s_nop 0
    v_exp_f32 v194, v26
    s_nop 0
    v_add_f32 v215, v215, v192
    s_nop 0
    v_exp_f32 v195, v27
    s_nop 0
    v_add_f32 v215, v215, v193
    s_nop 0
    v_cvt_pk_bf16_f32 v76, v192, v193
    s_nop 0
    v_exp_f32 v196, v28
    s_nop 0
    v_add_f32 v215, v215, v194
    s_nop 0
    v_exp_f32 v197, v29
    s_nop 0
    v_add_f32 v215, v215, v195
    s_nop 0
    v_cvt_pk_bf16_f32 v77, v194, v195
    s_nop 0
    v_exp_f32 v192, v30
    s_nop 0
    v_add_f32 v215, v215, v196
    s_nop 0
    v_exp_f32 v193, v31
    s_nop 0
    v_add_f32 v215, v215, v197
    s_nop 0
    v_cvt_pk_bf16_f32 v78, v196, v197
    s_nop 0
    v_add_f32 v215, v215, v192
    s_nop 0
    v_add_f32 v215, v215, v193
    s_nop 0
    v_cvt_pk_bf16_f32 v79, v192, v193
    s_nop 0
    s_nop 3
    s_branch F_retP
F_slowL1:
    s_nop 15
    s_nop 15
    v_max3_f32 v216, v32, v33, v34
    v_max3_f32 v216, v216, v35, v36
    v_max3_f32 v216, v216, v37, v38
    v_max3_f32 v216, v216, v39, v40
    v_max3_f32 v216, v216, v41, v42
    v_max3_f32 v216, v216, v43, v44
    v_max3_f32 v216, v216, v45, v46
    v_max_f32 v216, v216, v47
    v_mov_b32 v217, v216
    s_nop 1
    v_permlane32_swap_b32 v216, v217
    s_nop 1
    v_max_f32 v216, v216, v217
    v_max_f32 v216, 0, v216
    v_sub_f32 v217, 0, v216
    v_exp_f32 v218, v217
    v_sub_f32 v96, v96, v216
    v_sub_f32 v32, v32, v216
    v_sub_f32 v0, v0, v216
    v_sub_f32 v97, v97, v216
    v_sub_f32 v33, v33, v216
    v_sub_f32 v1, v1, v216
    v_sub_f32 v98, v98, v216
    v_sub_f32 v34, v34, v216
    v_sub_f32 v2, v2, v216
    v_sub_f32 v99, v99, v216
    v_sub_f32 v35, v35, v216
    v_sub_f32 v3, v3, v216
    v_sub_f32 v100, v100, v216
    v_sub_f32 v36, v36, v216
    v_sub_f32 v4, v4, v216
    v_sub_f32 v101, v101, v216
    v_sub_f32 v37, v37, v216
    v_sub_f32 v5, v5, v216
    v_sub_f32 v102, v102, v216
    v_sub_f32 v38, v38, v216
    v_sub_f32 v6, v6, v216
    v_sub_f32 v103, v103, v216
    v_sub_f32 v39, v39, v216
    v_sub_f32 v7, v7, v216
    v_sub_f32 v104, v104, v216
    v_sub_f32 v40, v40, v216
    v_sub_f32 v8, v8, v216
    v_sub_f32 v105, v105, v216
    v_sub_f32 v41, v41, v216
    v_sub_f32 v9, v9, v216
    v_sub_f32 v106, v106, v216
    v_sub_f32 v42, v42, v216
    v_sub_f32 v10, v10, v216
    v_sub_f32 v107, v107, v216
    v_sub_f32 v43, v43, v216
    v_sub_f32 v11, v11, v216
    v_sub_f32 v108, v108, v216
    v_sub_f32 v44, v44, v216
    v_sub_f32 v12, v12, v216
    v_sub_f32 v109, v109, v216
    v_sub_f32 v45, v45, v216
    v_sub_f32 v13, v13, v216
    v_sub_f32 v110, v110, v216
    v_sub_f32 v46, v46, v216
    v_sub_f32 v14, v14, v216
    v_sub_f32 v111, v111, v216
    v_sub_f32 v47, v47, v216
    v_sub_f32 v15, v15, v216
    v_mul_f32 v212, v212, v218
    v_accvgpr_read_b32 v220, a0
    v_accvgpr_read_b32 v221, a1
    v_accvgpr_read_b32 v222, a2
    v_accvgpr_read_b32 v223, a3
    v_mul_f32 v220, v220, v218
    v_mul_f32 v221, v221, v218
    v_mul_f32 v222, v222, v218
    v_mul_f32 v223, v223, v218
    v_accvgpr_write_b32 a0, v220
    v_accvgpr_write_b32 a1, v221
    v_accvgpr_write_b32 a2, v222
    v_accvgpr_write_b32 a3, v223
    v_accvgpr_read_b32 v220, a4
    v_accvgpr_read_b32 v221, a5
    v_accvgpr_read_b32 v222, a6
    v_accvgpr_read_b32 v223, a7
    v_mul_f32 v220, v220, v218
    v_mul_f32 v221, v221, v218
    v_mul_f32 v222, v222, v218
    v_mul_f32 v223, v223, v218
    v_accvgpr_write_b32 a4, v220
    v_accvgpr_write_b32 a5, v221
    v_accvgpr_write_b32 a6, v222
    v_accvgpr_write_b32 a7, v223
    v_accvgpr_read_b32 v220, a8
    v_accvgpr_read_b32 v221, a9
    v_accvgpr_read_b32 v222, a10
    v_accvgpr_read_b32 v223, a11
    v_mul_f32 v220, v220, v218
    v_mul_f32 v221, v221, v218
    v_mul_f32 v222, v222, v218
    v_mul_f32 v223, v223, v218
    v_accvgpr_write_b32 a8, v220
    v_accvgpr_write_b32 a9, v221
    v_accvgpr_write_b32 a10, v222
    v_accvgpr_write_b32 a11, v223
    v_accvgpr_read_b32 v220, a12
    v_accvgpr_read_b32 v221, a13
    v_accvgpr_read_b32 v222, a14
    v_accvgpr_read_b32 v223, a15
    v_mul_f32 v220, v220, v218
    v_mul_f32 v221, v221, v218
    v_mul_f32 v222, v222, v218
    v_mul_f32 v223, v223, v218
    v_accvgpr_write_b32 a12, v220
    v_accvgpr_write_b32 a13, v221
    v_accvgpr_write_b32 a14, v222
    v_accvgpr_write_b32 a15, v223
    v_accvgpr_read_b32 v220, a16
    v_accvgpr_read_b32 v221, a17
    v_accvgpr_read_b32 v222, a18
    v_accvgpr_read_b32 v223, a19
    v_mul_f32 v220, v220, v218
    v_mul_f32 v221, v221, v218
    v_mul_f32 v222, v222, v218
    v_mul_f32 v223, v223, v218
    v_accvgpr_write_b32 a16, v220
    v_accvgpr_write_b32 a17, v221
    v_accvgpr_write_b32 a18, v222
    v_accvgpr_write_b32 a19, v223
    v_accvgpr_read_b32 v220, a20
    v_accvgpr_read_b32 v221, a21
    v_accvgpr_read_b32 v222, a22
    v_accvgpr_read_b32 v223, a23
    v_mul_f32 v220, v220, v218
    v_mul_f32 v221, v221, v218
    v_mul_f32 v222, v222, v218
    v_mul_f32 v223, v223, v218
    v_accvgpr_write_b32 a20, v220
    v_accvgpr_write_b32 a21, v221
    v_accvgpr_write_b32 a22, v222
    v_accvgpr_write_b32 a23, v223
    v_accvgpr_read_b32 v220, a24
    v_accvgpr_read_b32 v221, a25
    v_accvgpr_read_b32 v222, a26
    v_accvgpr_read_b32 v223, a27
    v_mul_f32 v220, v220, v218
    v_mul_f32 v221, v221, v218
    v_mul_f32 v222, v222, v218
    v_mul_f32 v223, v223, v218
    v_accvgpr_write_b32 a24, v220
    v_accvgpr_write_b32 a25, v221
    v_accvgpr_write_b32 a26, v222
    v_accvgpr_write_b32 a27, v223
    v_accvgpr_read_b32 v220, a28
    v_accvgpr_read_b32 v221, a29
    v_accvgpr_read_b32 v222, a30
    v_accvgpr_read_b32 v223, a31
    v_mul_f32 v220, v220, v218
    v_mul_f32 v221, v221, v218
    v_mul_f32 v222, v222, v218
    v_mul_f32 v223, v223, v218
    v_accvgpr_write_b32 a28, v220
    v_accvgpr_write_b32 a29, v221
    v_accvgpr_write_b32 a30, v222
    v_accvgpr_write_b32 a31, v223
    v_accvgpr_read_b32 v220, a32
    v_accvgpr_read_b32 v221, a33
    v_accvgpr_read_b32 v222, a34
    v_accvgpr_read_b32 v223, a35
    v_mul_f32 v220, v220, v218
    v_mul_f32 v221, v221, v218
    v_mul_f32 v222, v222, v218
    v_mul_f32 v223, v223, v218
    v_accvgpr_write_b32 a32, v220
    v_accvgpr_write_b32 a33, v221
    v_accvgpr_write_b32 a34, v222
    v_accvgpr_write_b32 a35, v223
    v_accvgpr_read_b32 v220, a36
    v_accvgpr_read_b32 v221, a37
    v_accvgpr_read_b32 v222, a38
    v_accvgpr_read_b32 v223, a39
    v_mul_f32 v220, v220, v218
    v_mul_f32 v221, v221, v218
    v_mul_f32 v222, v222, v218
    v_mul_f32 v223, v223, v218
    v_accvgpr_write_b32 a36, v220
    v_accvgpr_write_b32 a37, v221
    v_accvgpr_write_b32 a38, v222
    v_accvgpr_write_b32 a39, v223
    v_accvgpr_read_b32 v220, a40
    v_accvgpr_read_b32 v221, a41
    v_accvgpr_read_b32 v222, a42
    v_accvgpr_read_b32 v223, a43
    v_mul_f32 v220, v220, v218
    v_mul_f32 v221, v221, v218
    v_mul_f32 v222, v222, v218
    v_mul_f32 v223, v223, v218
    v_accvgpr_write_b32 a40, v220
    v_accvgpr_write_b32 a41, v221
    v_accvgpr_write_b32 a42, v222
    v_accvgpr_write_b32 a43, v223
    v_accvgpr_read_b32 v220, a44
    v_accvgpr_read_b32 v221, a45
    v_accvgpr_read_b32 v222, a46
    v_accvgpr_read_b32 v223, a47
    v_mul_f32 v220, v220, v218
    v_mul_f32 v221, v221, v218
    v_mul_f32 v222, v222, v218
    v_mul_f32 v223, v223, v218
    v_accvgpr_write_b32 a44, v220
    v_accvgpr_write_b32 a45, v221
    v_accvgpr_write_b32 a46, v222
    v_accvgpr_write_b32 a47, v223
    v_accvgpr_read_b32 v220, a48
    v_accvgpr_read_b32 v221, a49
    v_accvgpr_read_b32 v222, a50
    v_accvgpr_read_b32 v223, a51
    v_mul_f32 v220, v220, v218
    v_mul_f32 v221, v221, v218
    v_mul_f32 v222, v222, v218
    v_mul_f32 v223, v223, v218
    v_accvgpr_write_b32 a48, v220
    v_accvgpr_write_b32 a49, v221
    v_accvgpr_write_b32 a50, v222
    v_accvgpr_write_b32 a51, v223
    v_accvgpr_read_b32 v220, a52
    v_accvgpr_read_b32 v221, a53
    v_accvgpr_read_b32 v222, a54
    v_accvgpr_read_b32 v223, a55
    v_mul_f32 v220, v220, v218
    v_mul_f32 v221, v221, v218
    v_mul_f32 v222, v222, v218
    v_mul_f32 v223, v223, v218
    v_accvgpr_write_b32 a52, v220
    v_accvgpr_write_b32 a53, v221
    v_accvgpr_write_b32 a54, v222
    v_accvgpr_write_b32 a55, v223
    v_accvgpr_read_b32 v220, a56
    v_accvgpr_read_b32 v221, a57
    v_accvgpr_read_b32 v222, a58
    v_accvgpr_read_b32 v223, a59
    v_mul_f32 v220, v220, v218
    v_mul_f32 v221, v221, v218
    v_mul_f32 v222, v222, v218
    v_mul_f32 v223, v223, v218
    v_accvgpr_write_b32 a56, v220
    v_accvgpr_write_b32 a57, v221
    v_accvgpr_write_b32 a58, v222
    v_accvgpr_write_b32 a59, v223
    v_accvgpr_read_b32 v220, a60
    v_accvgpr_read_b32 v221, a61
    v_accvgpr_read_b32 v222, a62
    v_accvgpr_read_b32 v223, a63
    v_mul_f32 v220, v220, v218
    v_mul_f32 v221, v221, v218
    v_mul_f32 v222, v222, v218
    v_mul_f32 v223, v223, v218
    v_accvgpr_write_b32 a60, v220
    v_accvgpr_write_b32 a61, v221
    v_accvgpr_write_b32 a62, v222
    v_accvgpr_write_b32 a63, v223
    v_accvgpr_read_b32 v220, a64
    v_accvgpr_read_b32 v221, a65
    v_accvgpr_read_b32 v222, a66
    v_accvgpr_read_b32 v223, a67
    v_mul_f32 v220, v220, v218
    v_mul_f32 v221, v221, v218
    v_mul_f32 v222, v222, v218
    v_mul_f32 v223, v223, v218
    v_accvgpr_write_b32 a64, v220
    v_accvgpr_write_b32 a65, v221
    v_accvgpr_write_b32 a66, v222
    v_accvgpr_write_b32 a67, v223
    v_accvgpr_read_b32 v220, a68
    v_accvgpr_read_b32 v221, a69
    v_accvgpr_read_b32 v222, a70
    v_accvgpr_read_b32 v223, a71
    v_mul_f32 v220, v220, v218
    v_mul_f32 v221, v221, v218
    v_mul_f32 v222, v222, v218
    v_mul_f32 v223, v223, v218
    v_accvgpr_write_b32 a68, v220
    v_accvgpr_write_b32 a69, v221
    v_accvgpr_write_b32 a70, v222
    v_accvgpr_write_b32 a71, v223
    v_accvgpr_read_b32 v220, a72
    v_accvgpr_read_b32 v221, a73
    v_accvgpr_read_b32 v222, a74
    v_accvgpr_read_b32 v223, a75
    v_mul_f32 v220, v220, v218
    v_mul_f32 v221, v221, v218
    v_mul_f32 v222, v222, v218
    v_mul_f32 v223, v223, v218
    v_accvgpr_write_b32 a72, v220
    v_accvgpr_write_b32 a73, v221
    v_accvgpr_write_b32 a74, v222
    v_accvgpr_write_b32 a75, v223
    v_accvgpr_read_b32 v220, a76
    v_accvgpr_read_b32 v221, a77
    v_accvgpr_read_b32 v222, a78
    v_accvgpr_read_b32 v223, a79
    v_mul_f32 v220, v220, v218
    v_mul_f32 v221, v221, v218
    v_mul_f32 v222, v222, v218
    v_mul_f32 v223, v223, v218
    v_accvgpr_write_b32 a76, v220
    v_accvgpr_write_b32 a77, v221
    v_accvgpr_write_b32 a78, v222
    v_accvgpr_write_b32 a79, v223
    v_accvgpr_read_b32 v220, a80
    v_accvgpr_read_b32 v221, a81
    v_accvgpr_read_b32 v222, a82
    v_accvgpr_read_b32 v223, a83
    v_mul_f32 v220, v220, v218
    v_mul_f32 v221, v221, v218
    v_mul_f32 v222, v222, v218
    v_mul_f32 v223, v223, v218
    v_accvgpr_write_b32 a80, v220
    v_accvgpr_write_b32 a81, v221
    v_accvgpr_write_b32 a82, v222
    v_accvgpr_write_b32 a83, v223
    v_accvgpr_read_b32 v220, a84
    v_accvgpr_read_b32 v221, a85
    v_accvgpr_read_b32 v222, a86
    v_accvgpr_read_b32 v223, a87
    v_mul_f32 v220, v220, v218
    v_mul_f32 v221, v221, v218
    v_mul_f32 v222, v222, v218
    v_mul_f32 v223, v223, v218
    v_accvgpr_write_b32 a84, v220
    v_accvgpr_write_b32 a85, v221
    v_accvgpr_write_b32 a86, v222
    v_accvgpr_write_b32 a87, v223
    v_accvgpr_read_b32 v220, a88
    v_accvgpr_read_b32 v221, a89
    v_accvgpr_read_b32 v222, a90
    v_accvgpr_read_b32 v223, a91
    v_mul_f32 v220, v220, v218
    v_mul_f32 v221, v221, v218
    v_mul_f32 v222, v222, v218
    v_mul_f32 v223, v223, v218
    v_accvgpr_write_b32 a88, v220
    v_accvgpr_write_b32 a89, v221
    v_accvgpr_write_b32 a90, v222
    v_accvgpr_write_b32 a91, v223
    v_accvgpr_read_b32 v220, a92
    v_accvgpr_read_b32 v221, a93
    v_accvgpr_read_b32 v222, a94
    v_accvgpr_read_b32 v223, a95
    v_mul_f32 v220, v220, v218
    v_mul_f32 v221, v221, v218
    v_mul_f32 v222, v222, v218
    v_mul_f32 v223, v223, v218
    v_accvgpr_write_b32 a92, v220
    v_accvgpr_write_b32 a93, v221
    v_accvgpr_write_b32 a94, v222
    v_accvgpr_write_b32 a95, v223
    v_max3_f32 v216, v48, v49, v50
    v_max3_f32 v216, v216, v51, v52
    v_max3_f32 v216, v216, v53, v54
    v_max3_f32 v216, v216, v55, v56
    v_max3_f32 v216, v216, v57, v58
    v_max3_f32 v216, v216, v59, v60
    v_max3_f32 v216, v216, v61, v62
    v_max_f32 v216, v216, v63
    v_mov_b32 v217, v216
    s_nop 1
    v_permlane32_swap_b32 v216, v217
    s_nop 1
    v_max_f32 v216, v216, v217
    v_max_f32 v216, 0, v216
    v_sub_f32 v217, 0, v216
    v_exp_f32 v218, v217
    v_sub_f32 v112, v112, v216
    v_sub_f32 v48, v48, v216
    v_sub_f32 v16, v16, v216
    v_sub_f32 v113, v113, v216
    v_sub_f32 v49, v49, v216
    v_sub_f32 v17, v17, v216
    v_sub_f32 v114, v114, v216
    v_sub_f32 v50, v50, v216
    v_sub_f32 v18, v18, v216
    v_sub_f32 v115, v115, v216
    v_sub_f32 v51, v51, v216
    v_sub_f32 v19, v19, v216
    v_sub_f32 v116, v116, v216
    v_sub_f32 v52, v52, v216
    v_sub_f32 v20, v20, v216
    v_sub_f32 v117, v117, v216
    v_sub_f32 v53, v53, v216
    v_sub_f32 v21, v21, v216
    v_sub_f32 v118, v118, v216
    v_sub_f32 v54, v54, v216
    v_sub_f32 v22, v22, v216
    v_sub_f32 v119, v119, v216
    v_sub_f32 v55, v55, v216
    v_sub_f32 v23, v23, v216
    v_sub_f32 v120, v120, v216
    v_sub_f32 v56, v56, v216
    v_sub_f32 v24, v24, v216
    v_sub_f32 v121, v121, v216
    v_sub_f32 v57, v57, v216
    v_sub_f32 v25, v25, v216
    v_sub_f32 v122, v122, v216
    v_sub_f32 v58, v58, v216
    v_sub_f32 v26, v26, v216
    v_sub_f32 v123, v123, v216
    v_sub_f32 v59, v59, v216
    v_sub_f32 v27, v27, v216
    v_sub_f32 v124, v124, v216
    v_sub_f32 v60, v60, v216
    v_sub_f32 v28, v28, v216
    v_sub_f32 v125, v125, v216
    v_sub_f32 v61, v61, v216
    v_sub_f32 v29, v29, v216
    v_sub_f32 v126, v126, v216
    v_sub_f32 v62, v62, v216
    v_sub_f32 v30, v30, v216
    v_sub_f32 v127, v127, v216
    v_sub_f32 v63, v63, v216
    v_sub_f32 v31, v31, v216
    v_mul_f32 v213, v213, v218
    v_accvgpr_read_b32 v220, a96
    v_accvgpr_read_b32 v221, a97
    v_accvgpr_read_b32 v222, a98
    v_accvgpr_read_b32 v223, a99
    v_mul_f32 v220, v220, v218
    v_mul_f32 v221, v221, v218
    v_mul_f32 v222, v222, v218
    v_mul_f32 v223, v223, v218
    v_accvgpr_write_b32 a96, v220
    v_accvgpr_write_b32 a97, v221
    v_accvgpr_write_b32 a98, v222
    v_accvgpr_write_b32 a99, v223
    v_accvgpr_read_b32 v220, a100
    v_accvgpr_read_b32 v221, a101
    v_accvgpr_read_b32 v222, a102
    v_accvgpr_read_b32 v223, a103
    v_mul_f32 v220, v220, v218
    v_mul_f32 v221, v221, v218
    v_mul_f32 v222, v222, v218
    v_mul_f32 v223, v223, v218
    v_accvgpr_write_b32 a100, v220
    v_accvgpr_write_b32 a101, v221
    v_accvgpr_write_b32 a102, v222
    v_accvgpr_write_b32 a103, v223
    v_accvgpr_read_b32 v220, a104
    v_accvgpr_read_b32 v221, a105
    v_accvgpr_read_b32 v222, a106
    v_accvgpr_read_b32 v223, a107
    v_mul_f32 v220, v220, v218
    v_mul_f32 v221, v221, v218
    v_mul_f32 v222, v222, v218
    v_mul_f32 v223, v223, v218
    v_accvgpr_write_b32 a104, v220
    v_accvgpr_write_b32 a105, v221
    v_accvgpr_write_b32 a106, v222
    v_accvgpr_write_b32 a107, v223
    v_accvgpr_read_b32 v220, a108
    v_accvgpr_read_b32 v221, a109
    v_accvgpr_read_b32 v222, a110
    v_accvgpr_read_b32 v223, a111
    v_mul_f32 v220, v220, v218
    v_mul_f32 v221, v221, v218
    v_mul_f32 v222, v222, v218
    v_mul_f32 v223, v223, v218
    v_accvgpr_write_b32 a108, v220
    v_accvgpr_write_b32 a109, v221
    v_accvgpr_write_b32 a110, v222
    v_accvgpr_write_b32 a111, v223
    v_accvgpr_read_b32 v220, a112
    v_accvgpr_read_b32 v221, a113
    v_accvgpr_read_b32 v222, a114
    v_accvgpr_read_b32 v223, a115
    v_mul_f32 v220, v220, v218
    v_mul_f32 v221, v221, v218
    v_mul_f32 v222, v222, v218
    v_mul_f32 v223, v223, v218
    v_accvgpr_write_b32 a112, v220
    v_accvgpr_write_b32 a113, v221
    v_accvgpr_write_b32 a114, v222
    v_accvgpr_write_b32 a115, v223
    v_accvgpr_read_b32 v220, a116
    v_accvgpr_read_b32 v221, a117
    v_accvgpr_read_b32 v222, a118
    v_accvgpr_read_b32 v223, a119
    v_mul_f32 v220, v220, v218
    v_mul_f32 v221, v221, v218
    v_mul_f32 v222, v222, v218
    v_mul_f32 v223, v223, v218
    v_accvgpr_write_b32 a116, v220
    v_accvgpr_write_b32 a117, v221
    v_accvgpr_write_b32 a118, v222
    v_accvgpr_write_b32 a119, v223
    v_accvgpr_read_b32 v220, a120
    v_accvgpr_read_b32 v221, a121
    v_accvgpr_read_b32 v222, a122
    v_accvgpr_read_b32 v223, a123
    v_mul_f32 v220, v220, v218
    v_mul_f32 v221, v221, v218
    v_mul_f32 v222, v222, v218
    v_mul_f32 v223, v223, v218
    v_accvgpr_write_b32 a120, v220
    v_accvgpr_write_b32 a121, v221
    v_accvgpr_write_b32 a122, v222
    v_accvgpr_write_b32 a123, v223
    v_accvgpr_read_b32 v220, a124
    v_accvgpr_read_b32 v221, a125
    v_accvgpr_read_b32 v222, a126
    v_accvgpr_read_b32 v223, a127
    v_mul_f32 v220, v220, v218
    v_mul_f32 v221, v221, v218
    v_mul_f32 v222, v222, v218
    v_mul_f32 v223, v223, v218
    v_accvgpr_write_b32 a124, v220
    v_accvgpr_write_b32 a125, v221
    v_accvgpr_write_b32 a126, v222
    v_accvgpr_write_b32 a127, v223
    v_accvgpr_read_b32 v220, a128
    v_accvgpr_read_b32 v221, a129
    v_accvgpr_read_b32 v222, a130
    v_accvgpr_read_b32 v223, a131
    v_mul_f32 v220, v220, v218
    v_mul_f32 v221, v221, v218
    v_mul_f32 v222, v222, v218
    v_mul_f32 v223, v223, v218
    v_accvgpr_write_b32 a128, v220
    v_accvgpr_write_b32 a129, v221
    v_accvgpr_write_b32 a130, v222
    v_accvgpr_write_b32 a131, v223
    v_accvgpr_read_b32 v220, a132
    v_accvgpr_read_b32 v221, a133
    v_accvgpr_read_b32 v222, a134
    v_accvgpr_read_b32 v223, a135
    v_mul_f32 v220, v220, v218
    v_mul_f32 v221, v221, v218
    v_mul_f32 v222, v222, v218
    v_mul_f32 v223, v223, v218
    v_accvgpr_write_b32 a132, v220
    v_accvgpr_write_b32 a133, v221
    v_accvgpr_write_b32 a134, v222
    v_accvgpr_write_b32 a135, v223
    v_accvgpr_read_b32 v220, a136
    v_accvgpr_read_b32 v221, a137
    v_accvgpr_read_b32 v222, a138
    v_accvgpr_read_b32 v223, a139
    v_mul_f32 v220, v220, v218
    v_mul_f32 v221, v221, v218
    v_mul_f32 v222, v222, v218
    v_mul_f32 v223, v223, v218
    v_accvgpr_write_b32 a136, v220
    v_accvgpr_write_b32 a137, v221
    v_accvgpr_write_b32 a138, v222
    v_accvgpr_write_b32 a139, v223
    v_accvgpr_read_b32 v220, a140
    v_accvgpr_read_b32 v221, a141
    v_accvgpr_read_b32 v222, a142
    v_accvgpr_read_b32 v223, a143
    v_mul_f32 v220, v220, v218
    v_mul_f32 v221, v221, v218
    v_mul_f32 v222, v222, v218
    v_mul_f32 v223, v223, v218
    v_accvgpr_write_b32 a140, v220
    v_accvgpr_write_b32 a141, v221
    v_accvgpr_write_b32 a142, v222
    v_accvgpr_write_b32 a143, v223
    v_accvgpr_read_b32 v220, a144
    v_accvgpr_read_b32 v221, a145
    v_accvgpr_read_b32 v222, a146
    v_accvgpr_read_b32 v223, a147
    v_mul_f32 v220, v220, v218
    v_mul_f32 v221, v221, v218
    v_mul_f32 v222, v222, v218
    v_mul_f32 v223, v223, v218
    v_accvgpr_write_b32 a144, v220
    v_accvgpr_write_b32 a145, v221
    v_accvgpr_write_b32 a146, v222
    v_accvgpr_write_b32 a147, v223
    v_accvgpr_read_b32 v220, a148
    v_accvgpr_read_b32 v221, a149
    v_accvgpr_read_b32 v222, a150
    v_accvgpr_read_b32 v223, a151
    v_mul_f32 v220, v220, v218
    v_mul_f32 v221, v221, v218
    v_mul_f32 v222, v222, v218
    v_mul_f32 v223, v223, v218
    v_accvgpr_write_b32 a148, v220
    v_accvgpr_write_b32 a149, v221
    v_accvgpr_write_b32 a150, v222
    v_accvgpr_write_b32 a151, v223
    v_accvgpr_read_b32 v220, a152
    v_accvgpr_read_b32 v221, a153
    v_accvgpr_read_b32 v222, a154
    v_accvgpr_read_b32 v223, a155
    v_mul_f32 v220, v220, v218
    v_mul_f32 v221, v221, v218
    v_mul_f32 v222, v222, v218
    v_mul_f32 v223, v223, v218
    v_accvgpr_write_b32 a152, v220
    v_accvgpr_write_b32 a153, v221
    v_accvgpr_write_b32 a154, v222
    v_accvgpr_write_b32 a155, v223
    v_accvgpr_read_b32 v220, a156
    v_accvgpr_read_b32 v221, a157
    v_accvgpr_read_b32 v222, a158
    v_accvgpr_read_b32 v223, a159
    v_mul_f32 v220, v220, v218
    v_mul_f32 v221, v221, v218
    v_mul_f32 v222, v222, v218
    v_mul_f32 v223, v223, v218
    v_accvgpr_write_b32 a156, v220
    v_accvgpr_write_b32 a157, v221
    v_accvgpr_write_b32 a158, v222
    v_accvgpr_write_b32 a159, v223
    v_accvgpr_read_b32 v220, a160
    v_accvgpr_read_b32 v221, a161
    v_accvgpr_read_b32 v222, a162
    v_accvgpr_read_b32 v223, a163
    v_mul_f32 v220, v220, v218
    v_mul_f32 v221, v221, v218
    v_mul_f32 v222, v222, v218
    v_mul_f32 v223, v223, v218
    v_accvgpr_write_b32 a160, v220
    v_accvgpr_write_b32 a161, v221
    v_accvgpr_write_b32 a162, v222
    v_accvgpr_write_b32 a163, v223
    v_accvgpr_read_b32 v220, a164
    v_accvgpr_read_b32 v221, a165
    v_accvgpr_read_b32 v222, a166
    v_accvgpr_read_b32 v223, a167
    v_mul_f32 v220, v220, v218
    v_mul_f32 v221, v221, v218
    v_mul_f32 v222, v222, v218
    v_mul_f32 v223, v223, v218
    v_accvgpr_write_b32 a164, v220
    v_accvgpr_write_b32 a165, v221
    v_accvgpr_write_b32 a166, v222
    v_accvgpr_write_b32 a167, v223
    v_accvgpr_read_b32 v220, a168
    v_accvgpr_read_b32 v221, a169
    v_accvgpr_read_b32 v222, a170
    v_accvgpr_read_b32 v223, a171
    v_mul_f32 v220, v220, v218
    v_mul_f32 v221, v221, v218
    v_mul_f32 v222, v222, v218
    v_mul_f32 v223, v223, v218
    v_accvgpr_write_b32 a168, v220
    v_accvgpr_write_b32 a169, v221
    v_accvgpr_write_b32 a170, v222
    v_accvgpr_write_b32 a171, v223
    v_accvgpr_read_b32 v220, a172
    v_accvgpr_read_b32 v221, a173
    v_accvgpr_read_b32 v222, a174
    v_accvgpr_read_b32 v223, a175
    v_mul_f32 v220, v220, v218
    v_mul_f32 v221, v221, v218
    v_mul_f32 v222, v222, v218
    v_mul_f32 v223, v223, v218
    v_accvgpr_write_b32 a172, v220
    v_accvgpr_write_b32 a173, v221
    v_accvgpr_write_b32 a174, v222
    v_accvgpr_write_b32 a175, v223
    v_accvgpr_read_b32 v220, a176
    v_accvgpr_read_b32 v221, a177
    v_accvgpr_read_b32 v222, a178
    v_accvgpr_read_b32 v223, a179
    v_mul_f32 v220, v220, v218
    v_mul_f32 v221, v221, v218
    v_mul_f32 v222, v222, v218
    v_mul_f32 v223, v223, v218
    v_accvgpr_write_b32 a176, v220
    v_accvgpr_write_b32 a177, v221
    v_accvgpr_write_b32 a178, v222
    v_accvgpr_write_b32 a179, v223
    v_accvgpr_read_b32 v220, a180
    v_accvgpr_read_b32 v221, a181
    v_accvgpr_read_b32 v222, a182
    v_accvgpr_read_b32 v223, a183
    v_mul_f32 v220, v220, v218
    v_mul_f32 v221, v221, v218
    v_mul_f32 v222, v222, v218
    v_mul_f32 v223, v223, v218
    v_accvgpr_write_b32 a180, v220
    v_accvgpr_write_b32 a181, v221
    v_accvgpr_write_b32 a182, v222
    v_accvgpr_write_b32 a183, v223
    v_accvgpr_read_b32 v220, a184
    v_accvgpr_read_b32 v221, a185
    v_accvgpr_read_b32 v222, a186
    v_accvgpr_read_b32 v223, a187
    v_mul_f32 v220, v220, v218
    v_mul_f32 v221, v221, v218
    v_mul_f32 v222, v222, v218
    v_mul_f32 v223, v223, v218
    v_accvgpr_write_b32 a184, v220
    v_accvgpr_write_b32 a185, v221
    v_accvgpr_write_b32 a186, v222
    v_accvgpr_write_b32 a187, v223
    v_accvgpr_read_b32 v220, a188
    v_accvgpr_read_b32 v221, a189
    v_accvgpr_read_b32 v222, a190
    v_accvgpr_read_b32 v223, a191
    v_mul_f32 v220, v220, v218
    v_mul_f32 v221, v221, v218
    v_mul_f32 v222, v222, v218
    v_mul_f32 v223, v223, v218
    v_accvgpr_write_b32 a188, v220
    v_accvgpr_write_b32 a189, v221
    v_accvgpr_write_b32 a190, v222
    v_accvgpr_write_b32 a191, v223
    v_exp_f32 v192, v32
    s_nop 0
    v_exp_f32 v193, v33
    s_nop 0
    v_exp_f32 v194, v34
    s_nop 0
    v_exp_f32 v195, v35
    s_nop 0
    v_add_f32 v214, v192, v193
    s_nop 0
    v_cvt_pk_bf16_f32 v80, v192, v193
    s_nop 0
    v_exp_f32 v196, v36
    s_nop 0
    v_add_f32 v214, v214, v194
    s_nop 0
    v_exp_f32 v197, v37
    s_nop 0
    v_add_f32 v214, v214, v195
    s_nop 0
    v_cvt_pk_bf16_f32 v81, v194, v195
    s_nop 0
    v_exp_f32 v192, v38
    s_nop 0
    v_add_f32 v214, v214, v196
    s_nop 0
    v_exp_f32 v193, v39
    s_nop 0
    v_add_f32 v214, v214, v197
    s_nop 0
    v_cvt_pk_bf16_f32 v82, v196, v197
    s_nop 0
    v_exp_f32 v194, v40
    s_nop 0
    v_add_f32 v214, v214, v192
    s_nop 0
    v_exp_f32 v195, v41
    s_nop 0
    v_add_f32 v214, v214, v193
    s_nop 0
    v_cvt_pk_bf16_f32 v83, v192, v193
    s_nop 0
    v_exp_f32 v196, v42
    s_nop 0
    v_add_f32 v214, v214, v194
    s_nop 0
    v_exp_f32 v197, v43
    s_nop 0
    v_add_f32 v214, v214, v195
    s_nop 0
    v_cvt_pk_bf16_f32 v84, v194, v195
    s_nop 0
    v_exp_f32 v192, v44
    s_nop 0
    v_add_f32 v214, v214, v196
    s_nop 0
    v_exp_f32 v193, v45
    s_nop 0
    v_add_f32 v214, v214, v197
    s_nop 0
    v_cvt_pk_bf16_f32 v85, v196, v197
    s_nop 0
    v_exp_f32 v194, v46
    s_nop 0
    v_add_f32 v214, v214, v192
    s_nop 0
    v_exp_f32 v195, v47
    s_nop 0
    v_add_f32 v214, v214, v193
    s_nop 0
    v_cvt_pk_bf16_f32 v86, v192, v193
    s_nop 0
    v_exp_f32 v196, v48
    s_nop 0
    v_add_f32 v214, v214, v194
    s_nop 0
    v_exp_f32 v197, v49
    s_nop 0
    v_add_f32 v214, v214, v195
    s_nop 0
    v_cvt_pk_bf16_f32 v87, v194, v195
    s_nop 0
    v_exp_f32 v192, v50
    s_nop 0
    v_exp_f32 v193, v51
    s_nop 0
    v_add_f32 v215, v196, v197
    s_nop 0
    v_cvt_pk_bf16_f32 v88, v196, v197
    s_nop 0
    v_exp_f32 v194, v52
    s_nop 0
    v_add_f32 v215, v215, v192
    s_nop 0
    v_exp_f32 v195, v53
    s_nop 0
    v_add_f32 v215, v215, v193
    s_nop 0
    v_cvt_pk_bf16_f32 v89, v192, v193
    s_nop 0
    v_exp_f32 v196, v54
    s_nop 0
    v_add_f32 v215, v215, v194
    s_nop 0
    v_exp_f32 v197, v55
    s_nop 0
    v_add_f32 v215, v215, v195
    s_nop 0
    v_cvt_pk_bf16_f32 v90, v194, v195
    s_nop 0
    v_exp_f32 v192, v56
    s_nop 0
    v_add_f32 v215, v215, v196
    s_nop 0
    v_exp_f32 v193, v57
    s_nop 0
    v_add_f32 v215, v215, v197
    s_nop 0
    v_cvt_pk_bf16_f32 v91, v196, v197
    s_nop 0
    v_exp_f32 v194, v58
    s_nop 0
    v_add_f32 v215, v215, v192
    s_nop 0
    v_exp_f32 v195, v59
    s_nop 0
    v_add_f32 v215, v215, v193
    s_nop 0
    v_cvt_pk_bf16_f32 v92, v192, v193
    s_nop 0
    v_exp_f32 v196, v60
    s_nop 0
    v_add_f32 v215, v215, v194
    s_nop 0
    v_exp_f32 v197, v61
    s_nop 0
    v_add_f32 v215, v215, v195
    s_nop 0
    v_cvt_pk_bf16_f32 v93, v194, v195
    s_nop 0
    v_exp_f32 v192, v62
    s_nop 0
    v_add_f32 v215, v215, v196
    s_nop 0
    v_exp_f32 v193, v63
    s_nop 0
    v_add_f32 v215, v215, v197
    s_nop 0
    v_cvt_pk_bf16_f32 v94, v196, v197
    s_nop 0
    v_add_f32 v215, v215, v192
    s_nop 0
    v_add_f32 v215, v215, v193
    s_nop 0
    v_cvt_pk_bf16_f32 v95, v192, v193
    s_nop 0
    s_nop 3
    s_branch F_retL1
F_slowL2:
    s_nop 15
    s_nop 15
    v_max3_f32 v216, v0, v1, v2
    v_max3_f32 v216, v216, v3, v4
    v_max3_f32 v216, v216, v5, v6
    v_max3_f32 v216, v216, v7, v8
    v_max3_f32 v216, v216, v9, v10
    v_max3_f32 v216, v216, v11, v12
    v_max3_f32 v216, v216, v13, v14
    v_max_f32 v216, v216, v15
    v_mov_b32 v217, v216
    s_nop 1
    v_permlane32_swap_b32 v216, v217
    s_nop 1
    v_max_f32 v216, v216, v217
    v_max_f32 v216, 0, v216
    v_sub_f32 v217, 0, v216
    v_exp_f32 v218, v217
    v_sub_f32 v96, v96, v216
    v_sub_f32 v0, v0, v216
    v_sub_f32 v32, v32, v216
    v_sub_f32 v97, v97, v216
    v_sub_f32 v1, v1, v216
    v_sub_f32 v33, v33, v216
    v_sub_f32 v98, v98, v216
    v_sub_f32 v2, v2, v216
    v_sub_f32 v34, v34, v216
    v_sub_f32 v99, v99, v216
    v_sub_f32 v3, v3, v216
    v_sub_f32 v35, v35, v216
    v_sub_f32 v100, v100, v216
    v_sub_f32 v4, v4, v216
    v_sub_f32 v36, v36, v216
    v_sub_f32 v101, v101, v216
    v_sub_f32 v5, v5, v216
    v_sub_f32 v37, v37, v216
    v_sub_f32 v102, v102, v216
    v_sub_f32 v6, v6, v216
    v_sub_f32 v38, v38, v216
    v_sub_f32 v103, v103, v216
    v_sub_f32 v7, v7, v216
    v_sub_f32 v39, v39, v216
    v_sub_f32 v104, v104, v216
    v_sub_f32 v8, v8, v216
    v_sub_f32 v40, v40, v216
    v_sub_f32 v105, v105, v216
    v_sub_f32 v9, v9, v216
    v_sub_f32 v41, v41, v216
    v_sub_f32 v106, v106, v216
    v_sub_f32 v10, v10, v216
    v_sub_f32 v42, v42, v216
    v_sub_f32 v107, v107, v216
    v_sub_f32 v11, v11, v216
    v_sub_f32 v43, v43, v216
    v_sub_f32 v108, v108, v216
    v_sub_f32 v12, v12, v216
    v_sub_f32 v44, v44, v216
    v_sub_f32 v109, v109, v216
    v_sub_f32 v13, v13, v216
    v_sub_f32 v45, v45, v216
    v_sub_f32 v110, v110, v216
    v_sub_f32 v14, v14, v216
    v_sub_f32 v46, v46, v216
    v_sub_f32 v111, v111, v216
    v_sub_f32 v15, v15, v216
    v_sub_f32 v47, v47, v216
    v_mul_f32 v212, v212, v218
    v_accvgpr_read_b32 v220, a0
    v_accvgpr_read_b32 v221, a1
    v_accvgpr_read_b32 v222, a2
    v_accvgpr_read_b32 v223, a3
    v_mul_f32 v220, v220, v218
    v_mul_f32 v221, v221, v218
    v_mul_f32 v222, v222, v218
    v_mul_f32 v223, v223, v218
    v_accvgpr_write_b32 a0, v220
    v_accvgpr_write_b32 a1, v221
    v_accvgpr_write_b32 a2, v222
    v_accvgpr_write_b32 a3, v223
    v_accvgpr_read_b32 v220, a4
    v_accvgpr_read_b32 v221, a5
    v_accvgpr_read_b32 v222, a6
    v_accvgpr_read_b32 v223, a7
    v_mul_f32 v220, v220, v218
    v_mul_f32 v221, v221, v218
    v_mul_f32 v222, v222, v218
    v_mul_f32 v223, v223, v218
    v_accvgpr_write_b32 a4, v220
    v_accvgpr_write_b32 a5, v221
    v_accvgpr_write_b32 a6, v222
    v_accvgpr_write_b32 a7, v223
    v_accvgpr_read_b32 v220, a8
    v_accvgpr_read_b32 v221, a9
    v_accvgpr_read_b32 v222, a10
    v_accvgpr_read_b32 v223, a11
    v_mul_f32 v220, v220, v218
    v_mul_f32 v221, v221, v218
    v_mul_f32 v222, v222, v218
    v_mul_f32 v223, v223, v218
    v_accvgpr_write_b32 a8, v220
    v_accvgpr_write_b32 a9, v221
    v_accvgpr_write_b32 a10, v222
    v_accvgpr_write_b32 a11, v223
    v_accvgpr_read_b32 v220, a12
    v_accvgpr_read_b32 v221, a13
    v_accvgpr_read_b32 v222, a14
    v_accvgpr_read_b32 v223, a15
    v_mul_f32 v220, v220, v218
    v_mul_f32 v221, v221, v218
    v_mul_f32 v222, v222, v218
    v_mul_f32 v223, v223, v218
    v_accvgpr_write_b32 a12, v220
    v_accvgpr_write_b32 a13, v221
    v_accvgpr_write_b32 a14, v222
    v_accvgpr_write_b32 a15, v223
    v_accvgpr_read_b32 v220, a16
    v_accvgpr_read_b32 v221, a17
    v_accvgpr_read_b32 v222, a18
    v_accvgpr_read_b32 v223, a19
    v_mul_f32 v220, v220, v218
    v_mul_f32 v221, v221, v218
    v_mul_f32 v222, v222, v218
    v_mul_f32 v223, v223, v218
    v_accvgpr_write_b32 a16, v220
    v_accvgpr_write_b32 a17, v221
    v_accvgpr_write_b32 a18, v222
    v_accvgpr_write_b32 a19, v223
    v_accvgpr_read_b32 v220, a20
    v_accvgpr_read_b32 v221, a21
    v_accvgpr_read_b32 v222, a22
    v_accvgpr_read_b32 v223, a23
    v_mul_f32 v220, v220, v218
    v_mul_f32 v221, v221, v218
    v_mul_f32 v222, v222, v218
    v_mul_f32 v223, v223, v218
    v_accvgpr_write_b32 a20, v220
    v_accvgpr_write_b32 a21, v221
    v_accvgpr_write_b32 a22, v222
    v_accvgpr_write_b32 a23, v223
    v_accvgpr_read_b32 v220, a24
    v_accvgpr_read_b32 v221, a25
    v_accvgpr_read_b32 v222, a26
    v_accvgpr_read_b32 v223, a27
    v_mul_f32 v220, v220, v218
    v_mul_f32 v221, v221, v218
    v_mul_f32 v222, v222, v218
    v_mul_f32 v223, v223, v218
    v_accvgpr_write_b32 a24, v220
    v_accvgpr_write_b32 a25, v221
    v_accvgpr_write_b32 a26, v222
    v_accvgpr_write_b32 a27, v223
    v_accvgpr_read_b32 v220, a28
    v_accvgpr_read_b32 v221, a29
    v_accvgpr_read_b32 v222, a30
    v_accvgpr_read_b32 v223, a31
    v_mul_f32 v220, v220, v218
    v_mul_f32 v221, v221, v218
    v_mul_f32 v222, v222, v218
    v_mul_f32 v223, v223, v218
    v_accvgpr_write_b32 a28, v220
    v_accvgpr_write_b32 a29, v221
    v_accvgpr_write_b32 a30, v222
    v_accvgpr_write_b32 a31, v223
    v_accvgpr_read_b32 v220, a32
    v_accvgpr_read_b32 v221, a33
    v_accvgpr_read_b32 v222, a34
    v_accvgpr_read_b32 v223, a35
    v_mul_f32 v220, v220, v218
    v_mul_f32 v221, v221, v218
    v_mul_f32 v222, v222, v218
    v_mul_f32 v223, v223, v218
    v_accvgpr_write_b32 a32, v220
    v_accvgpr_write_b32 a33, v221
    v_accvgpr_write_b32 a34, v222
    v_accvgpr_write_b32 a35, v223
    v_accvgpr_read_b32 v220, a36
    v_accvgpr_read_b32 v221, a37
    v_accvgpr_read_b32 v222, a38
    v_accvgpr_read_b32 v223, a39
    v_mul_f32 v220, v220, v218
    v_mul_f32 v221, v221, v218
    v_mul_f32 v222, v222, v218
    v_mul_f32 v223, v223, v218
    v_accvgpr_write_b32 a36, v220
    v_accvgpr_write_b32 a37, v221
    v_accvgpr_write_b32 a38, v222
    v_accvgpr_write_b32 a39, v223
    v_accvgpr_read_b32 v220, a40
    v_accvgpr_read_b32 v221, a41
    v_accvgpr_read_b32 v222, a42
    v_accvgpr_read_b32 v223, a43
    v_mul_f32 v220, v220, v218
    v_mul_f32 v221, v221, v218
    v_mul_f32 v222, v222, v218
    v_mul_f32 v223, v223, v218
    v_accvgpr_write_b32 a40, v220
    v_accvgpr_write_b32 a41, v221
    v_accvgpr_write_b32 a42, v222
    v_accvgpr_write_b32 a43, v223
    v_accvgpr_read_b32 v220, a44
    v_accvgpr_read_b32 v221, a45
    v_accvgpr_read_b32 v222, a46
    v_accvgpr_read_b32 v223, a47
    v_mul_f32 v220, v220, v218
    v_mul_f32 v221, v221, v218
    v_mul_f32 v222, v222, v218
    v_mul_f32 v223, v223, v218
    v_accvgpr_write_b32 a44, v220
    v_accvgpr_write_b32 a45, v221
    v_accvgpr_write_b32 a46, v222
    v_accvgpr_write_b32 a47, v223
    v_accvgpr_read_b32 v220, a48
    v_accvgpr_read_b32 v221, a49
    v_accvgpr_read_b32 v222, a50
    v_accvgpr_read_b32 v223, a51
    v_mul_f32 v220, v220, v218
    v_mul_f32 v221, v221, v218
    v_mul_f32 v222, v222, v218
    v_mul_f32 v223, v223, v218
    v_accvgpr_write_b32 a48, v220
    v_accvgpr_write_b32 a49, v221
    v_accvgpr_write_b32 a50, v222
    v_accvgpr_write_b32 a51, v223
    v_accvgpr_read_b32 v220, a52
    v_accvgpr_read_b32 v221, a53
    v_accvgpr_read_b32 v222, a54
    v_accvgpr_read_b32 v223, a55
    v_mul_f32 v220, v220, v218
    v_mul_f32 v221, v221, v218
    v_mul_f32 v222, v222, v218
    v_mul_f32 v223, v223, v218
    v_accvgpr_write_b32 a52, v220
    v_accvgpr_write_b32 a53, v221
    v_accvgpr_write_b32 a54, v222
    v_accvgpr_write_b32 a55, v223
    v_accvgpr_read_b32 v220, a56
    v_accvgpr_read_b32 v221, a57
    v_accvgpr_read_b32 v222, a58
    v_accvgpr_read_b32 v223, a59
    v_mul_f32 v220, v220, v218
    v_mul_f32 v221, v221, v218
    v_mul_f32 v222, v222, v218
    v_mul_f32 v223, v223, v218
    v_accvgpr_write_b32 a56, v220
    v_accvgpr_write_b32 a57, v221
    v_accvgpr_write_b32 a58, v222
    v_accvgpr_write_b32 a59, v223
    v_accvgpr_read_b32 v220, a60
    v_accvgpr_read_b32 v221, a61
    v_accvgpr_read_b32 v222, a62
    v_accvgpr_read_b32 v223, a63
    v_mul_f32 v220, v220, v218
    v_mul_f32 v221, v221, v218
    v_mul_f32 v222, v222, v218
    v_mul_f32 v223, v223, v218
    v_accvgpr_write_b32 a60, v220
    v_accvgpr_write_b32 a61, v221
    v_accvgpr_write_b32 a62, v222
    v_accvgpr_write_b32 a63, v223
    v_accvgpr_read_b32 v220, a64
    v_accvgpr_read_b32 v221, a65
    v_accvgpr_read_b32 v222, a66
    v_accvgpr_read_b32 v223, a67
    v_mul_f32 v220, v220, v218
    v_mul_f32 v221, v221, v218
    v_mul_f32 v222, v222, v218
    v_mul_f32 v223, v223, v218
    v_accvgpr_write_b32 a64, v220
    v_accvgpr_write_b32 a65, v221
    v_accvgpr_write_b32 a66, v222
    v_accvgpr_write_b32 a67, v223
    v_accvgpr_read_b32 v220, a68
    v_accvgpr_read_b32 v221, a69
    v_accvgpr_read_b32 v222, a70
    v_accvgpr_read_b32 v223, a71
    v_mul_f32 v220, v220, v218
    v_mul_f32 v221, v221, v218
    v_mul_f32 v222, v222, v218
    v_mul_f32 v223, v223, v218
    v_accvgpr_write_b32 a68, v220
    v_accvgpr_write_b32 a69, v221
    v_accvgpr_write_b32 a70, v222
    v_accvgpr_write_b32 a71, v223
    v_accvgpr_read_b32 v220, a72
    v_accvgpr_read_b32 v221, a73
    v_accvgpr_read_b32 v222, a74
    v_accvgpr_read_b32 v223, a75
    v_mul_f32 v220, v220, v218
    v_mul_f32 v221, v221, v218
    v_mul_f32 v222, v222, v218
    v_mul_f32 v223, v223, v218
    v_accvgpr_write_b32 a72, v220
    v_accvgpr_write_b32 a73, v221
    v_accvgpr_write_b32 a74, v222
    v_accvgpr_write_b32 a75, v223
    v_accvgpr_read_b32 v220, a76
    v_accvgpr_read_b32 v221, a77
    v_accvgpr_read_b32 v222, a78
    v_accvgpr_read_b32 v223, a79
    v_mul_f32 v220, v220, v218
    v_mul_f32 v221, v221, v218
    v_mul_f32 v222, v222, v218
    v_mul_f32 v223, v223, v218
    v_accvgpr_write_b32 a76, v220
    v_accvgpr_write_b32 a77, v221
    v_accvgpr_write_b32 a78, v222
    v_accvgpr_write_b32 a79, v223
    v_accvgpr_read_b32 v220, a80
    v_accvgpr_read_b32 v221, a81
    v_accvgpr_read_b32 v222, a82
    v_accvgpr_read_b32 v223, a83
    v_mul_f32 v220, v220, v218
    v_mul_f32 v221, v221, v218
    v_mul_f32 v222, v222, v218
    v_mul_f32 v223, v223, v218
    v_accvgpr_write_b32 a80, v220
    v_accvgpr_write_b32 a81, v221
    v_accvgpr_write_b32 a82, v222
    v_accvgpr_write_b32 a83, v223
    v_accvgpr_read_b32 v220, a84
    v_accvgpr_read_b32 v221, a85
    v_accvgpr_read_b32 v222, a86
    v_accvgpr_read_b32 v223, a87
    v_mul_f32 v220, v220, v218
    v_mul_f32 v221, v221, v218
    v_mul_f32 v222, v222, v218
    v_mul_f32 v223, v223, v218
    v_accvgpr_write_b32 a84, v220
    v_accvgpr_write_b32 a85, v221
    v_accvgpr_write_b32 a86, v222
    v_accvgpr_write_b32 a87, v223
    v_accvgpr_read_b32 v220, a88
    v_accvgpr_read_b32 v221, a89
    v_accvgpr_read_b32 v222, a90
    v_accvgpr_read_b32 v223, a91
    v_mul_f32 v220, v220, v218
    v_mul_f32 v221, v221, v218
    v_mul_f32 v222, v222, v218
    v_mul_f32 v223, v223, v218
    v_accvgpr_write_b32 a88, v220
    v_accvgpr_write_b32 a89, v221
    v_accvgpr_write_b32 a90, v222
    v_accvgpr_write_b32 a91, v223
    v_accvgpr_read_b32 v220, a92
    v_accvgpr_read_b32 v221, a93
    v_accvgpr_read_b32 v222, a94
    v_accvgpr_read_b32 v223, a95
    v_mul_f32 v220, v220, v218
    v_mul_f32 v221, v221, v218
    v_mul_f32 v222, v222, v218
    v_mul_f32 v223, v223, v218
    v_accvgpr_write_b32 a92, v220
    v_accvgpr_write_b32 a93, v221
    v_accvgpr_write_b32 a94, v222
    v_accvgpr_write_b32 a95, v223
    v_max3_f32 v216, v16, v17, v18
    v_max3_f32 v216, v216, v19, v20
    v_max3_f32 v216, v216, v21, v22
    v_max3_f32 v216, v216, v23, v24
    v_max3_f32 v216, v216, v25, v26
    v_max3_f32 v216, v216, v27, v28
    v_max3_f32 v216, v216, v29, v30
    v_max_f32 v216, v216, v31
    v_mov_b32 v217, v216
    s_nop 1
    v_permlane32_swap_b32 v216, v217
    s_nop 1
    v_max_f32 v216, v216, v217
    v_max_f32 v216, 0, v216
    v_sub_f32 v217, 0, v216
    v_exp_f32 v218, v217
    v_sub_f32 v112, v112, v216
    v_sub_f32 v16, v16, v216
    v_sub_f32 v48, v48, v216
    v_sub_f32 v113, v113, v216
    v_sub_f32 v17, v17, v216
    v_sub_f32 v49, v49, v216
    v_sub_f32 v114, v114, v216
    v_sub_f32 v18, v18, v216
    v_sub_f32 v50, v50, v216
    v_sub_f32 v115, v115, v216
    v_sub_f32 v19, v19, v216
    v_sub_f32 v51, v51, v216
    v_sub_f32 v116, v116, v216
    v_sub_f32 v20, v20, v216
    v_sub_f32 v52, v52, v216
    v_sub_f32 v117, v117, v216
    v_sub_f32 v21, v21, v216
    v_sub_f32 v53, v53, v216
    v_sub_f32 v118, v118, v216
    v_sub_f32 v22, v22, v216
    v_sub_f32 v54, v54, v216
    v_sub_f32 v119, v119, v216
    v_sub_f32 v23, v23, v216
    v_sub_f32 v55, v55, v216
    v_sub_f32 v120, v120, v216
    v_sub_f32 v24, v24, v216
    v_sub_f32 v56, v56, v216
    v_sub_f32 v121, v121, v216
    v_sub_f32 v25, v25, v216
    v_sub_f32 v57, v57, v216
    v_sub_f32 v122, v122, v216
    v_sub_f32 v26, v26, v216
    v_sub_f32 v58, v58, v216
    v_sub_f32 v123, v123, v216
    v_sub_f32 v27, v27, v216
    v_sub_f32 v59, v59, v216
    v_sub_f32 v124, v124, v216
    v_sub_f32 v28, v28, v216
    v_sub_f32 v60, v60, v216
    v_sub_f32 v125, v125, v216
    v_sub_f32 v29, v29, v216
    v_sub_f32 v61, v61, v216
    v_sub_f32 v126, v126, v216
    v_sub_f32 v30, v30, v216
    v_sub_f32 v62, v62, v216
    v_sub_f32 v127, v127, v216
    v_sub_f32 v31, v31, v216
    v_sub_f32 v63, v63, v216
    v_mul_f32 v213, v213, v218
    v_accvgpr_read_b32 v220, a96
    v_accvgpr_read_b32 v221, a97
    v_accvgpr_read_b32 v222, a98
    v_accvgpr_read_b32 v223, a99
    v_mul_f32 v220, v220, v218
    v_mul_f32 v221, v221, v218
    v_mul_f32 v222, v222, v218
    v_mul_f32 v223, v223, v218
    v_accvgpr_write_b32 a96, v220
    v_accvgpr_write_b32 a97, v221
    v_accvgpr_write_b32 a98, v222
    v_accvgpr_write_b32 a99, v223
    v_accvgpr_read_b32 v220, a100
    v_accvgpr_read_b32 v221, a101
    v_accvgpr_read_b32 v222, a102
    v_accvgpr_read_b32 v223, a103
    v_mul_f32 v220, v220, v218
    v_mul_f32 v221, v221, v218
    v_mul_f32 v222, v222, v218
    v_mul_f32 v223, v223, v218
    v_accvgpr_write_b32 a100, v220
    v_accvgpr_write_b32 a101, v221
    v_accvgpr_write_b32 a102, v222
    v_accvgpr_write_b32 a103, v223
    v_accvgpr_read_b32 v220, a104
    v_accvgpr_read_b32 v221, a105
    v_accvgpr_read_b32 v222, a106
    v_accvgpr_read_b32 v223, a107
    v_mul_f32 v220, v220, v218
    v_mul_f32 v221, v221, v218
    v_mul_f32 v222, v222, v218
    v_mul_f32 v223, v223, v218
    v_accvgpr_write_b32 a104, v220
    v_accvgpr_write_b32 a105, v221
    v_accvgpr_write_b32 a106, v222
    v_accvgpr_write_b32 a107, v223
    v_accvgpr_read_b32 v220, a108
    v_accvgpr_read_b32 v221, a109
    v_accvgpr_read_b32 v222, a110
    v_accvgpr_read_b32 v223, a111
    v_mul_f32 v220, v220, v218
    v_mul_f32 v221, v221, v218
    v_mul_f32 v222, v222, v218
    v_mul_f32 v223, v223, v218
    v_accvgpr_write_b32 a108, v220
    v_accvgpr_write_b32 a109, v221
    v_accvgpr_write_b32 a110, v222
    v_accvgpr_write_b32 a111, v223
    v_accvgpr_read_b32 v220, a112
    v_accvgpr_read_b32 v221, a113
    v_accvgpr_read_b32 v222, a114
    v_accvgpr_read_b32 v223, a115
    v_mul_f32 v220, v220, v218
    v_mul_f32 v221, v221, v218
    v_mul_f32 v222, v222, v218
    v_mul_f32 v223, v223, v218
    v_accvgpr_write_b32 a112, v220
    v_accvgpr_write_b32 a113, v221
    v_accvgpr_write_b32 a114, v222
    v_accvgpr_write_b32 a115, v223
    v_accvgpr_read_b32 v220, a116
    v_accvgpr_read_b32 v221, a117
    v_accvgpr_read_b32 v222, a118
    v_accvgpr_read_b32 v223, a119
    v_mul_f32 v220, v220, v218
    v_mul_f32 v221, v221, v218
    v_mul_f32 v222, v222, v218
    v_mul_f32 v223, v223, v218
    v_accvgpr_write_b32 a116, v220
    v_accvgpr_write_b32 a117, v221
    v_accvgpr_write_b32 a118, v222
    v_accvgpr_write_b32 a119, v223
    v_accvgpr_read_b32 v220, a120
    v_accvgpr_read_b32 v221, a121
    v_accvgpr_read_b32 v222, a122
    v_accvgpr_read_b32 v223, a123
    v_mul_f32 v220, v220, v218
    v_mul_f32 v221, v221, v218
    v_mul_f32 v222, v222, v218
    v_mul_f32 v223, v223, v218
    v_accvgpr_write_b32 a120, v220
    v_accvgpr_write_b32 a121, v221
    v_accvgpr_write_b32 a122, v222
    v_accvgpr_write_b32 a123, v223
    v_accvgpr_read_b32 v220, a124
    v_accvgpr_read_b32 v221, a125
    v_accvgpr_read_b32 v222, a126
    v_accvgpr_read_b32 v223, a127
    v_mul_f32 v220, v220, v218
    v_mul_f32 v221, v221, v218
    v_mul_f32 v222, v222, v218
    v_mul_f32 v223, v223, v218
    v_accvgpr_write_b32 a124, v220
    v_accvgpr_write_b32 a125, v221
    v_accvgpr_write_b32 a126, v222
    v_accvgpr_write_b32 a127, v223
    v_accvgpr_read_b32 v220, a128
    v_accvgpr_read_b32 v221, a129
    v_accvgpr_read_b32 v222, a130
    v_accvgpr_read_b32 v223, a131
    v_mul_f32 v220, v220, v218
    v_mul_f32 v221, v221, v218
    v_mul_f32 v222, v222, v218
    v_mul_f32 v223, v223, v218
    v_accvgpr_write_b32 a128, v220
    v_accvgpr_write_b32 a129, v221
    v_accvgpr_write_b32 a130, v222
    v_accvgpr_write_b32 a131, v223
    v_accvgpr_read_b32 v220, a132
    v_accvgpr_read_b32 v221, a133
    v_accvgpr_read_b32 v222, a134
    v_accvgpr_read_b32 v223, a135
    v_mul_f32 v220, v220, v218
    v_mul_f32 v221, v221, v218
    v_mul_f32 v222, v222, v218
    v_mul_f32 v223, v223, v218
    v_accvgpr_write_b32 a132, v220
    v_accvgpr_write_b32 a133, v221
    v_accvgpr_write_b32 a134, v222
    v_accvgpr_write_b32 a135, v223
    v_accvgpr_read_b32 v220, a136
    v_accvgpr_read_b32 v221, a137
    v_accvgpr_read_b32 v222, a138
    v_accvgpr_read_b32 v223, a139
    v_mul_f32 v220, v220, v218
    v_mul_f32 v221, v221, v218
    v_mul_f32 v222, v222, v218
    v_mul_f32 v223, v223, v218
    v_accvgpr_write_b32 a136, v220
    v_accvgpr_write_b32 a137, v221
    v_accvgpr_write_b32 a138, v222
    v_accvgpr_write_b32 a139, v223
    v_accvgpr_read_b32 v220, a140
    v_accvgpr_read_b32 v221, a141
    v_accvgpr_read_b32 v222, a142
    v_accvgpr_read_b32 v223, a143
    v_mul_f32 v220, v220, v218
    v_mul_f32 v221, v221, v218
    v_mul_f32 v222, v222, v218
    v_mul_f32 v223, v223, v218
    v_accvgpr_write_b32 a140, v220
    v_accvgpr_write_b32 a141, v221
    v_accvgpr_write_b32 a142, v222
    v_accvgpr_write_b32 a143, v223
    v_accvgpr_read_b32 v220, a144
    v_accvgpr_read_b32 v221, a145
    v_accvgpr_read_b32 v222, a146
    v_accvgpr_read_b32 v223, a147
    v_mul_f32 v220, v220, v218
    v_mul_f32 v221, v221, v218
    v_mul_f32 v222, v222, v218
    v_mul_f32 v223, v223, v218
    v_accvgpr_write_b32 a144, v220
    v_accvgpr_write_b32 a145, v221
    v_accvgpr_write_b32 a146, v222
    v_accvgpr_write_b32 a147, v223
    v_accvgpr_read_b32 v220, a148
    v_accvgpr_read_b32 v221, a149
    v_accvgpr_read_b32 v222, a150
    v_accvgpr_read_b32 v223, a151
    v_mul_f32 v220, v220, v218
    v_mul_f32 v221, v221, v218
    v_mul_f32 v222, v222, v218
    v_mul_f32 v223, v223, v218
    v_accvgpr_write_b32 a148, v220
    v_accvgpr_write_b32 a149, v221
    v_accvgpr_write_b32 a150, v222
    v_accvgpr_write_b32 a151, v223
    v_accvgpr_read_b32 v220, a152
    v_accvgpr_read_b32 v221, a153
    v_accvgpr_read_b32 v222, a154
    v_accvgpr_read_b32 v223, a155
    v_mul_f32 v220, v220, v218
    v_mul_f32 v221, v221, v218
    v_mul_f32 v222, v222, v218
    v_mul_f32 v223, v223, v218
    v_accvgpr_write_b32 a152, v220
    v_accvgpr_write_b32 a153, v221
    v_accvgpr_write_b32 a154, v222
    v_accvgpr_write_b32 a155, v223
    v_accvgpr_read_b32 v220, a156
    v_accvgpr_read_b32 v221, a157
    v_accvgpr_read_b32 v222, a158
    v_accvgpr_read_b32 v223, a159
    v_mul_f32 v220, v220, v218
    v_mul_f32 v221, v221, v218
    v_mul_f32 v222, v222, v218
    v_mul_f32 v223, v223, v218
    v_accvgpr_write_b32 a156, v220
    v_accvgpr_write_b32 a157, v221
    v_accvgpr_write_b32 a158, v222
    v_accvgpr_write_b32 a159, v223
    v_accvgpr_read_b32 v220, a160
    v_accvgpr_read_b32 v221, a161
    v_accvgpr_read_b32 v222, a162
    v_accvgpr_read_b32 v223, a163
    v_mul_f32 v220, v220, v218
    v_mul_f32 v221, v221, v218
    v_mul_f32 v222, v222, v218
    v_mul_f32 v223, v223, v218
    v_accvgpr_write_b32 a160, v220
    v_accvgpr_write_b32 a161, v221
    v_accvgpr_write_b32 a162, v222
    v_accvgpr_write_b32 a163, v223
    v_accvgpr_read_b32 v220, a164
    v_accvgpr_read_b32 v221, a165
    v_accvgpr_read_b32 v222, a166
    v_accvgpr_read_b32 v223, a167
    v_mul_f32 v220, v220, v218
    v_mul_f32 v221, v221, v218
    v_mul_f32 v222, v222, v218
    v_mul_f32 v223, v223, v218
    v_accvgpr_write_b32 a164, v220
    v_accvgpr_write_b32 a165, v221
    v_accvgpr_write_b32 a166, v222
    v_accvgpr_write_b32 a167, v223
    v_accvgpr_read_b32 v220, a168
    v_accvgpr_read_b32 v221, a169
    v_accvgpr_read_b32 v222, a170
    v_accvgpr_read_b32 v223, a171
    v_mul_f32 v220, v220, v218
    v_mul_f32 v221, v221, v218
    v_mul_f32 v222, v222, v218
    v_mul_f32 v223, v223, v218
    v_accvgpr_write_b32 a168, v220
    v_accvgpr_write_b32 a169, v221
    v_accvgpr_write_b32 a170, v222
    v_accvgpr_write_b32 a171, v223
    v_accvgpr_read_b32 v220, a172
    v_accvgpr_read_b32 v221, a173
    v_accvgpr_read_b32 v222, a174
    v_accvgpr_read_b32 v223, a175
    v_mul_f32 v220, v220, v218
    v_mul_f32 v221, v221, v218
    v_mul_f32 v222, v222, v218
    v_mul_f32 v223, v223, v218
    v_accvgpr_write_b32 a172, v220
    v_accvgpr_write_b32 a173, v221
    v_accvgpr_write_b32 a174, v222
    v_accvgpr_write_b32 a175, v223
    v_accvgpr_read_b32 v220, a176
    v_accvgpr_read_b32 v221, a177
    v_accvgpr_read_b32 v222, a178
    v_accvgpr_read_b32 v223, a179
    v_mul_f32 v220, v220, v218
    v_mul_f32 v221, v221, v218
    v_mul_f32 v222, v222, v218
    v_mul_f32 v223, v223, v218
    v_accvgpr_write_b32 a176, v220
    v_accvgpr_write_b32 a177, v221
    v_accvgpr_write_b32 a178, v222
    v_accvgpr_write_b32 a179, v223
    v_accvgpr_read_b32 v220, a180
    v_accvgpr_read_b32 v221, a181
    v_accvgpr_read_b32 v222, a182
    v_accvgpr_read_b32 v223, a183
    v_mul_f32 v220, v220, v218
    v_mul_f32 v221, v221, v218
    v_mul_f32 v222, v222, v218
    v_mul_f32 v223, v223, v218
    v_accvgpr_write_b32 a180, v220
    v_accvgpr_write_b32 a181, v221
    v_accvgpr_write_b32 a182, v222
    v_accvgpr_write_b32 a183, v223
    v_accvgpr_read_b32 v220, a184
    v_accvgpr_read_b32 v221, a185
    v_accvgpr_read_b32 v222, a186
    v_accvgpr_read_b32 v223, a187
    v_mul_f32 v220, v220, v218
    v_mul_f32 v221, v221, v218
    v_mul_f32 v222, v222, v218
    v_mul_f32 v223, v223, v218
    v_accvgpr_write_b32 a184, v220
    v_accvgpr_write_b32 a185, v221
    v_accvgpr_write_b32 a186, v222
    v_accvgpr_write_b32 a187, v223
    v_accvgpr_read_b32 v220, a188
    v_accvgpr_read_b32 v221, a189
    v_accvgpr_read_b32 v222, a190
    v_accvgpr_read_b32 v223, a191
    v_mul_f32 v220, v220, v218
    v_mul_f32 v221, v221, v218
    v_mul_f32 v222, v222, v218
    v_mul_f32 v223, v223, v218
    v_accvgpr_write_b32 a188, v220
    v_accvgpr_write_b32 a189, v221
    v_accvgpr_write_b32 a190, v222
    v_accvgpr_write_b32 a191, v223
    v_exp_f32 v192, v0
    s_nop 0
    v_exp_f32 v193, v1
    s_nop 0
    v_exp_f32 v194, v2
    s_nop 0
    v_exp_f32 v195, v3
    s_nop 0
    v_add_f32 v214, v192, v193
    s_nop 0
    v_cvt_pk_bf16_f32 v64, v192, v193
    s_nop 0
    v_exp_f32 v196, v4
    s_nop 0
    v_add_f32 v214, v214, v194
    s_nop 0
    v_exp_f32 v197, v5
    s_nop 0
    v_add_f32 v214, v214, v195
    s_nop 0
    v_cvt_pk_bf16_f32 v65, v194, v195
    s_nop 0
    v_exp_f32 v192, v6
    s_nop 0
    v_add_f32 v214, v214, v196
    s_nop 0
    v_exp_f32 v193, v7
    s_nop 0
    v_add_f32 v214, v214, v197
    s_nop 0
    v_cvt_pk_bf16_f32 v66, v196, v197
    s_nop 0
    v_exp_f32 v194, v8
    s_nop 0
    v_add_f32 v214, v214, v192
    s_nop 0
    v_exp_f32 v195, v9
    s_nop 0
    v_add_f32 v214, v214, v193
    s_nop 0
    v_cvt_pk_bf16_f32 v67, v192, v193
    s_nop 0
    v_exp_f32 v196, v10
    s_nop 0
    v_add_f32 v214, v214, v194
    s_nop 0
    v_exp_f32 v197, v11
    s_nop 0
    v_add_f32 v214, v214, v195
    s_nop 0
    v_cvt_pk_bf16_f32 v68, v194, v195
    s_nop 0
    v_exp_f32 v192, v12
    s_nop 0
    v_add_f32 v214, v214, v196
    s_nop 0
    v_exp_f32 v193, v13
    s_nop 0
    v_add_f32 v214, v214, v197
    s_nop 0
    v_cvt_pk_bf16_f32 v69, v196, v197
    s_nop 0
    v_exp_f32 v194, v14
    s_nop 0
    v_add_f32 v214, v214, v192
    s_nop 0
    v_exp_f32 v195, v15
    s_nop 0
    v_add_f32 v214, v214, v193
    s_nop 0
    v_cvt_pk_bf16_f32 v70, v192, v193
    s_nop 0
    v_exp_f32 v196, v16
    s_nop 0
    v_add_f32 v214, v214, v194
    s_nop 0
    v_exp_f32 v197, v17
    s_nop 0
    v_add_f32 v214, v214, v195
    s_nop 0
    v_cvt_pk_bf16_f32 v71, v194, v195
    s_nop 0
    v_exp_f32 v192, v18
    s_nop 0
    v_exp_f32 v193, v19
    s_nop 0
    v_add_f32 v215, v196, v197
    s_nop 0
    v_cvt_pk_bf16_f32 v72, v196, v197
    s_nop 0
    v_exp_f32 v194, v20
    s_nop 0
    v_add_f32 v215, v215, v192
    s_nop 0
    v_exp_f32 v195, v21
    s_nop 0
    v_add_f32 v215, v215, v193
    s_nop 0
    v_cvt_pk_bf16_f32 v73, v192, v193
    s_nop 0
    v_exp_f32 v196, v22
    s_nop 0
    v_add_f32 v215, v215, v194
    s_nop 0
    v_exp_f32 v197, v23
    s_nop 0
    v_add_f32 v215, v215, v195
    s_nop 0
    v_cvt_pk_bf16_f32 v74, v194, v195
    s_nop 0
    v_exp_f32 v192, v24
    s_nop 0
    v_add_f32 v215, v215, v196
    s_nop 0
    v_exp_f32 v193, v25
    s_nop 0
    v_add_f32 v215, v215, v197
    s_nop 0
    v_cvt_pk_bf16_f32 v75, v196, v197
    s_nop 0
    v_exp_f32 v194, v26
    s_nop 0
    v_add_f32 v215, v215, v192
    s_nop 0
    v_exp_f32 v195, v27
    s_nop 0
    v_add_f32 v215, v215, v193
    s_nop 0
    v_cvt_pk_bf16_f32 v76, v192, v193
    s_nop 0
    v_exp_f32 v196, v28
    s_nop 0
    v_add_f32 v215, v215, v194
    s_nop 0
    v_exp_f32 v197, v29
    s_nop 0
    v_add_f32 v215, v215, v195
    s_nop 0
    v_cvt_pk_bf16_f32 v77, v194, v195
    s_nop 0
    v_exp_f32 v192, v30
    s_nop 0
    v_add_f32 v215, v215, v196
    s_nop 0
    v_exp_f32 v193, v31
    s_nop 0
    v_add_f32 v215, v215, v197
    s_nop 0
    v_cvt_pk_bf16_f32 v78, v196, v197
    s_nop 0
    v_add_f32 v215, v215, v192
    s_nop 0
    v_add_f32 v215, v215, v193
    s_nop 0
    v_cvt_pk_bf16_f32 v79, v192, v193
    s_nop 0
    s_nop 3
    s_branch F_retL2
F_slowL3:
    s_nop 15
    s_nop 15
    v_max3_f32 v216, v32, v33, v34
    v_max3_f32 v216, v216, v35, v36
    v_max3_f32 v216, v216, v37, v38
    v_max3_f32 v216, v216, v39, v40
    v_max3_f32 v216, v216, v41, v42
    v_max3_f32 v216, v216, v43, v44
    v_max3_f32 v216, v216, v45, v46
    v_max_f32 v216, v216, v47
    v_mov_b32 v217, v216
    s_nop 1
    v_permlane32_swap_b32 v216, v217
    s_nop 1
    v_max_f32 v216, v216, v217
    v_max_f32 v216, 0, v216
    v_sub_f32 v217, 0, v216
    v_exp_f32 v218, v217
    v_sub_f32 v96, v96, v216
    v_sub_f32 v32, v32, v216
    v_sub_f32 v0, v0, v216
    v_sub_f32 v97, v97, v216
    v_sub_f32 v33, v33, v216
    v_sub_f32 v1, v1, v216
    v_sub_f32 v98, v98, v216
    v_sub_f32 v34, v34, v216
    v_sub_f32 v2, v2, v216
    v_sub_f32 v99, v99, v216
    v_sub_f32 v35, v35, v216
    v_sub_f32 v3, v3, v216
    v_sub_f32 v100, v100, v216
    v_sub_f32 v36, v36, v216
    v_sub_f32 v4, v4, v216
    v_sub_f32 v101, v101, v216
    v_sub_f32 v37, v37, v216
    v_sub_f32 v5, v5, v216
    v_sub_f32 v102, v102, v216
    v_sub_f32 v38, v38, v216
    v_sub_f32 v6, v6, v216
    v_sub_f32 v103, v103, v216
    v_sub_f32 v39, v39, v216
    v_sub_f32 v7, v7, v216
    v_sub_f32 v104, v104, v216
    v_sub_f32 v40, v40, v216
    v_sub_f32 v8, v8, v216
    v_sub_f32 v105, v105, v216
    v_sub_f32 v41, v41, v216
    v_sub_f32 v9, v9, v216
    v_sub_f32 v106, v106, v216
    v_sub_f32 v42, v42, v216
    v_sub_f32 v10, v10, v216
    v_sub_f32 v107, v107, v216
    v_sub_f32 v43, v43, v216
    v_sub_f32 v11, v11, v216
    v_sub_f32 v108, v108, v216
    v_sub_f32 v44, v44, v216
    v_sub_f32 v12, v12, v216
    v_sub_f32 v109, v109, v216
    v_sub_f32 v45, v45, v216
    v_sub_f32 v13, v13, v216
    v_sub_f32 v110, v110, v216
    v_sub_f32 v46, v46, v216
    v_sub_f32 v14, v14, v216
    v_sub_f32 v111, v111, v216
    v_sub_f32 v47, v47, v216
    v_sub_f32 v15, v15, v216
    v_mul_f32 v212, v212, v218
    v_accvgpr_read_b32 v220, a0
    v_accvgpr_read_b32 v221, a1
    v_accvgpr_read_b32 v222, a2
    v_accvgpr_read_b32 v223, a3
    v_mul_f32 v220, v220, v218
    v_mul_f32 v221, v221, v218
    v_mul_f32 v222, v222, v218
    v_mul_f32 v223, v223, v218
    v_accvgpr_write_b32 a0, v220
    v_accvgpr_write_b32 a1, v221
    v_accvgpr_write_b32 a2, v222
    v_accvgpr_write_b32 a3, v223
    v_accvgpr_read_b32 v220, a4
    v_accvgpr_read_b32 v221, a5
    v_accvgpr_read_b32 v222, a6
    v_accvgpr_read_b32 v223, a7
    v_mul_f32 v220, v220, v218
    v_mul_f32 v221, v221, v218
    v_mul_f32 v222, v222, v218
    v_mul_f32 v223, v223, v218
    v_accvgpr_write_b32 a4, v220
    v_accvgpr_write_b32 a5, v221
    v_accvgpr_write_b32 a6, v222
    v_accvgpr_write_b32 a7, v223
    v_accvgpr_read_b32 v220, a8
    v_accvgpr_read_b32 v221, a9
    v_accvgpr_read_b32 v222, a10
    v_accvgpr_read_b32 v223, a11
    v_mul_f32 v220, v220, v218
    v_mul_f32 v221, v221, v218
    v_mul_f32 v222, v222, v218
    v_mul_f32 v223, v223, v218
    v_accvgpr_write_b32 a8, v220
    v_accvgpr_write_b32 a9, v221
    v_accvgpr_write_b32 a10, v222
    v_accvgpr_write_b32 a11, v223
    v_accvgpr_read_b32 v220, a12
    v_accvgpr_read_b32 v221, a13
    v_accvgpr_read_b32 v222, a14
    v_accvgpr_read_b32 v223, a15
    v_mul_f32 v220, v220, v218
    v_mul_f32 v221, v221, v218
    v_mul_f32 v222, v222, v218
    v_mul_f32 v223, v223, v218
    v_accvgpr_write_b32 a12, v220
    v_accvgpr_write_b32 a13, v221
    v_accvgpr_write_b32 a14, v222
    v_accvgpr_write_b32 a15, v223
    v_accvgpr_read_b32 v220, a16
    v_accvgpr_read_b32 v221, a17
    v_accvgpr_read_b32 v222, a18
    v_accvgpr_read_b32 v223, a19
    v_mul_f32 v220, v220, v218
    v_mul_f32 v221, v221, v218
    v_mul_f32 v222, v222, v218
    v_mul_f32 v223, v223, v218
    v_accvgpr_write_b32 a16, v220
    v_accvgpr_write_b32 a17, v221
    v_accvgpr_write_b32 a18, v222
    v_accvgpr_write_b32 a19, v223
    v_accvgpr_read_b32 v220, a20
    v_accvgpr_read_b32 v221, a21
    v_accvgpr_read_b32 v222, a22
    v_accvgpr_read_b32 v223, a23
    v_mul_f32 v220, v220, v218
    v_mul_f32 v221, v221, v218
    v_mul_f32 v222, v222, v218
    v_mul_f32 v223, v223, v218
    v_accvgpr_write_b32 a20, v220
    v_accvgpr_write_b32 a21, v221
    v_accvgpr_write_b32 a22, v222
    v_accvgpr_write_b32 a23, v223
    v_accvgpr_read_b32 v220, a24
    v_accvgpr_read_b32 v221, a25
    v_accvgpr_read_b32 v222, a26
    v_accvgpr_read_b32 v223, a27
    v_mul_f32 v220, v220, v218
    v_mul_f32 v221, v221, v218
    v_mul_f32 v222, v222, v218
    v_mul_f32 v223, v223, v218
    v_accvgpr_write_b32 a24, v220
    v_accvgpr_write_b32 a25, v221
    v_accvgpr_write_b32 a26, v222
    v_accvgpr_write_b32 a27, v223
    v_accvgpr_read_b32 v220, a28
    v_accvgpr_read_b32 v221, a29
    v_accvgpr_read_b32 v222, a30
    v_accvgpr_read_b32 v223, a31
    v_mul_f32 v220, v220, v218
    v_mul_f32 v221, v221, v218
    v_mul_f32 v222, v222, v218
    v_mul_f32 v223, v223, v218
    v_accvgpr_write_b32 a28, v220
    v_accvgpr_write_b32 a29, v221
    v_accvgpr_write_b32 a30, v222
    v_accvgpr_write_b32 a31, v223
    v_accvgpr_read_b32 v220, a32
    v_accvgpr_read_b32 v221, a33
    v_accvgpr_read_b32 v222, a34
    v_accvgpr_read_b32 v223, a35
    v_mul_f32 v220, v220, v218
    v_mul_f32 v221, v221, v218
    v_mul_f32 v222, v222, v218
    v_mul_f32 v223, v223, v218
    v_accvgpr_write_b32 a32, v220
    v_accvgpr_write_b32 a33, v221
    v_accvgpr_write_b32 a34, v222
    v_accvgpr_write_b32 a35, v223
    v_accvgpr_read_b32 v220, a36
    v_accvgpr_read_b32 v221, a37
    v_accvgpr_read_b32 v222, a38
    v_accvgpr_read_b32 v223, a39
    v_mul_f32 v220, v220, v218
    v_mul_f32 v221, v221, v218
    v_mul_f32 v222, v222, v218
    v_mul_f32 v223, v223, v218
    v_accvgpr_write_b32 a36, v220
    v_accvgpr_write_b32 a37, v221
    v_accvgpr_write_b32 a38, v222
    v_accvgpr_write_b32 a39, v223
    v_accvgpr_read_b32 v220, a40
    v_accvgpr_read_b32 v221, a41
    v_accvgpr_read_b32 v222, a42
    v_accvgpr_read_b32 v223, a43
    v_mul_f32 v220, v220, v218
    v_mul_f32 v221, v221, v218
    v_mul_f32 v222, v222, v218
    v_mul_f32 v223, v223, v218
    v_accvgpr_write_b32 a40, v220
    v_accvgpr_write_b32 a41, v221
    v_accvgpr_write_b32 a42, v222
    v_accvgpr_write_b32 a43, v223
    v_accvgpr_read_b32 v220, a44
    v_accvgpr_read_b32 v221, a45
    v_accvgpr_read_b32 v222, a46
    v_accvgpr_read_b32 v223, a47
    v_mul_f32 v220, v220, v218
    v_mul_f32 v221, v221, v218
    v_mul_f32 v222, v222, v218
    v_mul_f32 v223, v223, v218
    v_accvgpr_write_b32 a44, v220
    v_accvgpr_write_b32 a45, v221
    v_accvgpr_write_b32 a46, v222
    v_accvgpr_write_b32 a47, v223
    v_accvgpr_read_b32 v220, a48
    v_accvgpr_read_b32 v221, a49
    v_accvgpr_read_b32 v222, a50
    v_accvgpr_read_b32 v223, a51
    v_mul_f32 v220, v220, v218
    v_mul_f32 v221, v221, v218
    v_mul_f32 v222, v222, v218
    v_mul_f32 v223, v223, v218
    v_accvgpr_write_b32 a48, v220
    v_accvgpr_write_b32 a49, v221
    v_accvgpr_write_b32 a50, v222
    v_accvgpr_write_b32 a51, v223
    v_accvgpr_read_b32 v220, a52
    v_accvgpr_read_b32 v221, a53
    v_accvgpr_read_b32 v222, a54
    v_accvgpr_read_b32 v223, a55
    v_mul_f32 v220, v220, v218
    v_mul_f32 v221, v221, v218
    v_mul_f32 v222, v222, v218
    v_mul_f32 v223, v223, v218
    v_accvgpr_write_b32 a52, v220
    v_accvgpr_write_b32 a53, v221
    v_accvgpr_write_b32 a54, v222
    v_accvgpr_write_b32 a55, v223
    v_accvgpr_read_b32 v220, a56
    v_accvgpr_read_b32 v221, a57
    v_accvgpr_read_b32 v222, a58
    v_accvgpr_read_b32 v223, a59
    v_mul_f32 v220, v220, v218
    v_mul_f32 v221, v221, v218
    v_mul_f32 v222, v222, v218
    v_mul_f32 v223, v223, v218
    v_accvgpr_write_b32 a56, v220
    v_accvgpr_write_b32 a57, v221
    v_accvgpr_write_b32 a58, v222
    v_accvgpr_write_b32 a59, v223
    v_accvgpr_read_b32 v220, a60
    v_accvgpr_read_b32 v221, a61
    v_accvgpr_read_b32 v222, a62
    v_accvgpr_read_b32 v223, a63
    v_mul_f32 v220, v220, v218
    v_mul_f32 v221, v221, v218
    v_mul_f32 v222, v222, v218
    v_mul_f32 v223, v223, v218
    v_accvgpr_write_b32 a60, v220
    v_accvgpr_write_b32 a61, v221
    v_accvgpr_write_b32 a62, v222
    v_accvgpr_write_b32 a63, v223
    v_accvgpr_read_b32 v220, a64
    v_accvgpr_read_b32 v221, a65
    v_accvgpr_read_b32 v222, a66
    v_accvgpr_read_b32 v223, a67
    v_mul_f32 v220, v220, v218
    v_mul_f32 v221, v221, v218
    v_mul_f32 v222, v222, v218
    v_mul_f32 v223, v223, v218
    v_accvgpr_write_b32 a64, v220
    v_accvgpr_write_b32 a65, v221
    v_accvgpr_write_b32 a66, v222
    v_accvgpr_write_b32 a67, v223
    v_accvgpr_read_b32 v220, a68
    v_accvgpr_read_b32 v221, a69
    v_accvgpr_read_b32 v222, a70
    v_accvgpr_read_b32 v223, a71
    v_mul_f32 v220, v220, v218
    v_mul_f32 v221, v221, v218
    v_mul_f32 v222, v222, v218
    v_mul_f32 v223, v223, v218
    v_accvgpr_write_b32 a68, v220
    v_accvgpr_write_b32 a69, v221
    v_accvgpr_write_b32 a70, v222
    v_accvgpr_write_b32 a71, v223
    v_accvgpr_read_b32 v220, a72
    v_accvgpr_read_b32 v221, a73
    v_accvgpr_read_b32 v222, a74
    v_accvgpr_read_b32 v223, a75
    v_mul_f32 v220, v220, v218
    v_mul_f32 v221, v221, v218
    v_mul_f32 v222, v222, v218
    v_mul_f32 v223, v223, v218
    v_accvgpr_write_b32 a72, v220
    v_accvgpr_write_b32 a73, v221
    v_accvgpr_write_b32 a74, v222
    v_accvgpr_write_b32 a75, v223
    v_accvgpr_read_b32 v220, a76
    v_accvgpr_read_b32 v221, a77
    v_accvgpr_read_b32 v222, a78
    v_accvgpr_read_b32 v223, a79
    v_mul_f32 v220, v220, v218
    v_mul_f32 v221, v221, v218
    v_mul_f32 v222, v222, v218
    v_mul_f32 v223, v223, v218
    v_accvgpr_write_b32 a76, v220
    v_accvgpr_write_b32 a77, v221
    v_accvgpr_write_b32 a78, v222
    v_accvgpr_write_b32 a79, v223
    v_accvgpr_read_b32 v220, a80
    v_accvgpr_read_b32 v221, a81
    v_accvgpr_read_b32 v222, a82
    v_accvgpr_read_b32 v223, a83
    v_mul_f32 v220, v220, v218
    v_mul_f32 v221, v221, v218
    v_mul_f32 v222, v222, v218
    v_mul_f32 v223, v223, v218
    v_accvgpr_write_b32 a80, v220
    v_accvgpr_write_b32 a81, v221
    v_accvgpr_write_b32 a82, v222
    v_accvgpr_write_b32 a83, v223
    v_accvgpr_read_b32 v220, a84
    v_accvgpr_read_b32 v221, a85
    v_accvgpr_read_b32 v222, a86
    v_accvgpr_read_b32 v223, a87
    v_mul_f32 v220, v220, v218
    v_mul_f32 v221, v221, v218
    v_mul_f32 v222, v222, v218
    v_mul_f32 v223, v223, v218
    v_accvgpr_write_b32 a84, v220
    v_accvgpr_write_b32 a85, v221
    v_accvgpr_write_b32 a86, v222
    v_accvgpr_write_b32 a87, v223
    v_accvgpr_read_b32 v220, a88
    v_accvgpr_read_b32 v221, a89
    v_accvgpr_read_b32 v222, a90
    v_accvgpr_read_b32 v223, a91
    v_mul_f32 v220, v220, v218
    v_mul_f32 v221, v221, v218
    v_mul_f32 v222, v222, v218
    v_mul_f32 v223, v223, v218
    v_accvgpr_write_b32 a88, v220
    v_accvgpr_write_b32 a89, v221
    v_accvgpr_write_b32 a90, v222
    v_accvgpr_write_b32 a91, v223
    v_accvgpr_read_b32 v220, a92
    v_accvgpr_read_b32 v221, a93
    v_accvgpr_read_b32 v222, a94
    v_accvgpr_read_b32 v223, a95
    v_mul_f32 v220, v220, v218
    v_mul_f32 v221, v221, v218
    v_mul_f32 v222, v222, v218
    v_mul_f32 v223, v223, v218
    v_accvgpr_write_b32 a92, v220
    v_accvgpr_write_b32 a93, v221
    v_accvgpr_write_b32 a94, v222
    v_accvgpr_write_b32 a95, v223
    v_max3_f32 v216, v48, v49, v50
    v_max3_f32 v216, v216, v51, v52
    v_max3_f32 v216, v216, v53, v54
    v_max3_f32 v216, v216, v55, v56
    v_max3_f32 v216, v216, v57, v58
    v_max3_f32 v216, v216, v59, v60
    v_max3_f32 v216, v216, v61, v62
    v_max_f32 v216, v216, v63
    v_mov_b32 v217, v216
    s_nop 1
    v_permlane32_swap_b32 v216, v217
    s_nop 1
    v_max_f32 v216, v216, v217
    v_max_f32 v216, 0, v216
    v_sub_f32 v217, 0, v216
    v_exp_f32 v218, v217
    v_sub_f32 v112, v112, v216
    v_sub_f32 v48, v48, v216
    v_sub_f32 v16, v16, v216
    v_sub_f32 v113, v113, v216
    v_sub_f32 v49, v49, v216
    v_sub_f32 v17, v17, v216
    v_sub_f32 v114, v114, v216
    v_sub_f32 v50, v50, v216
    v_sub_f32 v18, v18, v216
    v_sub_f32 v115, v115, v216
    v_sub_f32 v51, v51, v216
    v_sub_f32 v19, v19, v216
    v_sub_f32 v116, v116, v216
    v_sub_f32 v52, v52, v216
    v_sub_f32 v20, v20, v216
    v_sub_f32 v117, v117, v216
    v_sub_f32 v53, v53, v216
    v_sub_f32 v21, v21, v216
    v_sub_f32 v118, v118, v216
    v_sub_f32 v54, v54, v216
    v_sub_f32 v22, v22, v216
    v_sub_f32 v119, v119, v216
    v_sub_f32 v55, v55, v216
    v_sub_f32 v23, v23, v216
    v_sub_f32 v120, v120, v216
    v_sub_f32 v56, v56, v216
    v_sub_f32 v24, v24, v216
    v_sub_f32 v121, v121, v216
    v_sub_f32 v57, v57, v216
    v_sub_f32 v25, v25, v216
    v_sub_f32 v122, v122, v216
    v_sub_f32 v58, v58, v216
    v_sub_f32 v26, v26, v216
    v_sub_f32 v123, v123, v216
    v_sub_f32 v59, v59, v216
    v_sub_f32 v27, v27, v216
    v_sub_f32 v124, v124, v216
    v_sub_f32 v60, v60, v216
    v_sub_f32 v28, v28, v216
    v_sub_f32 v125, v125, v216
    v_sub_f32 v61, v61, v216
    v_sub_f32 v29, v29, v216
    v_sub_f32 v126, v126, v216
    v_sub_f32 v62, v62, v216
    v_sub_f32 v30, v30, v216
    v_sub_f32 v127, v127, v216
    v_sub_f32 v63, v63, v216
    v_sub_f32 v31, v31, v216
    v_mul_f32 v213, v213, v218
    v_accvgpr_read_b32 v220, a96
    v_accvgpr_read_b32 v221, a97
    v_accvgpr_read_b32 v222, a98
    v_accvgpr_read_b32 v223, a99
    v_mul_f32 v220, v220, v218
    v_mul_f32 v221, v221, v218
    v_mul_f32 v222, v222, v218
    v_mul_f32 v223, v223, v218
    v_accvgpr_write_b32 a96, v220
    v_accvgpr_write_b32 a97, v221
    v_accvgpr_write_b32 a98, v222
    v_accvgpr_write_b32 a99, v223
    v_accvgpr_read_b32 v220, a100
    v_accvgpr_read_b32 v221, a101
    v_accvgpr_read_b32 v222, a102
    v_accvgpr_read_b32 v223, a103
    v_mul_f32 v220, v220, v218
    v_mul_f32 v221, v221, v218
    v_mul_f32 v222, v222, v218
    v_mul_f32 v223, v223, v218
    v_accvgpr_write_b32 a100, v220
    v_accvgpr_write_b32 a101, v221
    v_accvgpr_write_b32 a102, v222
    v_accvgpr_write_b32 a103, v223
    v_accvgpr_read_b32 v220, a104
    v_accvgpr_read_b32 v221, a105
    v_accvgpr_read_b32 v222, a106
    v_accvgpr_read_b32 v223, a107
    v_mul_f32 v220, v220, v218
    v_mul_f32 v221, v221, v218
    v_mul_f32 v222, v222, v218
    v_mul_f32 v223, v223, v218
    v_accvgpr_write_b32 a104, v220
    v_accvgpr_write_b32 a105, v221
    v_accvgpr_write_b32 a106, v222
    v_accvgpr_write_b32 a107, v223
    v_accvgpr_read_b32 v220, a108
    v_accvgpr_read_b32 v221, a109
    v_accvgpr_read_b32 v222, a110
    v_accvgpr_read_b32 v223, a111
    v_mul_f32 v220, v220, v218
    v_mul_f32 v221, v221, v218
    v_mul_f32 v222, v222, v218
    v_mul_f32 v223, v223, v218
    v_accvgpr_write_b32 a108, v220
    v_accvgpr_write_b32 a109, v221
    v_accvgpr_write_b32 a110, v222
    v_accvgpr_write_b32 a111, v223
    v_accvgpr_read_b32 v220, a112
    v_accvgpr_read_b32 v221, a113
    v_accvgpr_read_b32 v222, a114
    v_accvgpr_read_b32 v223, a115
    v_mul_f32 v220, v220, v218
    v_mul_f32 v221, v221, v218
    v_mul_f32 v222, v222, v218
    v_mul_f32 v223, v223, v218
    v_accvgpr_write_b32 a112, v220
    v_accvgpr_write_b32 a113, v221
    v_accvgpr_write_b32 a114, v222
    v_accvgpr_write_b32 a115, v223
    v_accvgpr_read_b32 v220, a116
    v_accvgpr_read_b32 v221, a117
    v_accvgpr_read_b32 v222, a118
    v_accvgpr_read_b32 v223, a119
    v_mul_f32 v220, v220, v218
    v_mul_f32 v221, v221, v218
    v_mul_f32 v222, v222, v218
    v_mul_f32 v223, v223, v218
    v_accvgpr_write_b32 a116, v220
    v_accvgpr_write_b32 a117, v221
    v_accvgpr_write_b32 a118, v222
    v_accvgpr_write_b32 a119, v223
    v_accvgpr_read_b32 v220, a120
    v_accvgpr_read_b32 v221, a121
    v_accvgpr_read_b32 v222, a122
    v_accvgpr_read_b32 v223, a123
    v_mul_f32 v220, v220, v218
    v_mul_f32 v221, v221, v218
    v_mul_f32 v222, v222, v218
    v_mul_f32 v223, v223, v218
    v_accvgpr_write_b32 a120, v220
    v_accvgpr_write_b32 a121, v221
    v_accvgpr_write_b32 a122, v222
    v_accvgpr_write_b32 a123, v223
    v_accvgpr_read_b32 v220, a124
    v_accvgpr_read_b32 v221, a125
    v_accvgpr_read_b32 v222, a126
    v_accvgpr_read_b32 v223, a127
    v_mul_f32 v220, v220, v218
    v_mul_f32 v221, v221, v218
    v_mul_f32 v222, v222, v218
    v_mul_f32 v223, v223, v218
    v_accvgpr_write_b32 a124, v220
    v_accvgpr_write_b32 a125, v221
    v_accvgpr_write_b32 a126, v222
    v_accvgpr_write_b32 a127, v223
    v_accvgpr_read_b32 v220, a128
    v_accvgpr_read_b32 v221, a129
    v_accvgpr_read_b32 v222, a130
    v_accvgpr_read_b32 v223, a131
    v_mul_f32 v220, v220, v218
    v_mul_f32 v221, v221, v218
    v_mul_f32 v222, v222, v218
    v_mul_f32 v223, v223, v218
    v_accvgpr_write_b32 a128, v220
    v_accvgpr_write_b32 a129, v221
    v_accvgpr_write_b32 a130, v222
    v_accvgpr_write_b32 a131, v223
    v_accvgpr_read_b32 v220, a132
    v_accvgpr_read_b32 v221, a133
    v_accvgpr_read_b32 v222, a134
    v_accvgpr_read_b32 v223, a135
    v_mul_f32 v220, v220, v218
    v_mul_f32 v221, v221, v218
    v_mul_f32 v222, v222, v218
    v_mul_f32 v223, v223, v218
    v_accvgpr_write_b32 a132, v220
    v_accvgpr_write_b32 a133, v221
    v_accvgpr_write_b32 a134, v222
    v_accvgpr_write_b32 a135, v223
    v_accvgpr_read_b32 v220, a136
    v_accvgpr_read_b32 v221, a137
    v_accvgpr_read_b32 v222, a138
    v_accvgpr_read_b32 v223, a139
    v_mul_f32 v220, v220, v218
    v_mul_f32 v221, v221, v218
    v_mul_f32 v222, v222, v218
    v_mul_f32 v223, v223, v218
    v_accvgpr_write_b32 a136, v220
    v_accvgpr_write_b32 a137, v221
    v_accvgpr_write_b32 a138, v222
    v_accvgpr_write_b32 a139, v223
    v_accvgpr_read_b32 v220, a140
    v_accvgpr_read_b32 v221, a141
    v_accvgpr_read_b32 v222, a142
    v_accvgpr_read_b32 v223, a143
    v_mul_f32 v220, v220, v218
    v_mul_f32 v221, v221, v218
    v_mul_f32 v222, v222, v218
    v_mul_f32 v223, v223, v218
    v_accvgpr_write_b32 a140, v220
    v_accvgpr_write_b32 a141, v221
    v_accvgpr_write_b32 a142, v222
    v_accvgpr_write_b32 a143, v223
    v_accvgpr_read_b32 v220, a144
    v_accvgpr_read_b32 v221, a145
    v_accvgpr_read_b32 v222, a146
    v_accvgpr_read_b32 v223, a147
    v_mul_f32 v220, v220, v218
    v_mul_f32 v221, v221, v218
    v_mul_f32 v222, v222, v218
    v_mul_f32 v223, v223, v218
    v_accvgpr_write_b32 a144, v220
    v_accvgpr_write_b32 a145, v221
    v_accvgpr_write_b32 a146, v222
    v_accvgpr_write_b32 a147, v223
    v_accvgpr_read_b32 v220, a148
    v_accvgpr_read_b32 v221, a149
    v_accvgpr_read_b32 v222, a150
    v_accvgpr_read_b32 v223, a151
    v_mul_f32 v220, v220, v218
    v_mul_f32 v221, v221, v218
    v_mul_f32 v222, v222, v218
    v_mul_f32 v223, v223, v218
    v_accvgpr_write_b32 a148, v220
    v_accvgpr_write_b32 a149, v221
    v_accvgpr_write_b32 a150, v222
    v_accvgpr_write_b32 a151, v223
    v_accvgpr_read_b32 v220, a152
    v_accvgpr_read_b32 v221, a153
    v_accvgpr_read_b32 v222, a154
    v_accvgpr_read_b32 v223, a155
    v_mul_f32 v220, v220, v218
    v_mul_f32 v221, v221, v218
    v_mul_f32 v222, v222, v218
    v_mul_f32 v223, v223, v218
    v_accvgpr_write_b32 a152, v220
    v_accvgpr_write_b32 a153, v221
    v_accvgpr_write_b32 a154, v222
    v_accvgpr_write_b32 a155, v223
    v_accvgpr_read_b32 v220, a156
    v_accvgpr_read_b32 v221, a157
    v_accvgpr_read_b32 v222, a158
    v_accvgpr_read_b32 v223, a159
    v_mul_f32 v220, v220, v218
    v_mul_f32 v221, v221, v218
    v_mul_f32 v222, v222, v218
    v_mul_f32 v223, v223, v218
    v_accvgpr_write_b32 a156, v220
    v_accvgpr_write_b32 a157, v221
    v_accvgpr_write_b32 a158, v222
    v_accvgpr_write_b32 a159, v223
    v_accvgpr_read_b32 v220, a160
    v_accvgpr_read_b32 v221, a161
    v_accvgpr_read_b32 v222, a162
    v_accvgpr_read_b32 v223, a163
    v_mul_f32 v220, v220, v218
    v_mul_f32 v221, v221, v218
    v_mul_f32 v222, v222, v218
    v_mul_f32 v223, v223, v218
    v_accvgpr_write_b32 a160, v220
    v_accvgpr_write_b32 a161, v221
    v_accvgpr_write_b32 a162, v222
    v_accvgpr_write_b32 a163, v223
    v_accvgpr_read_b32 v220, a164
    v_accvgpr_read_b32 v221, a165
    v_accvgpr_read_b32 v222, a166
    v_accvgpr_read_b32 v223, a167
    v_mul_f32 v220, v220, v218
    v_mul_f32 v221, v221, v218
    v_mul_f32 v222, v222, v218
    v_mul_f32 v223, v223, v218
    v_accvgpr_write_b32 a164, v220
    v_accvgpr_write_b32 a165, v221
    v_accvgpr_write_b32 a166, v222
    v_accvgpr_write_b32 a167, v223
    v_accvgpr_read_b32 v220, a168
    v_accvgpr_read_b32 v221, a169
    v_accvgpr_read_b32 v222, a170
    v_accvgpr_read_b32 v223, a171
    v_mul_f32 v220, v220, v218
    v_mul_f32 v221, v221, v218
    v_mul_f32 v222, v222, v218
    v_mul_f32 v223, v223, v218
    v_accvgpr_write_b32 a168, v220
    v_accvgpr_write_b32 a169, v221
    v_accvgpr_write_b32 a170, v222
    v_accvgpr_write_b32 a171, v223
    v_accvgpr_read_b32 v220, a172
    v_accvgpr_read_b32 v221, a173
    v_accvgpr_read_b32 v222, a174
    v_accvgpr_read_b32 v223, a175
    v_mul_f32 v220, v220, v218
    v_mul_f32 v221, v221, v218
    v_mul_f32 v222, v222, v218
    v_mul_f32 v223, v223, v218
    v_accvgpr_write_b32 a172, v220
    v_accvgpr_write_b32 a173, v221
    v_accvgpr_write_b32 a174, v222
    v_accvgpr_write_b32 a175, v223
    v_accvgpr_read_b32 v220, a176
    v_accvgpr_read_b32 v221, a177
    v_accvgpr_read_b32 v222, a178
    v_accvgpr_read_b32 v223, a179
    v_mul_f32 v220, v220, v218
    v_mul_f32 v221, v221, v218
    v_mul_f32 v222, v222, v218
    v_mul_f32 v223, v223, v218
    v_accvgpr_write_b32 a176, v220
    v_accvgpr_write_b32 a177, v221
    v_accvgpr_write_b32 a178, v222
    v_accvgpr_write_b32 a179, v223
    v_accvgpr_read_b32 v220, a180
    v_accvgpr_read_b32 v221, a181
    v_accvgpr_read_b32 v222, a182
    v_accvgpr_read_b32 v223, a183
    v_mul_f32 v220, v220, v218
    v_mul_f32 v221, v221, v218
    v_mul_f32 v222, v222, v218
    v_mul_f32 v223, v223, v218
    v_accvgpr_write_b32 a180, v220
    v_accvgpr_write_b32 a181, v221
    v_accvgpr_write_b32 a182, v222
    v_accvgpr_write_b32 a183, v223
    v_accvgpr_read_b32 v220, a184
    v_accvgpr_read_b32 v221, a185
    v_accvgpr_read_b32 v222, a186
    v_accvgpr_read_b32 v223, a187
    v_mul_f32 v220, v220, v218
    v_mul_f32 v221, v221, v218
    v_mul_f32 v222, v222, v218
    v_mul_f32 v223, v223, v218
    v_accvgpr_write_b32 a184, v220
    v_accvgpr_write_b32 a185, v221
    v_accvgpr_write_b32 a186, v222
    v_accvgpr_write_b32 a187, v223
    v_accvgpr_read_b32 v220, a188
    v_accvgpr_read_b32 v221, a189
    v_accvgpr_read_b32 v222, a190
    v_accvgpr_read_b32 v223, a191
    v_mul_f32 v220, v220, v218
    v_mul_f32 v221, v221, v218
    v_mul_f32 v222, v222, v218
    v_mul_f32 v223, v223, v218
    v_accvgpr_write_b32 a188, v220
    v_accvgpr_write_b32 a189, v221
    v_accvgpr_write_b32 a190, v222
    v_accvgpr_write_b32 a191, v223
    v_exp_f32 v192, v32
    s_nop 0
    v_exp_f32 v193, v33
    s_nop 0
    v_exp_f32 v194, v34
    s_nop 0
    v_exp_f32 v195, v35
    s_nop 0
    v_add_f32 v214, v192, v193
    s_nop 0
    v_cvt_pk_bf16_f32 v80, v192, v193
    s_nop 0
    v_exp_f32 v196, v36
    s_nop 0
    v_add_f32 v214, v214, v194
    s_nop 0
    v_exp_f32 v197, v37
    s_nop 0
    v_add_f32 v214, v214, v195
    s_nop 0
    v_cvt_pk_bf16_f32 v81, v194, v195
    s_nop 0
    v_exp_f32 v192, v38
    s_nop 0
    v_add_f32 v214, v214, v196
    s_nop 0
    v_exp_f32 v193, v39
    s_nop 0
    v_add_f32 v214, v214, v197
    s_nop 0
    v_cvt_pk_bf16_f32 v82, v196, v197
    s_nop 0
    v_exp_f32 v194, v40
    s_nop 0
    v_add_f32 v214, v214, v192
    s_nop 0
    v_exp_f32 v195, v41
    s_nop 0
    v_add_f32 v214, v214, v193
    s_nop 0
    v_cvt_pk_bf16_f32 v83, v192, v193
    s_nop 0
    v_exp_f32 v196, v42
    s_nop 0
    v_add_f32 v214, v214, v194
    s_nop 0
    v_exp_f32 v197, v43
    s_nop 0
    v_add_f32 v214, v214, v195
    s_nop 0
    v_cvt_pk_bf16_f32 v84, v194, v195
    s_nop 0
    v_exp_f32 v192, v44
    s_nop 0
    v_add_f32 v214, v214, v196
    s_nop 0
    v_exp_f32 v193, v45
    s_nop 0
    v_add_f32 v214, v214, v197
    s_nop 0
    v_cvt_pk_bf16_f32 v85, v196, v197
    s_nop 0
    v_exp_f32 v194, v46
    s_nop 0
    v_add_f32 v214, v214, v192
    s_nop 0
    v_exp_f32 v195, v47
    s_nop 0
    v_add_f32 v214, v214, v193
    s_nop 0
    v_cvt_pk_bf16_f32 v86, v192, v193
    s_nop 0
    v_exp_f32 v196, v48
    s_nop 0
    v_add_f32 v214, v214, v194
    s_nop 0
    v_exp_f32 v197, v49
    s_nop 0
    v_add_f32 v214, v214, v195
    s_nop 0
    v_cvt_pk_bf16_f32 v87, v194, v195
    s_nop 0
    v_exp_f32 v192, v50
    s_nop 0
    v_exp_f32 v193, v51
    s_nop 0
    v_add_f32 v215, v196, v197
    s_nop 0
    v_cvt_pk_bf16_f32 v88, v196, v197
    s_nop 0
    v_exp_f32 v194, v52
    s_nop 0
    v_add_f32 v215, v215, v192
    s_nop 0
    v_exp_f32 v195, v53
    s_nop 0
    v_add_f32 v215, v215, v193
    s_nop 0
    v_cvt_pk_bf16_f32 v89, v192, v193
    s_nop 0
    v_exp_f32 v196, v54
    s_nop 0
    v_add_f32 v215, v215, v194
    s_nop 0
    v_exp_f32 v197, v55
    s_nop 0
    v_add_f32 v215, v215, v195
    s_nop 0
    v_cvt_pk_bf16_f32 v90, v194, v195
    s_nop 0
    v_exp_f32 v192, v56
    s_nop 0
    v_add_f32 v215, v215, v196
    s_nop 0
    v_exp_f32 v193, v57
    s_nop 0
    v_add_f32 v215, v215, v197
    s_nop 0
    v_cvt_pk_bf16_f32 v91, v196, v197
    s_nop 0
    v_exp_f32 v194, v58
    s_nop 0
    v_add_f32 v215, v215, v192
    s_nop 0
    v_exp_f32 v195, v59
    s_nop 0
    v_add_f32 v215, v215, v193
    s_nop 0
    v_cvt_pk_bf16_f32 v92, v192, v193
    s_nop 0
    v_exp_f32 v196, v60
    s_nop 0
    v_add_f32 v215, v215, v194
    s_nop 0
    v_exp_f32 v197, v61
    s_nop 0
    v_add_f32 v215, v215, v195
    s_nop 0
    v_cvt_pk_bf16_f32 v93, v194, v195
    s_nop 0
    v_exp_f32 v192, v62
    s_nop 0
    v_add_f32 v215, v215, v196
    s_nop 0
    v_exp_f32 v193, v63
    s_nop 0
    v_add_f32 v215, v215, v197
    s_nop 0
    v_cvt_pk_bf16_f32 v94, v196, v197
    s_nop 0
    v_add_f32 v215, v215, v192
    s_nop 0
    v_add_f32 v215, v215, v193
    s_nop 0
    v_cvt_pk_bf16_f32 v95, v192, v193
    s_nop 0
    s_nop 3
    s_branch F_retL3
F_slowL4:
    s_nop 15
    s_nop 15
    v_max3_f32 v216, v0, v1, v2
    v_max3_f32 v216, v216, v3, v4
    v_max3_f32 v216, v216, v5, v6
    v_max3_f32 v216, v216, v7, v8
    v_max3_f32 v216, v216, v9, v10
    v_max3_f32 v216, v216, v11, v12
    v_max3_f32 v216, v216, v13, v14
    v_max_f32 v216, v216, v15
    v_mov_b32 v217, v216
    s_nop 1
    v_permlane32_swap_b32 v216, v217
    s_nop 1
    v_max_f32 v216, v216, v217
    v_max_f32 v216, 0, v216
    v_sub_f32 v217, 0, v216
    v_exp_f32 v218, v217
    v_sub_f32 v96, v96, v216
    v_sub_f32 v0, v0, v216
    v_sub_f32 v32, v32, v216
    v_sub_f32 v97, v97, v216
    v_sub_f32 v1, v1, v216
    v_sub_f32 v33, v33, v216
    v_sub_f32 v98, v98, v216
    v_sub_f32 v2, v2, v216
    v_sub_f32 v34, v34, v216
    v_sub_f32 v99, v99, v216
    v_sub_f32 v3, v3, v216
    v_sub_f32 v35, v35, v216
    v_sub_f32 v100, v100, v216
    v_sub_f32 v4, v4, v216
    v_sub_f32 v36, v36, v216
    v_sub_f32 v101, v101, v216
    v_sub_f32 v5, v5, v216
    v_sub_f32 v37, v37, v216
    v_sub_f32 v102, v102, v216
    v_sub_f32 v6, v6, v216
    v_sub_f32 v38, v38, v216
    v_sub_f32 v103, v103, v216
    v_sub_f32 v7, v7, v216
    v_sub_f32 v39, v39, v216
    v_sub_f32 v104, v104, v216
    v_sub_f32 v8, v8, v216
    v_sub_f32 v40, v40, v216
    v_sub_f32 v105, v105, v216
    v_sub_f32 v9, v9, v216
    v_sub_f32 v41, v41, v216
    v_sub_f32 v106, v106, v216
    v_sub_f32 v10, v10, v216
    v_sub_f32 v42, v42, v216
    v_sub_f32 v107, v107, v216
    v_sub_f32 v11, v11, v216
    v_sub_f32 v43, v43, v216
    v_sub_f32 v108, v108, v216
    v_sub_f32 v12, v12, v216
    v_sub_f32 v44, v44, v216
    v_sub_f32 v109, v109, v216
    v_sub_f32 v13, v13, v216
    v_sub_f32 v45, v45, v216
    v_sub_f32 v110, v110, v216
    v_sub_f32 v14, v14, v216
    v_sub_f32 v46, v46, v216
    v_sub_f32 v111, v111, v216
    v_sub_f32 v15, v15, v216
    v_sub_f32 v47, v47, v216
    v_mul_f32 v212, v212, v218
    v_accvgpr_read_b32 v220, a0
    v_accvgpr_read_b32 v221, a1
    v_accvgpr_read_b32 v222, a2
    v_accvgpr_read_b32 v223, a3
    v_mul_f32 v220, v220, v218
    v_mul_f32 v221, v221, v218
    v_mul_f32 v222, v222, v218
    v_mul_f32 v223, v223, v218
    v_accvgpr_write_b32 a0, v220
    v_accvgpr_write_b32 a1, v221
    v_accvgpr_write_b32 a2, v222
    v_accvgpr_write_b32 a3, v223
    v_accvgpr_read_b32 v220, a4
    v_accvgpr_read_b32 v221, a5
    v_accvgpr_read_b32 v222, a6
    v_accvgpr_read_b32 v223, a7
    v_mul_f32 v220, v220, v218
    v_mul_f32 v221, v221, v218
    v_mul_f32 v222, v222, v218
    v_mul_f32 v223, v223, v218
    v_accvgpr_write_b32 a4, v220
    v_accvgpr_write_b32 a5, v221
    v_accvgpr_write_b32 a6, v222
    v_accvgpr_write_b32 a7, v223
    v_accvgpr_read_b32 v220, a8
    v_accvgpr_read_b32 v221, a9
    v_accvgpr_read_b32 v222, a10
    v_accvgpr_read_b32 v223, a11
    v_mul_f32 v220, v220, v218
    v_mul_f32 v221, v221, v218
    v_mul_f32 v222, v222, v218
    v_mul_f32 v223, v223, v218
    v_accvgpr_write_b32 a8, v220
    v_accvgpr_write_b32 a9, v221
    v_accvgpr_write_b32 a10, v222
    v_accvgpr_write_b32 a11, v223
    v_accvgpr_read_b32 v220, a12
    v_accvgpr_read_b32 v221, a13
    v_accvgpr_read_b32 v222, a14
    v_accvgpr_read_b32 v223, a15
    v_mul_f32 v220, v220, v218
    v_mul_f32 v221, v221, v218
    v_mul_f32 v222, v222, v218
    v_mul_f32 v223, v223, v218
    v_accvgpr_write_b32 a12, v220
    v_accvgpr_write_b32 a13, v221
    v_accvgpr_write_b32 a14, v222
    v_accvgpr_write_b32 a15, v223
    v_accvgpr_read_b32 v220, a16
    v_accvgpr_read_b32 v221, a17
    v_accvgpr_read_b32 v222, a18
    v_accvgpr_read_b32 v223, a19
    v_mul_f32 v220, v220, v218
    v_mul_f32 v221, v221, v218
    v_mul_f32 v222, v222, v218
    v_mul_f32 v223, v223, v218
    v_accvgpr_write_b32 a16, v220
    v_accvgpr_write_b32 a17, v221
    v_accvgpr_write_b32 a18, v222
    v_accvgpr_write_b32 a19, v223
    v_accvgpr_read_b32 v220, a20
    v_accvgpr_read_b32 v221, a21
    v_accvgpr_read_b32 v222, a22
    v_accvgpr_read_b32 v223, a23
    v_mul_f32 v220, v220, v218
    v_mul_f32 v221, v221, v218
    v_mul_f32 v222, v222, v218
    v_mul_f32 v223, v223, v218
    v_accvgpr_write_b32 a20, v220
    v_accvgpr_write_b32 a21, v221
    v_accvgpr_write_b32 a22, v222
    v_accvgpr_write_b32 a23, v223
    v_accvgpr_read_b32 v220, a24
    v_accvgpr_read_b32 v221, a25
    v_accvgpr_read_b32 v222, a26
    v_accvgpr_read_b32 v223, a27
    v_mul_f32 v220, v220, v218
    v_mul_f32 v221, v221, v218
    v_mul_f32 v222, v222, v218
    v_mul_f32 v223, v223, v218
    v_accvgpr_write_b32 a24, v220
    v_accvgpr_write_b32 a25, v221
    v_accvgpr_write_b32 a26, v222
    v_accvgpr_write_b32 a27, v223
    v_accvgpr_read_b32 v220, a28
    v_accvgpr_read_b32 v221, a29
    v_accvgpr_read_b32 v222, a30
    v_accvgpr_read_b32 v223, a31
    v_mul_f32 v220, v220, v218
    v_mul_f32 v221, v221, v218
    v_mul_f32 v222, v222, v218
    v_mul_f32 v223, v223, v218
    v_accvgpr_write_b32 a28, v220
    v_accvgpr_write_b32 a29, v221
    v_accvgpr_write_b32 a30, v222
    v_accvgpr_write_b32 a31, v223
    v_accvgpr_read_b32 v220, a32
    v_accvgpr_read_b32 v221, a33
    v_accvgpr_read_b32 v222, a34
    v_accvgpr_read_b32 v223, a35
    v_mul_f32 v220, v220, v218
    v_mul_f32 v221, v221, v218
    v_mul_f32 v222, v222, v218
    v_mul_f32 v223, v223, v218
    v_accvgpr_write_b32 a32, v220
    v_accvgpr_write_b32 a33, v221
    v_accvgpr_write_b32 a34, v222
    v_accvgpr_write_b32 a35, v223
    v_accvgpr_read_b32 v220, a36
    v_accvgpr_read_b32 v221, a37
    v_accvgpr_read_b32 v222, a38
    v_accvgpr_read_b32 v223, a39
    v_mul_f32 v220, v220, v218
    v_mul_f32 v221, v221, v218
    v_mul_f32 v222, v222, v218
    v_mul_f32 v223, v223, v218
    v_accvgpr_write_b32 a36, v220
    v_accvgpr_write_b32 a37, v221
    v_accvgpr_write_b32 a38, v222
    v_accvgpr_write_b32 a39, v223
    v_accvgpr_read_b32 v220, a40
    v_accvgpr_read_b32 v221, a41
    v_accvgpr_read_b32 v222, a42
    v_accvgpr_read_b32 v223, a43
    v_mul_f32 v220, v220, v218
    v_mul_f32 v221, v221, v218
    v_mul_f32 v222, v222, v218
    v_mul_f32 v223, v223, v218
    v_accvgpr_write_b32 a40, v220
    v_accvgpr_write_b32 a41, v221
    v_accvgpr_write_b32 a42, v222
    v_accvgpr_write_b32 a43, v223
    v_accvgpr_read_b32 v220, a44
    v_accvgpr_read_b32 v221, a45
    v_accvgpr_read_b32 v222, a46
    v_accvgpr_read_b32 v223, a47
    v_mul_f32 v220, v220, v218
    v_mul_f32 v221, v221, v218
    v_mul_f32 v222, v222, v218
    v_mul_f32 v223, v223, v218
    v_accvgpr_write_b32 a44, v220
    v_accvgpr_write_b32 a45, v221
    v_accvgpr_write_b32 a46, v222
    v_accvgpr_write_b32 a47, v223
    v_accvgpr_read_b32 v220, a48
    v_accvgpr_read_b32 v221, a49
    v_accvgpr_read_b32 v222, a50
    v_accvgpr_read_b32 v223, a51
    v_mul_f32 v220, v220, v218
    v_mul_f32 v221, v221, v218
    v_mul_f32 v222, v222, v218
    v_mul_f32 v223, v223, v218
    v_accvgpr_write_b32 a48, v220
    v_accvgpr_write_b32 a49, v221
    v_accvgpr_write_b32 a50, v222
    v_accvgpr_write_b32 a51, v223
    v_accvgpr_read_b32 v220, a52
    v_accvgpr_read_b32 v221, a53
    v_accvgpr_read_b32 v222, a54
    v_accvgpr_read_b32 v223, a55
    v_mul_f32 v220, v220, v218
    v_mul_f32 v221, v221, v218
    v_mul_f32 v222, v222, v218
    v_mul_f32 v223, v223, v218
    v_accvgpr_write_b32 a52, v220
    v_accvgpr_write_b32 a53, v221
    v_accvgpr_write_b32 a54, v222
    v_accvgpr_write_b32 a55, v223
    v_accvgpr_read_b32 v220, a56
    v_accvgpr_read_b32 v221, a57
    v_accvgpr_read_b32 v222, a58
    v_accvgpr_read_b32 v223, a59
    v_mul_f32 v220, v220, v218
    v_mul_f32 v221, v221, v218
    v_mul_f32 v222, v222, v218
    v_mul_f32 v223, v223, v218
    v_accvgpr_write_b32 a56, v220
    v_accvgpr_write_b32 a57, v221
    v_accvgpr_write_b32 a58, v222
    v_accvgpr_write_b32 a59, v223
    v_accvgpr_read_b32 v220, a60
    v_accvgpr_read_b32 v221, a61
    v_accvgpr_read_b32 v222, a62
    v_accvgpr_read_b32 v223, a63
    v_mul_f32 v220, v220, v218
    v_mul_f32 v221, v221, v218
    v_mul_f32 v222, v222, v218
    v_mul_f32 v223, v223, v218
    v_accvgpr_write_b32 a60, v220
    v_accvgpr_write_b32 a61, v221
    v_accvgpr_write_b32 a62, v222
    v_accvgpr_write_b32 a63, v223
    v_accvgpr_read_b32 v220, a64
    v_accvgpr_read_b32 v221, a65
    v_accvgpr_read_b32 v222, a66
    v_accvgpr_read_b32 v223, a67
    v_mul_f32 v220, v220, v218
    v_mul_f32 v221, v221, v218
    v_mul_f32 v222, v222, v218
    v_mul_f32 v223, v223, v218
    v_accvgpr_write_b32 a64, v220
    v_accvgpr_write_b32 a65, v221
    v_accvgpr_write_b32 a66, v222
    v_accvgpr_write_b32 a67, v223
    v_accvgpr_read_b32 v220, a68
    v_accvgpr_read_b32 v221, a69
    v_accvgpr_read_b32 v222, a70
    v_accvgpr_read_b32 v223, a71
    v_mul_f32 v220, v220, v218
    v_mul_f32 v221, v221, v218
    v_mul_f32 v222, v222, v218
    v_mul_f32 v223, v223, v218
    v_accvgpr_write_b32 a68, v220
    v_accvgpr_write_b32 a69, v221
    v_accvgpr_write_b32 a70, v222
    v_accvgpr_write_b32 a71, v223
    v_accvgpr_read_b32 v220, a72
    v_accvgpr_read_b32 v221, a73
    v_accvgpr_read_b32 v222, a74
    v_accvgpr_read_b32 v223, a75
    v_mul_f32 v220, v220, v218
    v_mul_f32 v221, v221, v218
    v_mul_f32 v222, v222, v218
    v_mul_f32 v223, v223, v218
    v_accvgpr_write_b32 a72, v220
    v_accvgpr_write_b32 a73, v221
    v_accvgpr_write_b32 a74, v222
    v_accvgpr_write_b32 a75, v223
    v_accvgpr_read_b32 v220, a76
    v_accvgpr_read_b32 v221, a77
    v_accvgpr_read_b32 v222, a78
    v_accvgpr_read_b32 v223, a79
    v_mul_f32 v220, v220, v218
    v_mul_f32 v221, v221, v218
    v_mul_f32 v222, v222, v218
    v_mul_f32 v223, v223, v218
    v_accvgpr_write_b32 a76, v220
    v_accvgpr_write_b32 a77, v221
    v_accvgpr_write_b32 a78, v222
    v_accvgpr_write_b32 a79, v223
    v_accvgpr_read_b32 v220, a80
    v_accvgpr_read_b32 v221, a81
    v_accvgpr_read_b32 v222, a82
    v_accvgpr_read_b32 v223, a83
    v_mul_f32 v220, v220, v218
    v_mul_f32 v221, v221, v218
    v_mul_f32 v222, v222, v218
    v_mul_f32 v223, v223, v218
    v_accvgpr_write_b32 a80, v220
    v_accvgpr_write_b32 a81, v221
    v_accvgpr_write_b32 a82, v222
    v_accvgpr_write_b32 a83, v223
    v_accvgpr_read_b32 v220, a84
    v_accvgpr_read_b32 v221, a85
    v_accvgpr_read_b32 v222, a86
    v_accvgpr_read_b32 v223, a87
    v_mul_f32 v220, v220, v218
    v_mul_f32 v221, v221, v218
    v_mul_f32 v222, v222, v218
    v_mul_f32 v223, v223, v218
    v_accvgpr_write_b32 a84, v220
    v_accvgpr_write_b32 a85, v221
    v_accvgpr_write_b32 a86, v222
    v_accvgpr_write_b32 a87, v223
    v_accvgpr_read_b32 v220, a88
    v_accvgpr_read_b32 v221, a89
    v_accvgpr_read_b32 v222, a90
    v_accvgpr_read_b32 v223, a91
    v_mul_f32 v220, v220, v218
    v_mul_f32 v221, v221, v218
    v_mul_f32 v222, v222, v218
    v_mul_f32 v223, v223, v218
    v_accvgpr_write_b32 a88, v220
    v_accvgpr_write_b32 a89, v221
    v_accvgpr_write_b32 a90, v222
    v_accvgpr_write_b32 a91, v223
    v_accvgpr_read_b32 v220, a92
    v_accvgpr_read_b32 v221, a93
    v_accvgpr_read_b32 v222, a94
    v_accvgpr_read_b32 v223, a95
    v_mul_f32 v220, v220, v218
    v_mul_f32 v221, v221, v218
    v_mul_f32 v222, v222, v218
    v_mul_f32 v223, v223, v218
    v_accvgpr_write_b32 a92, v220
    v_accvgpr_write_b32 a93, v221
    v_accvgpr_write_b32 a94, v222
    v_accvgpr_write_b32 a95, v223
    v_max3_f32 v216, v16, v17, v18
    v_max3_f32 v216, v216, v19, v20
    v_max3_f32 v216, v216, v21, v22
    v_max3_f32 v216, v216, v23, v24
    v_max3_f32 v216, v216, v25, v26
    v_max3_f32 v216, v216, v27, v28
    v_max3_f32 v216, v216, v29, v30
    v_max_f32 v216, v216, v31
    v_mov_b32 v217, v216
    s_nop 1
    v_permlane32_swap_b32 v216, v217
    s_nop 1
    v_max_f32 v216, v216, v217
    v_max_f32 v216, 0, v216
    v_sub_f32 v217, 0, v216
    v_exp_f32 v218, v217
    v_sub_f32 v112, v112, v216
    v_sub_f32 v16, v16, v216
    v_sub_f32 v48, v48, v216
    v_sub_f32 v113, v113, v216
    v_sub_f32 v17, v17, v216
    v_sub_f32 v49, v49, v216
    v_sub_f32 v114, v114, v216
    v_sub_f32 v18, v18, v216
    v_sub_f32 v50, v50, v216
    v_sub_f32 v115, v115, v216
    v_sub_f32 v19, v19, v216
    v_sub_f32 v51, v51, v216
    v_sub_f32 v116, v116, v216
    v_sub_f32 v20, v20, v216
    v_sub_f32 v52, v52, v216
    v_sub_f32 v117, v117, v216
    v_sub_f32 v21, v21, v216
    v_sub_f32 v53, v53, v216
    v_sub_f32 v118, v118, v216
    v_sub_f32 v22, v22, v216
    v_sub_f32 v54, v54, v216
    v_sub_f32 v119, v119, v216
    v_sub_f32 v23, v23, v216
    v_sub_f32 v55, v55, v216
    v_sub_f32 v120, v120, v216
    v_sub_f32 v24, v24, v216
    v_sub_f32 v56, v56, v216
    v_sub_f32 v121, v121, v216
    v_sub_f32 v25, v25, v216
    v_sub_f32 v57, v57, v216
    v_sub_f32 v122, v122, v216
    v_sub_f32 v26, v26, v216
    v_sub_f32 v58, v58, v216
    v_sub_f32 v123, v123, v216
    v_sub_f32 v27, v27, v216
    v_sub_f32 v59, v59, v216
    v_sub_f32 v124, v124, v216
    v_sub_f32 v28, v28, v216
    v_sub_f32 v60, v60, v216
    v_sub_f32 v125, v125, v216
    v_sub_f32 v29, v29, v216
    v_sub_f32 v61, v61, v216
    v_sub_f32 v126, v126, v216
    v_sub_f32 v30, v30, v216
    v_sub_f32 v62, v62, v216
    v_sub_f32 v127, v127, v216
    v_sub_f32 v31, v31, v216
    v_sub_f32 v63, v63, v216
    v_mul_f32 v213, v213, v218
    v_accvgpr_read_b32 v220, a96
    v_accvgpr_read_b32 v221, a97
    v_accvgpr_read_b32 v222, a98
    v_accvgpr_read_b32 v223, a99
    v_mul_f32 v220, v220, v218
    v_mul_f32 v221, v221, v218
    v_mul_f32 v222, v222, v218
    v_mul_f32 v223, v223, v218
    v_accvgpr_write_b32 a96, v220
    v_accvgpr_write_b32 a97, v221
    v_accvgpr_write_b32 a98, v222
    v_accvgpr_write_b32 a99, v223
    v_accvgpr_read_b32 v220, a100
    v_accvgpr_read_b32 v221, a101
    v_accvgpr_read_b32 v222, a102
    v_accvgpr_read_b32 v223, a103
    v_mul_f32 v220, v220, v218
    v_mul_f32 v221, v221, v218
    v_mul_f32 v222, v222, v218
    v_mul_f32 v223, v223, v218
    v_accvgpr_write_b32 a100, v220
    v_accvgpr_write_b32 a101, v221
    v_accvgpr_write_b32 a102, v222
    v_accvgpr_write_b32 a103, v223
    v_accvgpr_read_b32 v220, a104
    v_accvgpr_read_b32 v221, a105
    v_accvgpr_read_b32 v222, a106
    v_accvgpr_read_b32 v223, a107
    v_mul_f32 v220, v220, v218
    v_mul_f32 v221, v221, v218
    v_mul_f32 v222, v222, v218
    v_mul_f32 v223, v223, v218
    v_accvgpr_write_b32 a104, v220
    v_accvgpr_write_b32 a105, v221
    v_accvgpr_write_b32 a106, v222
    v_accvgpr_write_b32 a107, v223
    v_accvgpr_read_b32 v220, a108
    v_accvgpr_read_b32 v221, a109
    v_accvgpr_read_b32 v222, a110
    v_accvgpr_read_b32 v223, a111
    v_mul_f32 v220, v220, v218
    v_mul_f32 v221, v221, v218
    v_mul_f32 v222, v222, v218
    v_mul_f32 v223, v223, v218
    v_accvgpr_write_b32 a108, v220
    v_accvgpr_write_b32 a109, v221
    v_accvgpr_write_b32 a110, v222
    v_accvgpr_write_b32 a111, v223
    v_accvgpr_read_b32 v220, a112
    v_accvgpr_read_b32 v221, a113
    v_accvgpr_read_b32 v222, a114
    v_accvgpr_read_b32 v223, a115
    v_mul_f32 v220, v220, v218
    v_mul_f32 v221, v221, v218
    v_mul_f32 v222, v222, v218
    v_mul_f32 v223, v223, v218
    v_accvgpr_write_b32 a112, v220
    v_accvgpr_write_b32 a113, v221
    v_accvgpr_write_b32 a114, v222
    v_accvgpr_write_b32 a115, v223
    v_accvgpr_read_b32 v220, a116
    v_accvgpr_read_b32 v221, a117
    v_accvgpr_read_b32 v222, a118
    v_accvgpr_read_b32 v223, a119
    v_mul_f32 v220, v220, v218
    v_mul_f32 v221, v221, v218
    v_mul_f32 v222, v222, v218
    v_mul_f32 v223, v223, v218
    v_accvgpr_write_b32 a116, v220
    v_accvgpr_write_b32 a117, v221
    v_accvgpr_write_b32 a118, v222
    v_accvgpr_write_b32 a119, v223
    v_accvgpr_read_b32 v220, a120
    v_accvgpr_read_b32 v221, a121
    v_accvgpr_read_b32 v222, a122
    v_accvgpr_read_b32 v223, a123
    v_mul_f32 v220, v220, v218
    v_mul_f32 v221, v221, v218
    v_mul_f32 v222, v222, v218
    v_mul_f32 v223, v223, v218
    v_accvgpr_write_b32 a120, v220
    v_accvgpr_write_b32 a121, v221
    v_accvgpr_write_b32 a122, v222
    v_accvgpr_write_b32 a123, v223
    v_accvgpr_read_b32 v220, a124
    v_accvgpr_read_b32 v221, a125
    v_accvgpr_read_b32 v222, a126
    v_accvgpr_read_b32 v223, a127
    v_mul_f32 v220, v220, v218
    v_mul_f32 v221, v221, v218
    v_mul_f32 v222, v222, v218
    v_mul_f32 v223, v223, v218
    v_accvgpr_write_b32 a124, v220
    v_accvgpr_write_b32 a125, v221
    v_accvgpr_write_b32 a126, v222
    v_accvgpr_write_b32 a127, v223
    v_accvgpr_read_b32 v220, a128
    v_accvgpr_read_b32 v221, a129
    v_accvgpr_read_b32 v222, a130
    v_accvgpr_read_b32 v223, a131
    v_mul_f32 v220, v220, v218
    v_mul_f32 v221, v221, v218
    v_mul_f32 v222, v222, v218
    v_mul_f32 v223, v223, v218
    v_accvgpr_write_b32 a128, v220
    v_accvgpr_write_b32 a129, v221
    v_accvgpr_write_b32 a130, v222
    v_accvgpr_write_b32 a131, v223
    v_accvgpr_read_b32 v220, a132
    v_accvgpr_read_b32 v221, a133
    v_accvgpr_read_b32 v222, a134
    v_accvgpr_read_b32 v223, a135
    v_mul_f32 v220, v220, v218
    v_mul_f32 v221, v221, v218
    v_mul_f32 v222, v222, v218
    v_mul_f32 v223, v223, v218
    v_accvgpr_write_b32 a132, v220
    v_accvgpr_write_b32 a133, v221
    v_accvgpr_write_b32 a134, v222
    v_accvgpr_write_b32 a135, v223
    v_accvgpr_read_b32 v220, a136
    v_accvgpr_read_b32 v221, a137
    v_accvgpr_read_b32 v222, a138
    v_accvgpr_read_b32 v223, a139
    v_mul_f32 v220, v220, v218
    v_mul_f32 v221, v221, v218
    v_mul_f32 v222, v222, v218
    v_mul_f32 v223, v223, v218
    v_accvgpr_write_b32 a136, v220
    v_accvgpr_write_b32 a137, v221
    v_accvgpr_write_b32 a138, v222
    v_accvgpr_write_b32 a139, v223
    v_accvgpr_read_b32 v220, a140
    v_accvgpr_read_b32 v221, a141
    v_accvgpr_read_b32 v222, a142
    v_accvgpr_read_b32 v223, a143
    v_mul_f32 v220, v220, v218
    v_mul_f32 v221, v221, v218
    v_mul_f32 v222, v222, v218
    v_mul_f32 v223, v223, v218
    v_accvgpr_write_b32 a140, v220
    v_accvgpr_write_b32 a141, v221
    v_accvgpr_write_b32 a142, v222
    v_accvgpr_write_b32 a143, v223
    v_accvgpr_read_b32 v220, a144
    v_accvgpr_read_b32 v221, a145
    v_accvgpr_read_b32 v222, a146
    v_accvgpr_read_b32 v223, a147
    v_mul_f32 v220, v220, v218
    v_mul_f32 v221, v221, v218
    v_mul_f32 v222, v222, v218
    v_mul_f32 v223, v223, v218
    v_accvgpr_write_b32 a144, v220
    v_accvgpr_write_b32 a145, v221
    v_accvgpr_write_b32 a146, v222
    v_accvgpr_write_b32 a147, v223
    v_accvgpr_read_b32 v220, a148
    v_accvgpr_read_b32 v221, a149
    v_accvgpr_read_b32 v222, a150
    v_accvgpr_read_b32 v223, a151
    v_mul_f32 v220, v220, v218
    v_mul_f32 v221, v221, v218
    v_mul_f32 v222, v222, v218
    v_mul_f32 v223, v223, v218
    v_accvgpr_write_b32 a148, v220
    v_accvgpr_write_b32 a149, v221
    v_accvgpr_write_b32 a150, v222
    v_accvgpr_write_b32 a151, v223
    v_accvgpr_read_b32 v220, a152
    v_accvgpr_read_b32 v221, a153
    v_accvgpr_read_b32 v222, a154
    v_accvgpr_read_b32 v223, a155
    v_mul_f32 v220, v220, v218
    v_mul_f32 v221, v221, v218
    v_mul_f32 v222, v222, v218
    v_mul_f32 v223, v223, v218
    v_accvgpr_write_b32 a152, v220
    v_accvgpr_write_b32 a153, v221
    v_accvgpr_write_b32 a154, v222
    v_accvgpr_write_b32 a155, v223
    v_accvgpr_read_b32 v220, a156
    v_accvgpr_read_b32 v221, a157
    v_accvgpr_read_b32 v222, a158
    v_accvgpr_read_b32 v223, a159
    v_mul_f32 v220, v220, v218
    v_mul_f32 v221, v221, v218
    v_mul_f32 v222, v222, v218
    v_mul_f32 v223, v223, v218
    v_accvgpr_write_b32 a156, v220
    v_accvgpr_write_b32 a157, v221
    v_accvgpr_write_b32 a158, v222
    v_accvgpr_write_b32 a159, v223
    v_accvgpr_read_b32 v220, a160
    v_accvgpr_read_b32 v221, a161
    v_accvgpr_read_b32 v222, a162
    v_accvgpr_read_b32 v223, a163
    v_mul_f32 v220, v220, v218
    v_mul_f32 v221, v221, v218
    v_mul_f32 v222, v222, v218
    v_mul_f32 v223, v223, v218
    v_accvgpr_write_b32 a160, v220
    v_accvgpr_write_b32 a161, v221
    v_accvgpr_write_b32 a162, v222
    v_accvgpr_write_b32 a163, v223
    v_accvgpr_read_b32 v220, a164
    v_accvgpr_read_b32 v221, a165
    v_accvgpr_read_b32 v222, a166
    v_accvgpr_read_b32 v223, a167
    v_mul_f32 v220, v220, v218
    v_mul_f32 v221, v221, v218
    v_mul_f32 v222, v222, v218
    v_mul_f32 v223, v223, v218
    v_accvgpr_write_b32 a164, v220
    v_accvgpr_write_b32 a165, v221
    v_accvgpr_write_b32 a166, v222
    v_accvgpr_write_b32 a167, v223
    v_accvgpr_read_b32 v220, a168
    v_accvgpr_read_b32 v221, a169
    v_accvgpr_read_b32 v222, a170
    v_accvgpr_read_b32 v223, a171
    v_mul_f32 v220, v220, v218
    v_mul_f32 v221, v221, v218
    v_mul_f32 v222, v222, v218
    v_mul_f32 v223, v223, v218
    v_accvgpr_write_b32 a168, v220
    v_accvgpr_write_b32 a169, v221
    v_accvgpr_write_b32 a170, v222
    v_accvgpr_write_b32 a171, v223
    v_accvgpr_read_b32 v220, a172
    v_accvgpr_read_b32 v221, a173
    v_accvgpr_read_b32 v222, a174
    v_accvgpr_read_b32 v223, a175
    v_mul_f32 v220, v220, v218
    v_mul_f32 v221, v221, v218
    v_mul_f32 v222, v222, v218
    v_mul_f32 v223, v223, v218
    v_accvgpr_write_b32 a172, v220
    v_accvgpr_write_b32 a173, v221
    v_accvgpr_write_b32 a174, v222
    v_accvgpr_write_b32 a175, v223
    v_accvgpr_read_b32 v220, a176
    v_accvgpr_read_b32 v221, a177
    v_accvgpr_read_b32 v222, a178
    v_accvgpr_read_b32 v223, a179
    v_mul_f32 v220, v220, v218
    v_mul_f32 v221, v221, v218
    v_mul_f32 v222, v222, v218
    v_mul_f32 v223, v223, v218
    v_accvgpr_write_b32 a176, v220
    v_accvgpr_write_b32 a177, v221
    v_accvgpr_write_b32 a178, v222
    v_accvgpr_write_b32 a179, v223
    v_accvgpr_read_b32 v220, a180
    v_accvgpr_read_b32 v221, a181
    v_accvgpr_read_b32 v222, a182
    v_accvgpr_read_b32 v223, a183
    v_mul_f32 v220, v220, v218
    v_mul_f32 v221, v221, v218
    v_mul_f32 v222, v222, v218
    v_mul_f32 v223, v223, v218
    v_accvgpr_write_b32 a180, v220
    v_accvgpr_write_b32 a181, v221
    v_accvgpr_write_b32 a182, v222
    v_accvgpr_write_b32 a183, v223
    v_accvgpr_read_b32 v220, a184
    v_accvgpr_read_b32 v221, a185
    v_accvgpr_read_b32 v222, a186
    v_accvgpr_read_b32 v223, a187
    v_mul_f32 v220, v220, v218
    v_mul_f32 v221, v221, v218
    v_mul_f32 v222, v222, v218
    v_mul_f32 v223, v223, v218
    v_accvgpr_write_b32 a184, v220
    v_accvgpr_write_b32 a185, v221
    v_accvgpr_write_b32 a186, v222
    v_accvgpr_write_b32 a187, v223
    v_accvgpr_read_b32 v220, a188
    v_accvgpr_read_b32 v221, a189
    v_accvgpr_read_b32 v222, a190
    v_accvgpr_read_b32 v223, a191
    v_mul_f32 v220, v220, v218
    v_mul_f32 v221, v221, v218
    v_mul_f32 v222, v222, v218
    v_mul_f32 v223, v223, v218
    v_accvgpr_write_b32 a188, v220
    v_accvgpr_write_b32 a189, v221
    v_accvgpr_write_b32 a190, v222
    v_accvgpr_write_b32 a191, v223
    v_exp_f32 v192, v0
    s_nop 0
    v_exp_f32 v193, v1
    s_nop 0
    v_exp_f32 v194, v2
    s_nop 0
    v_exp_f32 v195, v3
    s_nop 0
    v_add_f32 v214, v192, v193
    s_nop 0
    v_cvt_pk_bf16_f32 v64, v192, v193
    s_nop 0
    v_exp_f32 v196, v4
    s_nop 0
    v_add_f32 v214, v214, v194
    s_nop 0
    v_exp_f32 v197, v5
    s_nop 0
    v_add_f32 v214, v214, v195
    s_nop 0
    v_cvt_pk_bf16_f32 v65, v194, v195
    s_nop 0
    v_exp_f32 v192, v6
    s_nop 0
    v_add_f32 v214, v214, v196
    s_nop 0
    v_exp_f32 v193, v7
    s_nop 0
    v_add_f32 v214, v214, v197
    s_nop 0
    v_cvt_pk_bf16_f32 v66, v196, v197
    s_nop 0
    v_exp_f32 v194, v8
    s_nop 0
    v_add_f32 v214, v214, v192
    s_nop 0
    v_exp_f32 v195, v9
    s_nop 0
    v_add_f32 v214, v214, v193
    s_nop 0
    v_cvt_pk_bf16_f32 v67, v192, v193
    s_nop 0
    v_exp_f32 v196, v10
    s_nop 0
    v_add_f32 v214, v214, v194
    s_nop 0
    v_exp_f32 v197, v11
    s_nop 0
    v_add_f32 v214, v214, v195
    s_nop 0
    v_cvt_pk_bf16_f32 v68, v194, v195
    s_nop 0
    v_exp_f32 v192, v12
    s_nop 0
    v_add_f32 v214, v214, v196
    s_nop 0
    v_exp_f32 v193, v13
    s_nop 0
    v_add_f32 v214, v214, v197
    s_nop 0
    v_cvt_pk_bf16_f32 v69, v196, v197
    s_nop 0
    v_exp_f32 v194, v14
    s_nop 0
    v_add_f32 v214, v214, v192
    s_nop 0
    v_exp_f32 v195, v15
    s_nop 0
    v_add_f32 v214, v214, v193
    s_nop 0
    v_cvt_pk_bf16_f32 v70, v192, v193
    s_nop 0
    v_exp_f32 v196, v16
    s_nop 0
    v_add_f32 v214, v214, v194
    s_nop 0
    v_exp_f32 v197, v17
    s_nop 0
    v_add_f32 v214, v214, v195
    s_nop 0
    v_cvt_pk_bf16_f32 v71, v194, v195
    s_nop 0
    v_exp_f32 v192, v18
    s_nop 0
    v_exp_f32 v193, v19
    s_nop 0
    v_add_f32 v215, v196, v197
    s_nop 0
    v_cvt_pk_bf16_f32 v72, v196, v197
    s_nop 0
    v_exp_f32 v194, v20
    s_nop 0
    v_add_f32 v215, v215, v192
    s_nop 0
    v_exp_f32 v195, v21
    s_nop 0
    v_add_f32 v215, v215, v193
    s_nop 0
    v_cvt_pk_bf16_f32 v73, v192, v193
    s_nop 0
    v_exp_f32 v196, v22
    s_nop 0
    v_add_f32 v215, v215, v194
    s_nop 0
    v_exp_f32 v197, v23
    s_nop 0
    v_add_f32 v215, v215, v195
    s_nop 0
    v_cvt_pk_bf16_f32 v74, v194, v195
    s_nop 0
    v_exp_f32 v192, v24
    s_nop 0
    v_add_f32 v215, v215, v196
    s_nop 0
    v_exp_f32 v193, v25
    s_nop 0
    v_add_f32 v215, v215, v197
    s_nop 0
    v_cvt_pk_bf16_f32 v75, v196, v197
    s_nop 0
    v_exp_f32 v194, v26
    s_nop 0
    v_add_f32 v215, v215, v192
    s_nop 0
    v_exp_f32 v195, v27
    s_nop 0
    v_add_f32 v215, v215, v193
    s_nop 0
    v_cvt_pk_bf16_f32 v76, v192, v193
    s_nop 0
    v_exp_f32 v196, v28
    s_nop 0
    v_add_f32 v215, v215, v194
    s_nop 0
    v_exp_f32 v197, v29
    s_nop 0
    v_add_f32 v215, v215, v195
    s_nop 0
    v_cvt_pk_bf16_f32 v77, v194, v195
    s_nop 0
    v_exp_f32 v192, v30
    s_nop 0
    v_add_f32 v215, v215, v196
    s_nop 0
    v_exp_f32 v193, v31
    s_nop 0
    v_add_f32 v215, v215, v197
    s_nop 0
    v_cvt_pk_bf16_f32 v78, v196, v197
    s_nop 0
    v_add_f32 v215, v215, v192
    s_nop 0
    v_add_f32 v215, v215, v193
    s_nop 0
    v_cvt_pk_bf16_f32 v79, v192, v193
    s_nop 0
    s_nop 3
    s_branch F_retL4
F_slowT:
    s_nop 15
    s_nop 15
    v_max3_f32 v216, v32, v33, v34
    v_max3_f32 v216, v216, v35, v36
    v_max3_f32 v216, v216, v37, v38
    v_max3_f32 v216, v216, v39, v40
    v_max3_f32 v216, v216, v41, v42
    v_max3_f32 v216, v216, v43, v44
    v_max3_f32 v216, v216, v45, v46
    v_max_f32 v216, v216, v47
    v_mov_b32 v217, v216
    s_nop 1
    v_permlane32_swap_b32 v216, v217
    s_nop 1
    v_max_f32 v216, v216, v217
    v_max_f32 v216, 0, v216
    v_sub_f32 v217, 0, v216
    v_exp_f32 v218, v217
    v_sub_f32 v96, v96, v216
    v_sub_f32 v32, v32, v216
    v_sub_f32 v97, v97, v216
    v_sub_f32 v33, v33, v216
    v_sub_f32 v98, v98, v216
    v_sub_f32 v34, v34, v216
    v_sub_f32 v99, v99, v216
    v_sub_f32 v35, v35, v216
    v_sub_f32 v100, v100, v216
    v_sub_f32 v36, v36, v216
    v_sub_f32 v101, v101, v216
    v_sub_f32 v37, v37, v216
    v_sub_f32 v102, v102, v216
    v_sub_f32 v38, v38, v216
    v_sub_f32 v103, v103, v216
    v_sub_f32 v39, v39, v216
    v_sub_f32 v104, v104, v216
    v_sub_f32 v40, v40, v216
    v_sub_f32 v105, v105, v216
    v_sub_f32 v41, v41, v216
    v_sub_f32 v106, v106, v216
    v_sub_f32 v42, v42, v216
    v_sub_f32 v107, v107, v216
    v_sub_f32 v43, v43, v216
    v_sub_f32 v108, v108, v216
    v_sub_f32 v44, v44, v216
    v_sub_f32 v109, v109, v216
    v_sub_f32 v45, v45, v216
    v_sub_f32 v110, v110, v216
    v_sub_f32 v46, v46, v216
    v_sub_f32 v111, v111, v216
    v_sub_f32 v47, v47, v216
    v_mul_f32 v212, v212, v218
    v_accvgpr_read_b32 v220, a0
    v_accvgpr_read_b32 v221, a1
    v_accvgpr_read_b32 v222, a2
    v_accvgpr_read_b32 v223, a3
    v_mul_f32 v220, v220, v218
    v_mul_f32 v221, v221, v218
    v_mul_f32 v222, v222, v218
    v_mul_f32 v223, v223, v218
    v_accvgpr_write_b32 a0, v220
    v_accvgpr_write_b32 a1, v221
    v_accvgpr_write_b32 a2, v222
    v_accvgpr_write_b32 a3, v223
    v_accvgpr_read_b32 v220, a4
    v_accvgpr_read_b32 v221, a5
    v_accvgpr_read_b32 v222, a6
    v_accvgpr_read_b32 v223, a7
    v_mul_f32 v220, v220, v218
    v_mul_f32 v221, v221, v218
    v_mul_f32 v222, v222, v218
    v_mul_f32 v223, v223, v218
    v_accvgpr_write_b32 a4, v220
    v_accvgpr_write_b32 a5, v221
    v_accvgpr_write_b32 a6, v222
    v_accvgpr_write_b32 a7, v223
    v_accvgpr_read_b32 v220, a8
    v_accvgpr_read_b32 v221, a9
    v_accvgpr_read_b32 v222, a10
    v_accvgpr_read_b32 v223, a11
    v_mul_f32 v220, v220, v218
    v_mul_f32 v221, v221, v218
    v_mul_f32 v222, v222, v218
    v_mul_f32 v223, v223, v218
    v_accvgpr_write_b32 a8, v220
    v_accvgpr_write_b32 a9, v221
    v_accvgpr_write_b32 a10, v222
    v_accvgpr_write_b32 a11, v223
    v_accvgpr_read_b32 v220, a12
    v_accvgpr_read_b32 v221, a13
    v_accvgpr_read_b32 v222, a14
    v_accvgpr_read_b32 v223, a15
    v_mul_f32 v220, v220, v218
    v_mul_f32 v221, v221, v218
    v_mul_f32 v222, v222, v218
    v_mul_f32 v223, v223, v218
    v_accvgpr_write_b32 a12, v220
    v_accvgpr_write_b32 a13, v221
    v_accvgpr_write_b32 a14, v222
    v_accvgpr_write_b32 a15, v223
    v_accvgpr_read_b32 v220, a16
    v_accvgpr_read_b32 v221, a17
    v_accvgpr_read_b32 v222, a18
    v_accvgpr_read_b32 v223, a19
    v_mul_f32 v220, v220, v218
    v_mul_f32 v221, v221, v218
    v_mul_f32 v222, v222, v218
    v_mul_f32 v223, v223, v218
    v_accvgpr_write_b32 a16, v220
    v_accvgpr_write_b32 a17, v221
    v_accvgpr_write_b32 a18, v222
    v_accvgpr_write_b32 a19, v223
    v_accvgpr_read_b32 v220, a20
    v_accvgpr_read_b32 v221, a21
    v_accvgpr_read_b32 v222, a22
    v_accvgpr_read_b32 v223, a23
    v_mul_f32 v220, v220, v218
    v_mul_f32 v221, v221, v218
    v_mul_f32 v222, v222, v218
    v_mul_f32 v223, v223, v218
    v_accvgpr_write_b32 a20, v220
    v_accvgpr_write_b32 a21, v221
    v_accvgpr_write_b32 a22, v222
    v_accvgpr_write_b32 a23, v223
    v_accvgpr_read_b32 v220, a24
    v_accvgpr_read_b32 v221, a25
    v_accvgpr_read_b32 v222, a26
    v_accvgpr_read_b32 v223, a27
    v_mul_f32 v220, v220, v218
    v_mul_f32 v221, v221, v218
    v_mul_f32 v222, v222, v218
    v_mul_f32 v223, v223, v218
    v_accvgpr_write_b32 a24, v220
    v_accvgpr_write_b32 a25, v221
    v_accvgpr_write_b32 a26, v222
    v_accvgpr_write_b32 a27, v223
    v_accvgpr_read_b32 v220, a28
    v_accvgpr_read_b32 v221, a29
    v_accvgpr_read_b32 v222, a30
    v_accvgpr_read_b32 v223, a31
    v_mul_f32 v220, v220, v218
    v_mul_f32 v221, v221, v218
    v_mul_f32 v222, v222, v218
    v_mul_f32 v223, v223, v218
    v_accvgpr_write_b32 a28, v220
    v_accvgpr_write_b32 a29, v221
    v_accvgpr_write_b32 a30, v222
    v_accvgpr_write_b32 a31, v223
    v_accvgpr_read_b32 v220, a32
    v_accvgpr_read_b32 v221, a33
    v_accvgpr_read_b32 v222, a34
    v_accvgpr_read_b32 v223, a35
    v_mul_f32 v220, v220, v218
    v_mul_f32 v221, v221, v218
    v_mul_f32 v222, v222, v218
    v_mul_f32 v223, v223, v218
    v_accvgpr_write_b32 a32, v220
    v_accvgpr_write_b32 a33, v221
    v_accvgpr_write_b32 a34, v222
    v_accvgpr_write_b32 a35, v223
    v_accvgpr_read_b32 v220, a36
    v_accvgpr_read_b32 v221, a37
    v_accvgpr_read_b32 v222, a38
    v_accvgpr_read_b32 v223, a39
    v_mul_f32 v220, v220, v218
    v_mul_f32 v221, v221, v218
    v_mul_f32 v222, v222, v218
    v_mul_f32 v223, v223, v218
    v_accvgpr_write_b32 a36, v220
    v_accvgpr_write_b32 a37, v221
    v_accvgpr_write_b32 a38, v222
    v_accvgpr_write_b32 a39, v223
    v_accvgpr_read_b32 v220, a40
    v_accvgpr_read_b32 v221, a41
    v_accvgpr_read_b32 v222, a42
    v_accvgpr_read_b32 v223, a43
    v_mul_f32 v220, v220, v218
    v_mul_f32 v221, v221, v218
    v_mul_f32 v222, v222, v218
    v_mul_f32 v223, v223, v218
    v_accvgpr_write_b32 a40, v220
    v_accvgpr_write_b32 a41, v221
    v_accvgpr_write_b32 a42, v222
    v_accvgpr_write_b32 a43, v223
    v_accvgpr_read_b32 v220, a44
    v_accvgpr_read_b32 v221, a45
    v_accvgpr_read_b32 v222, a46
    v_accvgpr_read_b32 v223, a47
    v_mul_f32 v220, v220, v218
    v_mul_f32 v221, v221, v218
    v_mul_f32 v222, v222, v218
    v_mul_f32 v223, v223, v218
    v_accvgpr_write_b32 a44, v220
    v_accvgpr_write_b32 a45, v221
    v_accvgpr_write_b32 a46, v222
    v_accvgpr_write_b32 a47, v223
    v_accvgpr_read_b32 v220, a48
    v_accvgpr_read_b32 v221, a49
    v_accvgpr_read_b32 v222, a50
    v_accvgpr_read_b32 v223, a51
    v_mul_f32 v220, v220, v218
    v_mul_f32 v221, v221, v218
    v_mul_f32 v222, v222, v218
    v_mul_f32 v223, v223, v218
    v_accvgpr_write_b32 a48, v220
    v_accvgpr_write_b32 a49, v221
    v_accvgpr_write_b32 a50, v222
    v_accvgpr_write_b32 a51, v223
    v_accvgpr_read_b32 v220, a52
    v_accvgpr_read_b32 v221, a53
    v_accvgpr_read_b32 v222, a54
    v_accvgpr_read_b32 v223, a55
    v_mul_f32 v220, v220, v218
    v_mul_f32 v221, v221, v218
    v_mul_f32 v222, v222, v218
    v_mul_f32 v223, v223, v218
    v_accvgpr_write_b32 a52, v220
    v_accvgpr_write_b32 a53, v221
    v_accvgpr_write_b32 a54, v222
    v_accvgpr_write_b32 a55, v223
    v_accvgpr_read_b32 v220, a56
    v_accvgpr_read_b32 v221, a57
    v_accvgpr_read_b32 v222, a58
    v_accvgpr_read_b32 v223, a59
    v_mul_f32 v220, v220, v218
    v_mul_f32 v221, v221, v218
    v_mul_f32 v222, v222, v218
    v_mul_f32 v223, v223, v218
    v_accvgpr_write_b32 a56, v220
    v_accvgpr_write_b32 a57, v221
    v_accvgpr_write_b32 a58, v222
    v_accvgpr_write_b32 a59, v223
    v_accvgpr_read_b32 v220, a60
    v_accvgpr_read_b32 v221, a61
    v_accvgpr_read_b32 v222, a62
    v_accvgpr_read_b32 v223, a63
    v_mul_f32 v220, v220, v218
    v_mul_f32 v221, v221, v218
    v_mul_f32 v222, v222, v218
    v_mul_f32 v223, v223, v218
    v_accvgpr_write_b32 a60, v220
    v_accvgpr_write_b32 a61, v221
    v_accvgpr_write_b32 a62, v222
    v_accvgpr_write_b32 a63, v223
    v_accvgpr_read_b32 v220, a64
    v_accvgpr_read_b32 v221, a65
    v_accvgpr_read_b32 v222, a66
    v_accvgpr_read_b32 v223, a67
    v_mul_f32 v220, v220, v218
    v_mul_f32 v221, v221, v218
    v_mul_f32 v222, v222, v218
    v_mul_f32 v223, v223, v218
    v_accvgpr_write_b32 a64, v220
    v_accvgpr_write_b32 a65, v221
    v_accvgpr_write_b32 a66, v222
    v_accvgpr_write_b32 a67, v223
    v_accvgpr_read_b32 v220, a68
    v_accvgpr_read_b32 v221, a69
    v_accvgpr_read_b32 v222, a70
    v_accvgpr_read_b32 v223, a71
    v_mul_f32 v220, v220, v218
    v_mul_f32 v221, v221, v218
    v_mul_f32 v222, v222, v218
    v_mul_f32 v223, v223, v218
    v_accvgpr_write_b32 a68, v220
    v_accvgpr_write_b32 a69, v221
    v_accvgpr_write_b32 a70, v222
    v_accvgpr_write_b32 a71, v223
    v_accvgpr_read_b32 v220, a72
    v_accvgpr_read_b32 v221, a73
    v_accvgpr_read_b32 v222, a74
    v_accvgpr_read_b32 v223, a75
    v_mul_f32 v220, v220, v218
    v_mul_f32 v221, v221, v218
    v_mul_f32 v222, v222, v218
    v_mul_f32 v223, v223, v218
    v_accvgpr_write_b32 a72, v220
    v_accvgpr_write_b32 a73, v221
    v_accvgpr_write_b32 a74, v222
    v_accvgpr_write_b32 a75, v223
    v_accvgpr_read_b32 v220, a76
    v_accvgpr_read_b32 v221, a77
    v_accvgpr_read_b32 v222, a78
    v_accvgpr_read_b32 v223, a79
    v_mul_f32 v220, v220, v218
    v_mul_f32 v221, v221, v218
    v_mul_f32 v222, v222, v218
    v_mul_f32 v223, v223, v218
    v_accvgpr_write_b32 a76, v220
    v_accvgpr_write_b32 a77, v221
    v_accvgpr_write_b32 a78, v222
    v_accvgpr_write_b32 a79, v223
    v_accvgpr_read_b32 v220, a80
    v_accvgpr_read_b32 v221, a81
    v_accvgpr_read_b32 v222, a82
    v_accvgpr_read_b32 v223, a83
    v_mul_f32 v220, v220, v218
    v_mul_f32 v221, v221, v218
    v_mul_f32 v222, v222, v218
    v_mul_f32 v223, v223, v218
    v_accvgpr_write_b32 a80, v220
    v_accvgpr_write_b32 a81, v221
    v_accvgpr_write_b32 a82, v222
    v_accvgpr_write_b32 a83, v223
    v_accvgpr_read_b32 v220, a84
    v_accvgpr_read_b32 v221, a85
    v_accvgpr_read_b32 v222, a86
    v_accvgpr_read_b32 v223, a87
    v_mul_f32 v220, v220, v218
    v_mul_f32 v221, v221, v218
    v_mul_f32 v222, v222, v218
    v_mul_f32 v223, v223, v218
    v_accvgpr_write_b32 a84, v220
    v_accvgpr_write_b32 a85, v221
    v_accvgpr_write_b32 a86, v222
    v_accvgpr_write_b32 a87, v223
    v_accvgpr_read_b32 v220, a88
    v_accvgpr_read_b32 v221, a89
    v_accvgpr_read_b32 v222, a90
    v_accvgpr_read_b32 v223, a91
    v_mul_f32 v220, v220, v218
    v_mul_f32 v221, v221, v218
    v_mul_f32 v222, v222, v218
    v_mul_f32 v223, v223, v218
    v_accvgpr_write_b32 a88, v220
    v_accvgpr_write_b32 a89, v221
    v_accvgpr_write_b32 a90, v222
    v_accvgpr_write_b32 a91, v223
    v_accvgpr_read_b32 v220, a92
    v_accvgpr_read_b32 v221, a93
    v_accvgpr_read_b32 v222, a94
    v_accvgpr_read_b32 v223, a95
    v_mul_f32 v220, v220, v218
    v_mul_f32 v221, v221, v218
    v_mul_f32 v222, v222, v218
    v_mul_f32 v223, v223, v218
    v_accvgpr_write_b32 a92, v220
    v_accvgpr_write_b32 a93, v221
    v_accvgpr_write_b32 a94, v222
    v_accvgpr_write_b32 a95, v223
    v_max3_f32 v216, v48, v49, v50
    v_max3_f32 v216, v216, v51, v52
    v_max3_f32 v216, v216, v53, v54
    v_max3_f32 v216, v216, v55, v56
    v_max3_f32 v216, v216, v57, v58
    v_max3_f32 v216, v216, v59, v60
    v_max3_f32 v216, v216, v61, v62
    v_max_f32 v216, v216, v63
    v_mov_b32 v217, v216
    s_nop 1
    v_permlane32_swap_b32 v216, v217
    s_nop 1
    v_max_f32 v216, v216, v217
    v_max_f32 v216, 0, v216
    v_sub_f32 v217, 0, v216
    v_exp_f32 v218, v217
    v_sub_f32 v112, v112, v216
    v_sub_f32 v48, v48, v216
    v_sub_f32 v113, v113, v216
    v_sub_f32 v49, v49, v216
    v_sub_f32 v114, v114, v216
    v_sub_f32 v50, v50, v216
    v_sub_f32 v115, v115, v216
    v_sub_f32 v51, v51, v216
    v_sub_f32 v116, v116, v216
    v_sub_f32 v52, v52, v216
    v_sub_f32 v117, v117, v216
    v_sub_f32 v53, v53, v216
    v_sub_f32 v118, v118, v216
    v_sub_f32 v54, v54, v216
    v_sub_f32 v119, v119, v216
    v_sub_f32 v55, v55, v216
    v_sub_f32 v120, v120, v216
    v_sub_f32 v56, v56, v216
    v_sub_f32 v121, v121, v216
    v_sub_f32 v57, v57, v216
    v_sub_f32 v122, v122, v216
    v_sub_f32 v58, v58, v216
    v_sub_f32 v123, v123, v216
    v_sub_f32 v59, v59, v216
    v_sub_f32 v124, v124, v216
    v_sub_f32 v60, v60, v216
    v_sub_f32 v125, v125, v216
    v_sub_f32 v61, v61, v216
    v_sub_f32 v126, v126, v216
    v_sub_f32 v62, v62, v216
    v_sub_f32 v127, v127, v216
    v_sub_f32 v63, v63, v216
    v_mul_f32 v213, v213, v218
    v_accvgpr_read_b32 v220, a96
    v_accvgpr_read_b32 v221, a97
    v_accvgpr_read_b32 v222, a98
    v_accvgpr_read_b32 v223, a99
    v_mul_f32 v220, v220, v218
    v_mul_f32 v221, v221, v218
    v_mul_f32 v222, v222, v218
    v_mul_f32 v223, v223, v218
    v_accvgpr_write_b32 a96, v220
    v_accvgpr_write_b32 a97, v221
    v_accvgpr_write_b32 a98, v222
    v_accvgpr_write_b32 a99, v223
    v_accvgpr_read_b32 v220, a100
    v_accvgpr_read_b32 v221, a101
    v_accvgpr_read_b32 v222, a102
    v_accvgpr_read_b32 v223, a103
    v_mul_f32 v220, v220, v218
    v_mul_f32 v221, v221, v218
    v_mul_f32 v222, v222, v218
    v_mul_f32 v223, v223, v218
    v_accvgpr_write_b32 a100, v220
    v_accvgpr_write_b32 a101, v221
    v_accvgpr_write_b32 a102, v222
    v_accvgpr_write_b32 a103, v223
    v_accvgpr_read_b32 v220, a104
    v_accvgpr_read_b32 v221, a105
    v_accvgpr_read_b32 v222, a106
    v_accvgpr_read_b32 v223, a107
    v_mul_f32 v220, v220, v218
    v_mul_f32 v221, v221, v218
    v_mul_f32 v222, v222, v218
    v_mul_f32 v223, v223, v218
    v_accvgpr_write_b32 a104, v220
    v_accvgpr_write_b32 a105, v221
    v_accvgpr_write_b32 a106, v222
    v_accvgpr_write_b32 a107, v223
    v_accvgpr_read_b32 v220, a108
    v_accvgpr_read_b32 v221, a109
    v_accvgpr_read_b32 v222, a110
    v_accvgpr_read_b32 v223, a111
    v_mul_f32 v220, v220, v218
    v_mul_f32 v221, v221, v218
    v_mul_f32 v222, v222, v218
    v_mul_f32 v223, v223, v218
    v_accvgpr_write_b32 a108, v220
    v_accvgpr_write_b32 a109, v221
    v_accvgpr_write_b32 a110, v222
    v_accvgpr_write_b32 a111, v223
    v_accvgpr_read_b32 v220, a112
    v_accvgpr_read_b32 v221, a113
    v_accvgpr_read_b32 v222, a114
    v_accvgpr_read_b32 v223, a115
    v_mul_f32 v220, v220, v218
    v_mul_f32 v221, v221, v218
    v_mul_f32 v222, v222, v218
    v_mul_f32 v223, v223, v218
    v_accvgpr_write_b32 a112, v220
    v_accvgpr_write_b32 a113, v221
    v_accvgpr_write_b32 a114, v222
    v_accvgpr_write_b32 a115, v223
    v_accvgpr_read_b32 v220, a116
    v_accvgpr_read_b32 v221, a117
    v_accvgpr_read_b32 v222, a118
    v_accvgpr_read_b32 v223, a119
    v_mul_f32 v220, v220, v218
    v_mul_f32 v221, v221, v218
    v_mul_f32 v222, v222, v218
    v_mul_f32 v223, v223, v218
    v_accvgpr_write_b32 a116, v220
    v_accvgpr_write_b32 a117, v221
    v_accvgpr_write_b32 a118, v222
    v_accvgpr_write_b32 a119, v223
    v_accvgpr_read_b32 v220, a120
    v_accvgpr_read_b32 v221, a121
    v_accvgpr_read_b32 v222, a122
    v_accvgpr_read_b32 v223, a123
    v_mul_f32 v220, v220, v218
    v_mul_f32 v221, v221, v218
    v_mul_f32 v222, v222, v218
    v_mul_f32 v223, v223, v218
    v_accvgpr_write_b32 a120, v220
    v_accvgpr_write_b32 a121, v221
    v_accvgpr_write_b32 a122, v222
    v_accvgpr_write_b32 a123, v223
    v_accvgpr_read_b32 v220, a124
    v_accvgpr_read_b32 v221, a125
    v_accvgpr_read_b32 v222, a126
    v_accvgpr_read_b32 v223, a127
    v_mul_f32 v220, v220, v218
    v_mul_f32 v221, v221, v218
    v_mul_f32 v222, v222, v218
    v_mul_f32 v223, v223, v218
    v_accvgpr_write_b32 a124, v220
    v_accvgpr_write_b32 a125, v221
    v_accvgpr_write_b32 a126, v222
    v_accvgpr_write_b32 a127, v223
    v_accvgpr_read_b32 v220, a128
    v_accvgpr_read_b32 v221, a129
    v_accvgpr_read_b32 v222, a130
    v_accvgpr_read_b32 v223, a131
    v_mul_f32 v220, v220, v218
    v_mul_f32 v221, v221, v218
    v_mul_f32 v222, v222, v218
    v_mul_f32 v223, v223, v218
    v_accvgpr_write_b32 a128, v220
    v_accvgpr_write_b32 a129, v221
    v_accvgpr_write_b32 a130, v222
    v_accvgpr_write_b32 a131, v223
    v_accvgpr_read_b32 v220, a132
    v_accvgpr_read_b32 v221, a133
    v_accvgpr_read_b32 v222, a134
    v_accvgpr_read_b32 v223, a135
    v_mul_f32 v220, v220, v218
    v_mul_f32 v221, v221, v218
    v_mul_f32 v222, v222, v218
    v_mul_f32 v223, v223, v218
    v_accvgpr_write_b32 a132, v220
    v_accvgpr_write_b32 a133, v221
    v_accvgpr_write_b32 a134, v222
    v_accvgpr_write_b32 a135, v223
    v_accvgpr_read_b32 v220, a136
    v_accvgpr_read_b32 v221, a137
    v_accvgpr_read_b32 v222, a138
    v_accvgpr_read_b32 v223, a139
    v_mul_f32 v220, v220, v218
    v_mul_f32 v221, v221, v218
    v_mul_f32 v222, v222, v218
    v_mul_f32 v223, v223, v218
    v_accvgpr_write_b32 a136, v220
    v_accvgpr_write_b32 a137, v221
    v_accvgpr_write_b32 a138, v222
    v_accvgpr_write_b32 a139, v223
    v_accvgpr_read_b32 v220, a140
    v_accvgpr_read_b32 v221, a141
    v_accvgpr_read_b32 v222, a142
    v_accvgpr_read_b32 v223, a143
    v_mul_f32 v220, v220, v218
    v_mul_f32 v221, v221, v218
    v_mul_f32 v222, v222, v218
    v_mul_f32 v223, v223, v218
    v_accvgpr_write_b32 a140, v220
    v_accvgpr_write_b32 a141, v221
    v_accvgpr_write_b32 a142, v222
    v_accvgpr_write_b32 a143, v223
    v_accvgpr_read_b32 v220, a144
    v_accvgpr_read_b32 v221, a145
    v_accvgpr_read_b32 v222, a146
    v_accvgpr_read_b32 v223, a147
    v_mul_f32 v220, v220, v218
    v_mul_f32 v221, v221, v218
    v_mul_f32 v222, v222, v218
    v_mul_f32 v223, v223, v218
    v_accvgpr_write_b32 a144, v220
    v_accvgpr_write_b32 a145, v221
    v_accvgpr_write_b32 a146, v222
    v_accvgpr_write_b32 a147, v223
    v_accvgpr_read_b32 v220, a148
    v_accvgpr_read_b32 v221, a149
    v_accvgpr_read_b32 v222, a150
    v_accvgpr_read_b32 v223, a151
    v_mul_f32 v220, v220, v218
    v_mul_f32 v221, v221, v218
    v_mul_f32 v222, v222, v218
    v_mul_f32 v223, v223, v218
    v_accvgpr_write_b32 a148, v220
    v_accvgpr_write_b32 a149, v221
    v_accvgpr_write_b32 a150, v222
    v_accvgpr_write_b32 a151, v223
    v_accvgpr_read_b32 v220, a152
    v_accvgpr_read_b32 v221, a153
    v_accvgpr_read_b32 v222, a154
    v_accvgpr_read_b32 v223, a155
    v_mul_f32 v220, v220, v218
    v_mul_f32 v221, v221, v218
    v_mul_f32 v222, v222, v218
    v_mul_f32 v223, v223, v218
    v_accvgpr_write_b32 a152, v220
    v_accvgpr_write_b32 a153, v221
    v_accvgpr_write_b32 a154, v222
    v_accvgpr_write_b32 a155, v223
    v_accvgpr_read_b32 v220, a156
    v_accvgpr_read_b32 v221, a157
    v_accvgpr_read_b32 v222, a158
    v_accvgpr_read_b32 v223, a159
    v_mul_f32 v220, v220, v218
    v_mul_f32 v221, v221, v218
    v_mul_f32 v222, v222, v218
    v_mul_f32 v223, v223, v218
    v_accvgpr_write_b32 a156, v220
    v_accvgpr_write_b32 a157, v221
    v_accvgpr_write_b32 a158, v222
    v_accvgpr_write_b32 a159, v223
    v_accvgpr_read_b32 v220, a160
    v_accvgpr_read_b32 v221, a161
    v_accvgpr_read_b32 v222, a162
    v_accvgpr_read_b32 v223, a163
    v_mul_f32 v220, v220, v218
    v_mul_f32 v221, v221, v218
    v_mul_f32 v222, v222, v218
    v_mul_f32 v223, v223, v218
    v_accvgpr_write_b32 a160, v220
    v_accvgpr_write_b32 a161, v221
    v_accvgpr_write_b32 a162, v222
    v_accvgpr_write_b32 a163, v223
    v_accvgpr_read_b32 v220, a164
    v_accvgpr_read_b32 v221, a165
    v_accvgpr_read_b32 v222, a166
    v_accvgpr_read_b32 v223, a167
    v_mul_f32 v220, v220, v218
    v_mul_f32 v221, v221, v218
    v_mul_f32 v222, v222, v218
    v_mul_f32 v223, v223, v218
    v_accvgpr_write_b32 a164, v220
    v_accvgpr_write_b32 a165, v221
    v_accvgpr_write_b32 a166, v222
    v_accvgpr_write_b32 a167, v223
    v_accvgpr_read_b32 v220, a168
    v_accvgpr_read_b32 v221, a169
    v_accvgpr_read_b32 v222, a170
    v_accvgpr_read_b32 v223, a171
    v_mul_f32 v220, v220, v218
    v_mul_f32 v221, v221, v218
    v_mul_f32 v222, v222, v218
    v_mul_f32 v223, v223, v218
    v_accvgpr_write_b32 a168, v220
    v_accvgpr_write_b32 a169, v221
    v_accvgpr_write_b32 a170, v222
    v_accvgpr_write_b32 a171, v223
    v_accvgpr_read_b32 v220, a172
    v_accvgpr_read_b32 v221, a173
    v_accvgpr_read_b32 v222, a174
    v_accvgpr_read_b32 v223, a175
    v_mul_f32 v220, v220, v218
    v_mul_f32 v221, v221, v218
    v_mul_f32 v222, v222, v218
    v_mul_f32 v223, v223, v218
    v_accvgpr_write_b32 a172, v220
    v_accvgpr_write_b32 a173, v221
    v_accvgpr_write_b32 a174, v222
    v_accvgpr_write_b32 a175, v223
    v_accvgpr_read_b32 v220, a176
    v_accvgpr_read_b32 v221, a177
    v_accvgpr_read_b32 v222, a178
    v_accvgpr_read_b32 v223, a179
    v_mul_f32 v220, v220, v218
    v_mul_f32 v221, v221, v218
    v_mul_f32 v222, v222, v218
    v_mul_f32 v223, v223, v218
    v_accvgpr_write_b32 a176, v220
    v_accvgpr_write_b32 a177, v221
    v_accvgpr_write_b32 a178, v222
    v_accvgpr_write_b32 a179, v223
    v_accvgpr_read_b32 v220, a180
    v_accvgpr_read_b32 v221, a181
    v_accvgpr_read_b32 v222, a182
    v_accvgpr_read_b32 v223, a183
    v_mul_f32 v220, v220, v218
    v_mul_f32 v221, v221, v218
    v_mul_f32 v222, v222, v218
    v_mul_f32 v223, v223, v218
    v_accvgpr_write_b32 a180, v220
    v_accvgpr_write_b32 a181, v221
    v_accvgpr_write_b32 a182, v222
    v_accvgpr_write_b32 a183, v223
    v_accvgpr_read_b32 v220, a184
    v_accvgpr_read_b32 v221, a185
    v_accvgpr_read_b32 v222, a186
    v_accvgpr_read_b32 v223, a187
    v_mul_f32 v220, v220, v218
    v_mul_f32 v221, v221, v218
    v_mul_f32 v222, v222, v218
    v_mul_f32 v223, v223, v218
    v_accvgpr_write_b32 a184, v220
    v_accvgpr_write_b32 a185, v221
    v_accvgpr_write_b32 a186, v222
    v_accvgpr_write_b32 a187, v223
    v_accvgpr_read_b32 v220, a188
    v_accvgpr_read_b32 v221, a189
    v_accvgpr_read_b32 v222, a190
    v_accvgpr_read_b32 v223, a191
    v_mul_f32 v220, v220, v218
    v_mul_f32 v221, v221, v218
    v_mul_f32 v222, v222, v218
    v_mul_f32 v223, v223, v218
    v_accvgpr_write_b32 a188, v220
    v_accvgpr_write_b32 a189, v221
    v_accvgpr_write_b32 a190, v222
    v_accvgpr_write_b32 a191, v223
    v_exp_f32 v192, v32
    s_nop 0
    v_exp_f32 v193, v33
    s_nop 0
    v_exp_f32 v194, v34
    s_nop 0
    v_exp_f32 v195, v35
    s_nop 0
    v_add_f32 v214, v192, v193
    s_nop 0
    v_cvt_pk_bf16_f32 v80, v192, v193
    s_nop 0
    v_exp_f32 v196, v36
    s_nop 0
    v_add_f32 v214, v214, v194
    s_nop 0
    v_exp_f32 v197, v37
    s_nop 0
    v_add_f32 v214, v214, v195
    s_nop 0
    v_cvt_pk_bf16_f32 v81, v194, v195
    s_nop 0
    v_exp_f32 v192, v38
    s_nop 0
    v_add_f32 v214, v214, v196
    s_nop 0
    v_exp_f32 v193, v39
    s_nop 0
    v_add_f32 v214, v214, v197
    s_nop 0
    v_cvt_pk_bf16_f32 v82, v196, v197
    s_nop 0
    v_exp_f32 v194, v40
    s_nop 0
    v_add_f32 v214, v214, v192
    s_nop 0
    v_exp_f32 v195, v41
    s_nop 0
    v_add_f32 v214, v214, v193
    s_nop 0
    v_cvt_pk_bf16_f32 v83, v192, v193
    s_nop 0
    v_exp_f32 v196, v42
    s_nop 0
    v_add_f32 v214, v214, v194
    s_nop 0
    v_exp_f32 v197, v43
    s_nop 0
    v_add_f32 v214, v214, v195
    s_nop 0
    v_cvt_pk_bf16_f32 v84, v194, v195
    s_nop 0
    v_exp_f32 v192, v44
    s_nop 0
    v_add_f32 v214, v214, v196
    s_nop 0
    v_exp_f32 v193, v45
    s_nop 0
    v_add_f32 v214, v214, v197
    s_nop 0
    v_cvt_pk_bf16_f32 v85, v196, v197
    s_nop 0
    v_exp_f32 v194, v46
    s_nop 0
    v_add_f32 v214, v214, v192
    s_nop 0
    v_exp_f32 v195, v47
    s_nop 0
    v_add_f32 v214, v214, v193
    s_nop 0
    v_cvt_pk_bf16_f32 v86, v192, v193
    s_nop 0
    v_exp_f32 v196, v48
    s_nop 0
    v_add_f32 v214, v214, v194
    s_nop 0
    v_exp_f32 v197, v49
    s_nop 0
    v_add_f32 v214, v214, v195
    s_nop 0
    v_cvt_pk_bf16_f32 v87, v194, v195
    s_nop 0
    v_exp_f32 v192, v50
    s_nop 0
    v_exp_f32 v193, v51
    s_nop 0
    v_add_f32 v215, v196, v197
    s_nop 0
    v_cvt_pk_bf16_f32 v88, v196, v197
    s_nop 0
    v_exp_f32 v194, v52
    s_nop 0
    v_add_f32 v215, v215, v192
    s_nop 0
    v_exp_f32 v195, v53
    s_nop 0
    v_add_f32 v215, v215, v193
    s_nop 0
    v_cvt_pk_bf16_f32 v89, v192, v193
    s_nop 0
    v_exp_f32 v196, v54
    s_nop 0
    v_add_f32 v215, v215, v194
    s_nop 0
    v_exp_f32 v197, v55
    s_nop 0
    v_add_f32 v215, v215, v195
    s_nop 0
    v_cvt_pk_bf16_f32 v90, v194, v195
    s_nop 0
    v_exp_f32 v192, v56
    s_nop 0
    v_add_f32 v215, v215, v196
    s_nop 0
    v_exp_f32 v193, v57
    s_nop 0
    v_add_f32 v215, v215, v197
    s_nop 0
    v_cvt_pk_bf16_f32 v91, v196, v197
    s_nop 0
    v_exp_f32 v194, v58
    s_nop 0
    v_add_f32 v215, v215, v192
    s_nop 0
    v_exp_f32 v195, v59
    s_nop 0
    v_add_f32 v215, v215, v193
    s_nop 0
    v_cvt_pk_bf16_f32 v92, v192, v193
    s_nop 0
    v_exp_f32 v196, v60
    s_nop 0
    v_add_f32 v215, v215, v194
    s_nop 0
    v_exp_f32 v197, v61
    s_nop 0
    v_add_f32 v215, v215, v195
    s_nop 0
    v_cvt_pk_bf16_f32 v93, v194, v195
    s_nop 0
    v_exp_f32 v192, v62
    s_nop 0
    v_add_f32 v215, v215, v196
    s_nop 0
    v_exp_f32 v193, v63
    s_nop 0
    v_add_f32 v215, v215, v197
    s_nop 0
    v_cvt_pk_bf16_f32 v94, v196, v197
    s_nop 0
    v_add_f32 v215, v215, v192
    s_nop 0
    v_add_f32 v215, v215, v193
    s_nop 0
    v_cvt_pk_bf16_f32 v95, v192, v193
    s_nop 0
    s_nop 3
    s_branch F_retT
.section .rodata,"a"
.p2align 6
.amdhsa_kernel standalone__mha_softmax__prompt_kernel
  .amdhsa_next_free_vgpr 512
  .amdhsa_next_free_sgpr 102
  .amdhsa_accum_offset 256
  .amdhsa_group_segment_fixed_size 0
  .amdhsa_kernarg_size 48
  .amdhsa_user_sgpr_count 2
  .amdhsa_user_sgpr_kernarg_segment_ptr 1
  .amdhsa_system_sgpr_workgroup_id_x 1
.end_amdhsa_kernel
```
